```python
import torch

def _softmax(x, axis=-1):
    return torch.softmax(x, dim=axis)

def _gelu(x):
    return torch.nn.functional.gelu(x, approximate='tanh')

def _silu(x):
    return torch.nn.functional.silu(x)

def _sigmoid(x):
    return torch.sigmoid(x)

def _layernorm(x, axis=-1, eps=1e-05):
    m = x.mean(dim=axis, keepdim=True)
    v = x.var(dim=axis, keepdim=True, unbiased=False)
    return (x - m) / torch.sqrt(v + eps)

def _scatter_add(tgt, idx, src, axis=0):
    return tgt.clone().index_add_(axis, idx, src)

def _segment_sum(src, seg, n):
    out = torch.zeros((n,) + src.shape[1:], dtype=src.dtype)
    return out.index_add_(0, seg, src)

def _pad(x, pw):
    flat = tuple((v for pair in reversed(pw) for v in pair))
    return torch.nn.functional.pad(x, flat)
kernel_name = 'adaLN_cond__linear_kernel_hedgehog__dense_activation_squared_relu__prompt'

def setup_inputs():

    _w = lambda a: (lambda t: t.to(torch.bfloat16) if t.is_floating_point() else t)(torch.as_tensor(a))

    def _A_setup():
        B, S, D, H = (1, 2048, 1024, 32)
        Dh = D // H
        return {'x': _w((lambda *s: torch.randn(*s, dtype=torch.bfloat16) * 0.05)(B, S, D)), 'wqkv': _w((lambda *s: torch.randn(*s, dtype=torch.bfloat16) * 0.4)(D, 3 * D)), 'w_phi': _w((lambda *s: torch.randn(*s, dtype=torch.bfloat16) * 0.4)(H, Dh, Dh) * Dh ** (-0.5)), 'wo': _w((lambda *s: torch.randn(*s, dtype=torch.bfloat16) * 0.05)(D, D))}
    _A_in = _A_setup()

    def _B_setup():
        B, S, D, F = (1, 2048, 1024, 3584)
        return {'x': _w((lambda *s: torch.randn(*s, dtype=torch.bfloat16) * 0.05)(B, S, D)), 'w1': _w((lambda *s: torch.randn(*s, dtype=torch.bfloat16) * 0.05)(D, F)), 'b1': _w((lambda *s: torch.randn(*s, dtype=torch.bfloat16) * 0.4)(F)), 'w2': _w((lambda *s: torch.randn(*s, dtype=torch.bfloat16) * 0.05)(F, D)), 'b2': _w((lambda *s: torch.randn(*s, dtype=torch.bfloat16) * 6.4)(D))}
    _B_in = _B_setup()
    return {'A_x': _A_in['x'], 'A_wqkv': _A_in['wqkv'], 'A_w_phi': _A_in['w_phi'], 'A_wo': _A_in['wo'], 'B_x': _B_in['x'], 'B_w1': _B_in['w1'], 'B_b1': _B_in['b1'], 'B_w2': _B_in['w2'], 'B_b2': _B_in['b2'], 'c': _w((lambda *s: torch.randn(*s, dtype=torch.bfloat16) * 0.1)(1, 1024) * 8.0), 'w_mod': _w((lambda *s: torch.randn(*s, dtype=torch.bfloat16) * 0.1)(1024, 6 * 1024) * 1024 ** (-0.5) * 8.0)}

def reference(A_x, A_wqkv, A_w_phi, A_wo, B_x, B_w1, B_b1, B_w2, B_b2, c, w_mod):

    def _A_ref(x, wqkv, w_phi, wo):
        B, S, D = x.shape
        H = 32
        Dh = D // H
        qkv = (lambda x, *d: x.permute(*d))((x @ wqkv).reshape(B, S, 3, H, Dh), 2, 0, 3, 1, 4)
        q, k, v = (qkv[0], qkv[1], qkv[2])
        pq = torch.einsum('bhsd,hdf->bhsf', q, w_phi)
        pk = torch.einsum('bhsd,hdf->bhsf', k, w_phi)
        phi_q = torch.concatenate([_softmax(pq, axis=-1), _softmax(-pq, axis=-1)], axis=-1)
        phi_k = torch.concatenate([_softmax(pk, axis=-1), _softmax(-pk, axis=-1)], axis=-1)
        kv = torch.einsum('bhsf,bhsd->bhfd', phi_k, v)
        z = torch.einsum('bhsf->bhf', phi_k)
        num = torch.einsum('bhqf,bhfd->bhqd', phi_q, kv)
        den = torch.einsum('bhqf,bhf->bhq', phi_q, z)[..., None] + 1e-06
        o = num / den
        return (lambda x, *d: x.permute(*d))(o, 0, 2, 1, 3).reshape(B, S, D) @ wo

    def _B_ref(x, w1, b1, w2, b2):
        h = torch.einsum('bsd,df->bsf', x, w1) + b1
        zero = torch.zeros_like(h)
        r = torch.where(h > zero, h, zero)
        h = r * r
        out = torch.einsum('bsf,fd->bsd', h, w2) + b2
        return out
    x = A_x
    mod = (_silu(c) @ w_mod).reshape(c.shape[0], 6, 1, -1)
    sa, ca, ga, sb, cb, gb = (mod[:, 0].clone(), mod[:, 1].clone(), mod[:, 2].clone(), mod[:, 3].clone(), mod[:, 4].clone(), mod[:, 5].clone())
    h = _layernorm(x, axis=-1) * (1 + ca) + sa
    x = x + ga * _A_ref(h, A_wqkv, A_w_phi, A_wo)
    h = _layernorm(x, axis=-1) * (1 + cb) + sb
    x = x + gb * _B_ref(h, B_w1, B_b1, B_w2, B_b2)
    return x
```

```asm
; @launch grid=(256,1,1) block=(512,1,1) lds=163840
.amdgcn_target "amdgcn-amd-amdhsa--gfx950"
.text
.globl adaLN_cond__linear_kernel_hedgehog__dense_activation_squared_relu__prompt_kernel
.p2align 8
.type adaLN_cond__linear_kernel_hedgehog__dense_activation_squared_relu__prompt_kernel,@function
adaLN_cond__linear_kernel_hedgehog__dense_activation_squared_relu__prompt_kernel:
    s_cmp_ge_u32 s2, 256
    s_cbranch_scc1 mega_end
    v_lshrrev_b32 v2, 6, v0
    v_and_b32 v1, 63, v0
    v_readfirstlane_b32 s42, v2
    s_nop 0
    s_cmp_lt_u32 s42, 4
    s_cbranch_scc1 mega_cons
    s_load_dwordx2 s[74:75], s[0:1], 72
    s_load_dwordx2 s[76:77], s[0:1], 80
    s_load_dwordx2 s[6:7], s[0:1], 104
    s_load_dwordx2 s[4:5], s[0:1], 8
    s_load_dwordx2 s[32:33], s[0:1], 16
    s_load_dwordx2 s[78:79], s[0:1], 24
    s_load_dwordx2 s[34:35], s[0:1], 48
    s_load_dwordx2 s[30:31], s[0:1], 64
    s_and_b32 s36, s2, 7
    s_lshr_b32 s37, s2, 3
    s_and_b32 s38, s36, 1
    s_lshr_b32 s36, s36, 1
    s_and_b32 s39, s37, 7
    s_lshr_b32 s37, s37, 3
    s_mul_i32 s38, s38, 8
    s_add_u32 s40, s38, s39
    s_mul_i32 s36, s36, 4
    s_add_u32 s41, s36, s37
    s_add_u32 s39, s39, s37
    s_and_b32 s39, s39, 3
    s_mul_i32 s43, s41, 128
    s_and_b32 s60, s2, 7
    s_lshl_b32 s60, s60, 3
    s_bfe_u32 s61, s2, 0x30003
    s_add_u32 s60, s60, s61
    s_lshr_b32 s61, s2, 6
    s_lshl_b32 s62, s61, 9
    s_mul_i32 s63, s61, 3145728
    s_lshl_b32 s64, s60, 6
    s_add_u32 s63, s63, s64
    v_and_b32 v2, 255, v0
    v_mov_b32 v5, 88064
    v_mov_b32 v6, 0
    v_mov_b32 v7, 0
    ds_write_b32 v5, v6
    v_mov_b32 v3, 147392
    ds_write_b64 v3, v[6:7]
    s_waitcnt lgkmcnt(0)
    s_mov_b32 s20, s74
    s_mov_b32 s21, s75
    s_mov_b32 s22, 2048
    s_mov_b32 s23, 0x20000
    s_mov_b32 s24, s76
    s_mov_b32 s25, s77
    s_mov_b32 s26, 12582912
    s_mov_b32 s27, 0x20000
    v_lshrrev_b32 v44, 2, v2
    v_lshlrev_b32 v45, 3, v44
    v_mul_u32_u24 v44, 49152, v44
    buffer_load_dwordx2 v[8:9], v45, s[20:23], s62 offen
    v_and_b32 v45, 3, v2
    v_lshl_add_u32 v44, v45, 4, v44
    buffer_load_dwordx4 v[12:15], v44, s[24:27], s63 offen nt
    s_add_u32 s63, s63, 12288
    buffer_load_dwordx4 v[16:19], v44, s[24:27], s63 offen nt
    s_add_u32 s63, s63, 12288
    buffer_load_dwordx4 v[20:23], v44, s[24:27], s63 offen nt
    s_add_u32 s63, s63, 12288
    buffer_load_dwordx4 v[24:27], v44, s[24:27], s63 offen nt
    s_barrier
    s_load_dword s3, s[6:7], 524288
    s_add_u32 s16, s6, 983040
    s_addc_u32 s17, s7, 0
    s_mov_b32 s18, 65536
    s_mov_b32 s19, 0x20000
    s_waitcnt vmcnt(4)
    v_lshlrev_b32 v48, 16, v8
    v_and_b32 v49, 0xffff0000, v8
    v_lshlrev_b32 v50, 16, v9
    v_and_b32 v51, 0xffff0000, v9
    s_mov_b32 s58, 0x3fb8aa3b
    v_mul_f32 v56, s58, v48
    v_mul_f32 v57, s58, v49
    v_mul_f32 v58, s58, v50
    v_mul_f32 v59, s58, v51
    v_exp_f32 v56, -v56
    v_exp_f32 v57, -v57
    v_exp_f32 v58, -v58
    v_exp_f32 v59, -v59
    v_add_f32 v56, 1.0, v56
    v_add_f32 v57, 1.0, v57
    v_add_f32 v58, 1.0, v58
    v_add_f32 v59, 1.0, v59
    v_rcp_f32 v56, v56
    v_rcp_f32 v57, v57
    v_rcp_f32 v58, v58
    v_rcp_f32 v59, v59
    v_mul_f32 v48, v48, v56
    v_mul_f32 v49, v49, v57
    v_mul_f32 v50, v50, v58
    v_mul_f32 v51, v51, v59
    v_cvt_pk_bf16_f32 v56, v48, v49
    v_cvt_pk_bf16_f32 v57, v50, v51
    v_lshlrev_b32 v48, 16, v56
    v_and_b32 v49, 0xffff0000, v56
    v_lshlrev_b32 v50, 16, v57
    v_and_b32 v51, 0xffff0000, v57
    s_waitcnt vmcnt(3)
    v_lshlrev_b32 v64, 16, v12
    v_and_b32 v65, 0xffff0000, v12
    v_lshlrev_b32 v66, 16, v13
    v_and_b32 v67, 0xffff0000, v13
    v_lshlrev_b32 v68, 16, v14
    v_and_b32 v69, 0xffff0000, v14
    v_lshlrev_b32 v70, 16, v15
    v_and_b32 v71, 0xffff0000, v15
    v_pk_mul_f32 v[56:57], v[64:65], v[48:49] op_sel_hi:[1,0]
    v_pk_mul_f32 v[58:59], v[66:67], v[48:49] op_sel_hi:[1,0]
    v_pk_mul_f32 v[60:61], v[68:69], v[48:49] op_sel_hi:[1,0]
    v_pk_mul_f32 v[62:63], v[70:71], v[48:49] op_sel_hi:[1,0]
    s_waitcnt vmcnt(2)
    v_lshlrev_b32 v64, 16, v16
    v_and_b32 v65, 0xffff0000, v16
    v_lshlrev_b32 v66, 16, v17
    v_and_b32 v67, 0xffff0000, v17
    v_lshlrev_b32 v68, 16, v18
    v_and_b32 v69, 0xffff0000, v18
    v_lshlrev_b32 v70, 16, v19
    v_and_b32 v71, 0xffff0000, v19
    v_pk_fma_f32 v[56:57], v[64:65], v[48:49], v[56:57] op_sel:[0,1,0]
    v_pk_fma_f32 v[58:59], v[66:67], v[48:49], v[58:59] op_sel:[0,1,0]
    v_pk_fma_f32 v[60:61], v[68:69], v[48:49], v[60:61] op_sel:[0,1,0]
    v_pk_fma_f32 v[62:63], v[70:71], v[48:49], v[62:63] op_sel:[0,1,0]
    s_waitcnt vmcnt(1)
    v_lshlrev_b32 v64, 16, v20
    v_and_b32 v65, 0xffff0000, v20
    v_lshlrev_b32 v66, 16, v21
    v_and_b32 v67, 0xffff0000, v21
    v_lshlrev_b32 v68, 16, v22
    v_and_b32 v69, 0xffff0000, v22
    v_lshlrev_b32 v70, 16, v23
    v_and_b32 v71, 0xffff0000, v23
    v_pk_fma_f32 v[56:57], v[64:65], v[50:51], v[56:57] op_sel_hi:[1,0,1]
    v_pk_fma_f32 v[58:59], v[66:67], v[50:51], v[58:59] op_sel_hi:[1,0,1]
    v_pk_fma_f32 v[60:61], v[68:69], v[50:51], v[60:61] op_sel_hi:[1,0,1]
    v_pk_fma_f32 v[62:63], v[70:71], v[50:51], v[62:63] op_sel_hi:[1,0,1]
    s_waitcnt vmcnt(0)
    v_lshlrev_b32 v64, 16, v24
    v_and_b32 v65, 0xffff0000, v24
    v_lshlrev_b32 v66, 16, v25
    v_and_b32 v67, 0xffff0000, v25
    v_lshlrev_b32 v68, 16, v26
    v_and_b32 v69, 0xffff0000, v26
    v_lshlrev_b32 v70, 16, v27
    v_and_b32 v71, 0xffff0000, v27
    v_pk_fma_f32 v[56:57], v[64:65], v[50:51], v[56:57] op_sel:[0,1,0]
    v_pk_fma_f32 v[58:59], v[66:67], v[50:51], v[58:59] op_sel:[0,1,0]
    v_pk_fma_f32 v[60:61], v[68:69], v[50:51], v[60:61] op_sel:[0,1,0]
    v_pk_fma_f32 v[62:63], v[70:71], v[50:51], v[62:63] op_sel:[0,1,0]
    v_add_f32_dpp v56, v56, v56 row_ror:4 row_mask:0xf bank_mask:0xf
    v_add_f32_dpp v57, v57, v57 row_ror:4 row_mask:0xf bank_mask:0xf
    v_add_f32_dpp v58, v58, v58 row_ror:4 row_mask:0xf bank_mask:0xf
    v_add_f32_dpp v59, v59, v59 row_ror:4 row_mask:0xf bank_mask:0xf
    v_add_f32_dpp v60, v60, v60 row_ror:4 row_mask:0xf bank_mask:0xf
    v_add_f32_dpp v61, v61, v61 row_ror:4 row_mask:0xf bank_mask:0xf
    v_add_f32_dpp v62, v62, v62 row_ror:4 row_mask:0xf bank_mask:0xf
    v_add_f32_dpp v63, v63, v63 row_ror:4 row_mask:0xf bank_mask:0xf
    v_add_f32_dpp v56, v56, v56 row_ror:8 row_mask:0xf bank_mask:0xf
    v_add_f32_dpp v57, v57, v57 row_ror:8 row_mask:0xf bank_mask:0xf
    v_add_f32_dpp v58, v58, v58 row_ror:8 row_mask:0xf bank_mask:0xf
    v_add_f32_dpp v59, v59, v59 row_ror:8 row_mask:0xf bank_mask:0xf
    v_add_f32_dpp v60, v60, v60 row_ror:8 row_mask:0xf bank_mask:0xf
    v_add_f32_dpp v61, v61, v61 row_ror:8 row_mask:0xf bank_mask:0xf
    v_add_f32_dpp v62, v62, v62 row_ror:8 row_mask:0xf bank_mask:0xf
    v_add_f32_dpp v63, v63, v63 row_ror:8 row_mask:0xf bank_mask:0xf
    v_lshrrev_b32 v3, 4, v2
    v_lshlrev_b32 v3, 7, v3
    v_and_b32 v4, 3, v1
    v_lshl_add_u32 v3, v4, 5, v3
    v_add_u32 v3, 86016, v3
    ds_write_b128 v3, v[56:59]
    ds_write_b128 v3, v[60:63] offset:16
    v_and_b32 v4, 31, v1
    v_lshrrev_b32 v3, 5, v1
    v_lshlrev_b32 v3, 10, v3
    v_lshl_add_u32 v3, v4, 2, v3
    v_add_u32 v3, 86016, v3
    s_lshl_b32 s60, s60, 8
    s_lshl_b32 s61, s61, 14
    s_add_u32 s60, s60, s61
    v_lshlrev_b32 v4, 3, v4
    v_mov_b32 v6, 1
    s_waitcnt lgkmcnt(0)
    s_mul_i32 s3, s3, 0x9e3779b1
    s_add_u32 s3, s3, 0x7f4a7c15
    s_mov_b64 exec, 1
    ds_add_rtn_u32 v6, v5, v6
    s_mov_b64 exec, -1
    s_waitcnt lgkmcnt(0)
    v_readfirstlane_b32 s59, v6
    s_nop 0
    s_cmp_lg_u32 s59, 3
    s_cbranch_scc1 ph0_nl
    ds_read_b32 v8, v3 offset:0
    ds_read_b32 v9, v3 offset:128
    ds_read_b32 v10, v3 offset:256
    ds_read_b32 v11, v3 offset:384
    ds_read_b32 v12, v3 offset:512
    ds_read_b32 v13, v3 offset:640
    ds_read_b32 v14, v3 offset:768
    ds_read_b32 v15, v3 offset:896
    v_mov_b32 v17, s3
    s_waitcnt lgkmcnt(0)
    v_add_f32 v8, v8, v12
    v_add_f32 v9, v9, v13
    v_add_f32 v10, v10, v14
    v_add_f32 v11, v11, v15
    v_add_f32 v8, v8, v10
    v_add_f32 v9, v9, v11
    v_add_f32 v16, v8, v9
    v_add_f32 v10, v8, v9
    s_nop 1
    v_permlane32_swap_b32 v16, v10
    v_add_f32 v16, v16, v10
    s_mov_b64 exec, 0xffffffff
    buffer_store_dwordx2 v[16:17], v4, s[16:19], s60 offen sc1
    s_mov_b64 exec, -1
ph0_nl:
    s_lshr_b32 s62, s2, 3
    s_cmp_eq_u32 s42, 7
    s_cselect_b32 s62, s62, 8
    s_min_u32 s62, s62, 8
    s_getpc_b64 s[64:65]
ph0_cpc:
    s_add_u32 s64, s64, ph0_done-ph0_cpc
    s_addc_u32 s65, s65, 0
    s_lshl_b32 s66, s62, 13
    v_lshl_add_u32 v250, v1, 7, s66
    v_min_u32 v250, code_end-ph0_done-4, v250
    global_load_dword v251, v250, s[64:65]
    s_add_u32 s16, s6, 131072
    s_addc_u32 s17, s7, 0
    s_mov_b32 s18, 720896
    s_mov_b32 s19, 0x20000
    s_lshl_b32 s62, s2, 9
    s_lshl_b32 s63, s2, 11
    s_add_u32 s63, s63, 393216
    s_cmp_eq_u32 s42, 4
    s_cselect_b32 s62, s62, s63
    s_cselect_b32 s63, 3, 15
    s_cmp_gt_u32 s42, 5
    s_cselect_b32 s62, 0x7000000, s62
    v_min_u32 v249, s63, v1
    v_lshlrev_b32 v249, 7, v249
    buffer_load_dword v251, v249, s[16:19], s62 offen
    s_lshl_b32 s62, s2, 8
    s_add_u32 s63, s62, 0
    s_load_dword s59, s[32:33], s63
    s_add_u32 s63, s62, 64
    s_load_dword s59, s[32:33], s63
    s_add_u32 s63, s62, 128
    s_load_dword s59, s[32:33], s63
    s_add_u32 s63, s62, 192
    s_load_dword s59, s[32:33], s63
    s_and_b32 s62, s2, 31
    s_lshl_b32 s62, s62, 6
    s_load_dword s59, s[30:31], s62
    s_min_u32 s62, s2, 111
    s_lshl_b32 s62, s62, 6
    s_load_dword s59, s[34:35], s62
    s_barrier
ph0_done:
    s_sub_u32 s54, s42, 4
    s_getpc_b64 s[66:67]
qkv_pc:
    s_add_u32 s66, s66, qkv_tab-qkv_pc
    s_addc_u32 s67, s67, 0
    s_lshl_b32 s55, s39, 6
    v_add_u32 v2, s55, v1
    global_load_ubyte v3, v2, s[66:67]
    s_mul_i32 s55, s40, 8
    s_mul_i32 s56, s54, 2
    s_add_u32 s55, s55, s56
    s_mul_i32 s55, s55, 32768
    v_lshl_add_u32 v5, v1, 4, s55
    s_mul_i32 s48, s54, 4096
    v_add_u32 v6, 30720, v5
    v_lshrrev_b32 v7, 3, v1
    v_and_b32 v10, 7, v1
    v_and_b32 v8, 2, v7
    v_xor_b32 v9, v10, v8
    v_mul_u32_u24 v8, 6144, v7
    s_mul_i32 s55, s54, 98304
    s_add_u32 s56, s55, s43
    v_add_u32 v8, s56, v8
    v_xor_b32 v11, 4, v9
    v_lshl_add_u32 v11, v11, 4, v8
    v_lshl_add_u32 v9, v9, 4, v8
    s_mul_i32 s49, s54, 2048
    s_add_u32 s49, s49, 16384
    v_add_u32 v12, 48128, v11
    v_add_u32 v13, 2048, v9
    v_add_u32 v14, 50176, v11
    v_add_u32 v15, 4096, v9
    v_add_u32 v16, 52224, v11
    s_mul_i32 s45, s39, 2048
    s_mul_i32 s46, s39, 393216
    s_mov_b32 s52, 1
    s_waitcnt lgkmcnt(0)
    s_add_u32 s8, s6, 8388608
    s_addc_u32 s9, s7, 0
    s_mov_b32 s10, 4194304
    s_mov_b32 s11, 0x20000
    s_mov_b32 s12, s4
    s_mov_b32 s13, s5
    s_mov_b32 s14, 6291456
    s_mov_b32 s15, 0x20000
    s_barrier
    s_add_u32 s84, s6, 524288
    s_addc_u32 s85, s7, 0
    s_mov_b32 s86, 327680
    s_mov_b32 s87, 0x20000
    s_lshl_b32 s88, s40, 11
    s_add_u32 s88, s88, 32768
    s_lshl_b32 s89, s40, 11
    s_add_u32 s89, s89, 32768
    s_lshl_b32 s90, s41, 7
    s_add_u32 s88, s88, s90
    v_lshlrev_b32 v252, 7, v1
    v_mov_b32 v253, s3
    s_mov_b32 s90, 200000
    s_barrier
    s_cmp_lg_u32 s42, 4
    s_cbranch_scc1 f1_s5
    s_mov_b64 exec, 1
    buffer_store_dword v253, v252, s[84:87], s88 offen sc1
    s_mov_b64 exec, -1
f1_s5:
    s_add_u32 m0, s49, 0
    s_nop 0
    buffer_load_dwordx4 v9, s[12:15], s46 offen lds
    buffer_load_dwordx4 v12, s[12:15], s46 offen offset:1024 lds
    s_add_u32 m0, s49, 8192
    s_nop 0
    buffer_load_dwordx4 v13, s[12:15], s46 offen lds
    buffer_load_dwordx4 v14, s[12:15], s46 offen offset:1024 lds
    s_add_u32 m0, s49, 16384
    s_nop 0
    buffer_load_dwordx4 v15, s[12:15], s46 offen lds
    buffer_load_dwordx4 v16, s[12:15], s46 offen offset:1024 lds
    s_waitcnt vmcnt(6)
    v_mul_u32_u24 v4, 393216, v3
    v_mul_u32_u24 v3, 2048, v3
    v_readlane_b32 s46, v4, 1
    s_mov_b32 s52, 2
    s_add_u32 m0, s49, 40960
    s_nop 2
    buffer_load_dwordx4 v9, s[12:15], s46 offen lds
    buffer_load_dwordx4 v12, s[12:15], s46 offen offset:1024 lds
    s_add_u32 m0, s49, 49152
    s_nop 0
    buffer_load_dwordx4 v13, s[12:15], s46 offen lds
    buffer_load_dwordx4 v14, s[12:15], s46 offen offset:1024 lds
    s_add_u32 m0, s49, 57344
    s_nop 0
    buffer_load_dwordx4 v15, s[12:15], s46 offen lds
    buffer_load_dwordx4 v16, s[12:15], s46 offen offset:1024 lds
    v_readlane_b32 s37, v3, 1
    s_lshr_b32 s36, s45, 11
    s_lshr_b32 s37, s37, 11
    s_cmp_lg_u32 s42, 5
    s_cbranch_scc1 f1_sx
    s_mov_b64 exec, 0xffff
    buffer_load_dword v253, v252, s[84:87], s89 offen sc1
f1_sp:
    buffer_load_dword v254, v252, s[84:87], s89 offen sc1
    s_sub_u32 s90, s90, 1
    s_waitcnt vmcnt(1)
    v_cmp_ne_u32 vcc, s3, v253
    s_nop 0
    s_cmp_eq_u64 vcc, 0
    s_cbranch_scc1 f1_sy
    buffer_load_dword v253, v252, s[84:87], s89 offen sc1
    s_waitcnt vmcnt(1)
    v_cmp_ne_u32 vcc, s3, v254
    s_nop 0
    s_cmp_eq_u64 vcc, 0
    s_cbranch_scc1 f1_sy
    s_cmp_lg_u32 s90, 0
    s_cbranch_scc1 f1_sp
f1_sy:
    s_mov_b64 exec, -1
f1_sx:
    s_barrier
    s_add_u32 m0, s48, 0
    s_nop 0
    buffer_load_dwordx4 v5, s[8:11], s45 offen sc1 lds
    buffer_load_dwordx4 v5, s[8:11], s45 offen offset:1024 sc1 lds
    buffer_load_dwordx4 v6, s[8:11], s45 offen offset:2048 sc1 lds
    buffer_load_dwordx4 v6, s[8:11], s45 offen offset:3072 sc1 lds
    s_mov_b32 s16, s32
    s_mov_b32 s17, s33
    s_mov_b32 s18, 65536
    s_mov_b32 s19, 0x20000
    v_lshrrev_b32 v17, 3, v1
    v_and_b32 v17, 2, v17
    v_xor_b32 v17, v1, v17
    v_lshlrev_b32 v17, 4, v17
    s_sub_u32 s59, s42, 4
    s_lshl_b32 s59, s59, 10
    s_add_u32 m0, s59, 122880
    s_lshl_b32 s61, s41, 12
    s_add_u32 s59, s59, s61
    buffer_load_dwordx4 v17, s[16:19], s59 offen lds
    v_readlane_b32 s45, v3, 1
    s_add_u32 m0, s48, 40960
    s_nop 3
    buffer_load_dwordx4 v5, s[8:11], s45 offen sc1 lds
    buffer_load_dwordx4 v5, s[8:11], s45 offen offset:1024 sc1 lds
    buffer_load_dwordx4 v6, s[8:11], s45 offen offset:2048 sc1 lds
    buffer_load_dwordx4 v6, s[8:11], s45 offen offset:3072 sc1 lds
    s_waitcnt vmcnt(5)
    s_barrier
    v_readlane_b32 s45, v3, s52
    v_readlane_b32 s46, v4, s52
    s_add_u32 s52, s52, 1
    s_add_u32 m0, s48, 81920
    s_nop 1
    buffer_load_dwordx4 v5, s[8:11], s45 offen sc1 lds
    buffer_load_dwordx4 v5, s[8:11], s45 offen offset:1024 sc1 lds
    buffer_load_dwordx4 v6, s[8:11], s45 offen offset:2048 sc1 lds
    buffer_load_dwordx4 v6, s[8:11], s45 offen offset:3072 sc1 lds
    s_add_u32 m0, s49, 81920
    s_nop 0
    buffer_load_dwordx4 v9, s[12:15], s46 offen lds
    buffer_load_dwordx4 v12, s[12:15], s46 offen offset:1024 lds
    s_add_u32 m0, s49, 90112
    s_nop 0
    buffer_load_dwordx4 v13, s[12:15], s46 offen lds
    buffer_load_dwordx4 v14, s[12:15], s46 offen offset:1024 lds
    s_add_u32 m0, s49, 98304
    s_nop 0
    buffer_load_dwordx4 v15, s[12:15], s46 offen lds
    buffer_load_dwordx4 v16, s[12:15], s46 offen offset:1024 lds
    v_readlane_b32 s45, v3, s52
    v_readlane_b32 s46, v4, s52
    s_add_u32 s52, s52, 1
    s_mov_b32 s47, 0
    s_waitcnt vmcnt(10)
    s_barrier
    s_add_u32 m0, s48, 0
    s_nop 0
    buffer_load_dwordx4 v5, s[8:11], s45 offen sc1 lds
    buffer_load_dwordx4 v5, s[8:11], s45 offen offset:1024 sc1 lds
    buffer_load_dwordx4 v6, s[8:11], s45 offen offset:2048 sc1 lds
    buffer_load_dwordx4 v6, s[8:11], s45 offen offset:3072 sc1 lds
    s_add_u32 m0, s49, 0
    s_nop 0
    buffer_load_dwordx4 v9, s[12:15], s46 offen lds
    buffer_load_dwordx4 v12, s[12:15], s46 offen offset:1024 lds
    s_add_u32 m0, s49, 8192
    s_nop 0
    buffer_load_dwordx4 v13, s[12:15], s46 offen lds
    buffer_load_dwordx4 v14, s[12:15], s46 offen offset:1024 lds
    s_add_u32 m0, s49, 16384
    s_nop 0
    buffer_load_dwordx4 v15, s[12:15], s46 offen lds
    buffer_load_dwordx4 v16, s[12:15], s46 offen offset:1024 lds
    v_readlane_b32 s45, v3, s52
    v_readlane_b32 s46, v4, s52
    s_add_u32 s52, s52, 1
    s_waitcnt vmcnt(10)
    s_barrier
    s_add_u32 m0, s48, 40960
    s_nop 0
    buffer_load_dwordx4 v5, s[8:11], s45 offen sc1 lds
    buffer_load_dwordx4 v5, s[8:11], s45 offen offset:1024 sc1 lds
    buffer_load_dwordx4 v6, s[8:11], s45 offen offset:2048 sc1 lds
    buffer_load_dwordx4 v6, s[8:11], s45 offen offset:3072 sc1 lds
    s_add_u32 m0, s49, 40960
    s_nop 0
    buffer_load_dwordx4 v9, s[12:15], s46 offen lds
    buffer_load_dwordx4 v12, s[12:15], s46 offen offset:1024 lds
    s_add_u32 m0, s49, 49152
    s_nop 0
    buffer_load_dwordx4 v13, s[12:15], s46 offen lds
    buffer_load_dwordx4 v14, s[12:15], s46 offen offset:1024 lds
    s_add_u32 m0, s49, 57344
    s_nop 0
    buffer_load_dwordx4 v15, s[12:15], s46 offen lds
    buffer_load_dwordx4 v16, s[12:15], s46 offen offset:1024 lds
    v_readlane_b32 s45, v3, s52
    v_readlane_b32 s46, v4, s52
    s_add_u32 s52, s52, 1
    s_waitcnt vmcnt(10)
    s_barrier
    s_add_u32 m0, s48, 81920
    s_nop 0
    buffer_load_dwordx4 v5, s[8:11], s45 offen sc1 lds
    buffer_load_dwordx4 v5, s[8:11], s45 offen offset:1024 sc1 lds
    buffer_load_dwordx4 v6, s[8:11], s45 offen offset:2048 sc1 lds
    buffer_load_dwordx4 v6, s[8:11], s45 offen offset:3072 sc1 lds
    s_add_u32 m0, s49, 81920
    s_nop 0
    buffer_load_dwordx4 v9, s[12:15], s46 offen lds
    buffer_load_dwordx4 v12, s[12:15], s46 offen offset:1024 lds
    s_add_u32 m0, s49, 90112
    s_nop 0
    buffer_load_dwordx4 v13, s[12:15], s46 offen lds
    buffer_load_dwordx4 v14, s[12:15], s46 offen offset:1024 lds
    s_add_u32 m0, s49, 98304
    s_nop 0
    buffer_load_dwordx4 v15, s[12:15], s46 offen lds
    buffer_load_dwordx4 v16, s[12:15], s46 offen offset:1024 lds
    v_readlane_b32 s45, v3, s52
    v_readlane_b32 s46, v4, s52
    s_add_u32 s52, s52, 1
    s_waitcnt vmcnt(10)
    s_barrier
    s_add_u32 m0, s48, 0
    s_nop 0
    buffer_load_dwordx4 v5, s[8:11], s45 offen sc1 lds
    buffer_load_dwordx4 v5, s[8:11], s45 offen offset:1024 sc1 lds
    buffer_load_dwordx4 v6, s[8:11], s45 offen offset:2048 sc1 lds
    buffer_load_dwordx4 v6, s[8:11], s45 offen offset:3072 sc1 lds
    s_add_u32 m0, s49, 0
    s_nop 0
    buffer_load_dwordx4 v9, s[12:15], s46 offen lds
    buffer_load_dwordx4 v12, s[12:15], s46 offen offset:1024 lds
    s_add_u32 m0, s49, 8192
    s_nop 0
    buffer_load_dwordx4 v13, s[12:15], s46 offen lds
    buffer_load_dwordx4 v14, s[12:15], s46 offen offset:1024 lds
    s_add_u32 m0, s49, 16384
    s_nop 0
    buffer_load_dwordx4 v15, s[12:15], s46 offen lds
    buffer_load_dwordx4 v16, s[12:15], s46 offen offset:1024 lds
    v_readlane_b32 s45, v3, s52
    v_readlane_b32 s46, v4, s52
    s_add_u32 s52, s52, 1
    s_waitcnt vmcnt(10)
    s_barrier
    s_add_u32 m0, s48, 40960
    s_nop 0
    buffer_load_dwordx4 v5, s[8:11], s45 offen sc1 lds
    buffer_load_dwordx4 v5, s[8:11], s45 offen offset:1024 sc1 lds
    buffer_load_dwordx4 v6, s[8:11], s45 offen offset:2048 sc1 lds
    buffer_load_dwordx4 v6, s[8:11], s45 offen offset:3072 sc1 lds
    s_add_u32 m0, s49, 40960
    s_nop 0
    buffer_load_dwordx4 v9, s[12:15], s46 offen lds
    buffer_load_dwordx4 v12, s[12:15], s46 offen offset:1024 lds
    s_add_u32 m0, s49, 49152
    s_nop 0
    buffer_load_dwordx4 v13, s[12:15], s46 offen lds
    buffer_load_dwordx4 v14, s[12:15], s46 offen offset:1024 lds
    s_add_u32 m0, s49, 57344
    s_nop 0
    buffer_load_dwordx4 v15, s[12:15], s46 offen lds
    buffer_load_dwordx4 v16, s[12:15], s46 offen offset:1024 lds
    v_readlane_b32 s45, v3, s52
    v_readlane_b32 s46, v4, s52
    s_add_u32 s52, s52, 1
    s_waitcnt vmcnt(10)
    s_barrier
    s_add_u32 m0, s48, 81920
    s_nop 0
    buffer_load_dwordx4 v5, s[8:11], s45 offen sc1 lds
    buffer_load_dwordx4 v5, s[8:11], s45 offen offset:1024 sc1 lds
    buffer_load_dwordx4 v6, s[8:11], s45 offen offset:2048 sc1 lds
    buffer_load_dwordx4 v6, s[8:11], s45 offen offset:3072 sc1 lds
    s_add_u32 m0, s49, 81920
    s_nop 0
    buffer_load_dwordx4 v9, s[12:15], s46 offen lds
    buffer_load_dwordx4 v12, s[12:15], s46 offen offset:1024 lds
    s_add_u32 m0, s49, 90112
    s_nop 0
    buffer_load_dwordx4 v13, s[12:15], s46 offen lds
    buffer_load_dwordx4 v14, s[12:15], s46 offen offset:1024 lds
    s_add_u32 m0, s49, 98304
    s_nop 0
    buffer_load_dwordx4 v15, s[12:15], s46 offen lds
    buffer_load_dwordx4 v16, s[12:15], s46 offen offset:1024 lds
    v_readlane_b32 s45, v3, s52
    v_readlane_b32 s46, v4, s52
    s_add_u32 s52, s52, 1
    s_waitcnt vmcnt(10)
    s_barrier
    s_add_u32 m0, s48, 0
    s_nop 0
    buffer_load_dwordx4 v5, s[8:11], s45 offen sc1 lds
    buffer_load_dwordx4 v5, s[8:11], s45 offen offset:1024 sc1 lds
    buffer_load_dwordx4 v6, s[8:11], s45 offen offset:2048 sc1 lds
    buffer_load_dwordx4 v6, s[8:11], s45 offen offset:3072 sc1 lds
    s_add_u32 m0, s49, 0
    s_nop 0
    buffer_load_dwordx4 v9, s[12:15], s46 offen lds
    buffer_load_dwordx4 v12, s[12:15], s46 offen offset:1024 lds
    s_add_u32 m0, s49, 8192
    s_nop 0
    buffer_load_dwordx4 v13, s[12:15], s46 offen lds
    buffer_load_dwordx4 v14, s[12:15], s46 offen offset:1024 lds
    s_add_u32 m0, s49, 16384
    s_nop 0
    buffer_load_dwordx4 v15, s[12:15], s46 offen lds
    buffer_load_dwordx4 v16, s[12:15], s46 offen offset:1024 lds
    v_readlane_b32 s45, v3, s52
    v_readlane_b32 s46, v4, s52
    s_add_u32 s52, s52, 1
    s_waitcnt vmcnt(10)
    s_barrier
    s_add_u32 m0, s48, 40960
    s_nop 0
    buffer_load_dwordx4 v5, s[8:11], s45 offen sc1 lds
    buffer_load_dwordx4 v5, s[8:11], s45 offen offset:1024 sc1 lds
    buffer_load_dwordx4 v6, s[8:11], s45 offen offset:2048 sc1 lds
    buffer_load_dwordx4 v6, s[8:11], s45 offen offset:3072 sc1 lds
    s_add_u32 m0, s49, 40960
    s_nop 0
    buffer_load_dwordx4 v9, s[12:15], s46 offen lds
    buffer_load_dwordx4 v12, s[12:15], s46 offen offset:1024 lds
    s_add_u32 m0, s49, 49152
    s_nop 0
    buffer_load_dwordx4 v13, s[12:15], s46 offen lds
    buffer_load_dwordx4 v14, s[12:15], s46 offen offset:1024 lds
    s_add_u32 m0, s49, 57344
    s_nop 0
    buffer_load_dwordx4 v15, s[12:15], s46 offen lds
    buffer_load_dwordx4 v16, s[12:15], s46 offen offset:1024 lds
    v_readlane_b32 s45, v3, s52
    v_readlane_b32 s46, v4, s52
    s_add_u32 s52, s52, 1
    s_waitcnt vmcnt(10)
    s_barrier
    s_add_u32 m0, s48, 81920
    s_nop 0
    buffer_load_dwordx4 v5, s[8:11], s45 offen sc1 lds
    buffer_load_dwordx4 v5, s[8:11], s45 offen offset:1024 sc1 lds
    buffer_load_dwordx4 v6, s[8:11], s45 offen offset:2048 sc1 lds
    buffer_load_dwordx4 v6, s[8:11], s45 offen offset:3072 sc1 lds
    s_add_u32 m0, s49, 81920
    s_nop 0
    buffer_load_dwordx4 v9, s[12:15], s46 offen lds
    buffer_load_dwordx4 v12, s[12:15], s46 offen offset:1024 lds
    s_add_u32 m0, s49, 90112
    s_nop 0
    buffer_load_dwordx4 v13, s[12:15], s46 offen lds
    buffer_load_dwordx4 v14, s[12:15], s46 offen offset:1024 lds
    s_add_u32 m0, s49, 98304
    s_nop 0
    buffer_load_dwordx4 v15, s[12:15], s46 offen lds
    buffer_load_dwordx4 v16, s[12:15], s46 offen offset:1024 lds
    v_readlane_b32 s45, v3, s52
    v_readlane_b32 s46, v4, s52
    s_add_u32 s52, s52, 1
    s_waitcnt vmcnt(10)
    s_barrier
    s_add_u32 m0, s48, 0
    s_nop 0
    buffer_load_dwordx4 v5, s[8:11], s45 offen sc1 lds
    buffer_load_dwordx4 v5, s[8:11], s45 offen offset:1024 sc1 lds
    buffer_load_dwordx4 v6, s[8:11], s45 offen offset:2048 sc1 lds
    buffer_load_dwordx4 v6, s[8:11], s45 offen offset:3072 sc1 lds
    s_add_u32 m0, s49, 0
    s_nop 0
    buffer_load_dwordx4 v9, s[12:15], s46 offen lds
    buffer_load_dwordx4 v12, s[12:15], s46 offen offset:1024 lds
    s_add_u32 m0, s49, 8192
    s_nop 0
    buffer_load_dwordx4 v13, s[12:15], s46 offen lds
    buffer_load_dwordx4 v14, s[12:15], s46 offen offset:1024 lds
    s_add_u32 m0, s49, 16384
    s_nop 0
    buffer_load_dwordx4 v15, s[12:15], s46 offen lds
    buffer_load_dwordx4 v16, s[12:15], s46 offen offset:1024 lds
    v_readlane_b32 s45, v3, s52
    v_readlane_b32 s46, v4, s52
    s_add_u32 s52, s52, 1
    s_waitcnt vmcnt(10)
    s_barrier
    s_add_u32 m0, s48, 40960
    s_nop 0
    buffer_load_dwordx4 v5, s[8:11], s45 offen sc1 lds
    buffer_load_dwordx4 v5, s[8:11], s45 offen offset:1024 sc1 lds
    buffer_load_dwordx4 v6, s[8:11], s45 offen offset:2048 sc1 lds
    buffer_load_dwordx4 v6, s[8:11], s45 offen offset:3072 sc1 lds
    s_add_u32 m0, s49, 40960
    s_nop 0
    buffer_load_dwordx4 v9, s[12:15], s46 offen lds
    buffer_load_dwordx4 v12, s[12:15], s46 offen offset:1024 lds
    s_add_u32 m0, s49, 49152
    s_nop 0
    buffer_load_dwordx4 v13, s[12:15], s46 offen lds
    buffer_load_dwordx4 v14, s[12:15], s46 offen offset:1024 lds
    s_add_u32 m0, s49, 57344
    s_nop 0
    buffer_load_dwordx4 v15, s[12:15], s46 offen lds
    buffer_load_dwordx4 v16, s[12:15], s46 offen offset:1024 lds
    v_readlane_b32 s45, v3, s52
    v_readlane_b32 s46, v4, s52
    s_add_u32 s52, s52, 1
    s_waitcnt vmcnt(10)
    s_barrier
    s_add_u32 m0, s48, 81920
    s_nop 0
    buffer_load_dwordx4 v5, s[8:11], s45 offen sc1 lds
    buffer_load_dwordx4 v5, s[8:11], s45 offen offset:1024 sc1 lds
    buffer_load_dwordx4 v6, s[8:11], s45 offen offset:2048 sc1 lds
    buffer_load_dwordx4 v6, s[8:11], s45 offen offset:3072 sc1 lds
    s_add_u32 m0, s49, 81920
    s_nop 0
    buffer_load_dwordx4 v9, s[12:15], s46 offen lds
    buffer_load_dwordx4 v12, s[12:15], s46 offen offset:1024 lds
    s_add_u32 m0, s49, 90112
    s_nop 0
    buffer_load_dwordx4 v13, s[12:15], s46 offen lds
    buffer_load_dwordx4 v14, s[12:15], s46 offen offset:1024 lds
    s_add_u32 m0, s49, 98304
    s_nop 0
    buffer_load_dwordx4 v15, s[12:15], s46 offen lds
    buffer_load_dwordx4 v16, s[12:15], s46 offen offset:1024 lds
    v_readlane_b32 s45, v3, s52
    v_readlane_b32 s46, v4, s52
    s_add_u32 s52, s52, 1
    s_waitcnt vmcnt(10)
    s_barrier
    s_add_u32 m0, s48, 0
    s_nop 0
    buffer_load_dwordx4 v5, s[8:11], s45 offen sc1 lds
    buffer_load_dwordx4 v5, s[8:11], s45 offen offset:1024 sc1 lds
    buffer_load_dwordx4 v6, s[8:11], s45 offen offset:2048 sc1 lds
    buffer_load_dwordx4 v6, s[8:11], s45 offen offset:3072 sc1 lds
    s_add_u32 m0, s49, 0
    s_nop 0
    buffer_load_dwordx4 v9, s[12:15], s46 offen lds
    buffer_load_dwordx4 v12, s[12:15], s46 offen offset:1024 lds
    s_add_u32 m0, s49, 8192
    s_nop 0
    buffer_load_dwordx4 v13, s[12:15], s46 offen lds
    buffer_load_dwordx4 v14, s[12:15], s46 offen offset:1024 lds
    s_add_u32 m0, s49, 16384
    s_nop 0
    buffer_load_dwordx4 v15, s[12:15], s46 offen lds
    buffer_load_dwordx4 v16, s[12:15], s46 offen offset:1024 lds
    s_waitcnt vmcnt(10)
    s_barrier
    s_mov_b32 s20, s74
    s_mov_b32 s21, s75
    s_mov_b32 s22, 2048
    s_mov_b32 s23, 0x20000
    s_mov_b32 s24, s76
    s_mov_b32 s25, s77
    s_mov_b32 s26, 12582912
    s_mov_b32 s27, 0x20000
    s_lshr_b32 s61, s2, 6
    s_lshl_b32 s62, s61, 9
    s_mul_i32 s63, s61, 3145728
    s_and_b32 s64, s2, 63
    s_lshl_b32 s65, s64, 7
    s_add_u32 s63, s63, s65
    s_add_u32 s63, s63, 4096
    v_and_b32 v58, 255, v0
    s_mov_b32 s16, s34
    s_mov_b32 s17, s35
    s_mov_b32 s18, 7168
    s_mov_b32 s19, 0x20000
    s_min_u32 s59, s2, 64
    s_mul_i32 s59, s59, 448
    v_lshlrev_b32 v249, 1, v58
    buffer_load_ushort v248, v249, s[16:19], s59 offen
    v_lshrrev_b32 v56, 3, v58
    v_lshlrev_b32 v57, 4, v56
    v_mul_u32_u24 v56, 98304, v56
    buffer_load_dwordx4 v[20:23], v57, s[20:23], s62 offen
    v_and_b32 v57, 7, v58
    v_lshl_add_u32 v56, v57, 4, v56
    buffer_load_dwordx4 v[24:27], v56, s[24:27], s63 offen nt
    s_add_u32 s63, s63, 12288
    buffer_load_dwordx4 v[28:31], v56, s[24:27], s63 offen nt
    s_add_u32 s63, s63, 12288
    buffer_load_dwordx4 v[32:35], v56, s[24:27], s63 offen nt
    s_add_u32 s63, s63, 12288
    buffer_load_dwordx4 v[36:39], v56, s[24:27], s63 offen nt
    s_add_u32 s63, s63, 12288
    buffer_load_dwordx4 v[40:43], v56, s[24:27], s63 offen nt
    s_add_u32 s63, s63, 12288
    buffer_load_dwordx4 v[44:47], v56, s[24:27], s63 offen nt
    s_add_u32 s63, s63, 12288
    buffer_load_dwordx4 v[48:51], v56, s[24:27], s63 offen nt
    s_add_u32 s63, s63, 12288
    buffer_load_dwordx4 v[52:55], v56, s[24:27], s63 offen nt
    s_mov_b32 s28, s78
    s_mov_b32 s29, s79
    s_mov_b32 s30, 2097152
    s_mov_b32 s31, 0x20000
    v_lshlrev_b32 v59, 11, v7
    v_lshl_add_u32 v59, v10, 7, v59
    s_lshr_b32 s62, s2, 3
    s_lshl_b32 s62, s62, 2
    s_add_u32 s62, s62, s42
    s_sub_u32 s62, s62, 4
    s_lshl_b32 s62, s62, 14
    s_bfe_u32 s63, s2, 0x10002
    s_lshl_b32 s63, s63, 10
    s_add_u32 s62, s62, s63
    buffer_load_dword v251, v59, s[28:31], s62 offen
    s_load_dwordx2 s[30:31], s[0:1], 40
    v_lshrrev_b32 v59, 4, v1
    v_mul_u32_u24 v59, 7168, v59
    v_and_b32 v250, 15, v1
    v_min_u32 v250, 13, v250
    v_lshl_add_u32 v59, v250, 7, v59
    s_lshr_b32 s62, s2, 3
    s_mul_i32 s62, s62, 10
    s_sub_u32 s63, s42, 4
    s_lshl_b32 s63, s63, 2
    s_add_u32 s62, s62, s63
    s_and_b32 s63, s2, 1
    s_lshl_b32 s63, s63, 9
    s_add_u32 s62, s62, s63
    s_mul_i32 s62, s62, 7168
    s_bfe_u32 s63, s2, 0x20001
    s_mul_i32 s63, s63, 1792
    s_add_u32 s62, s62, s63
    s_waitcnt lgkmcnt(0)
    s_mov_b32 s28, s30
    s_mov_b32 s29, s31
    s_mov_b32 s30, 7340032
    s_mov_b32 s31, 0x20000
    buffer_load_dword v251, v59, s[28:31], s62 offen
    s_waitcnt vmcnt(12)
    s_barrier
    s_add_u32 s16, s6, 950272
    s_addc_u32 s17, s7, 0
    s_mov_b32 s18, 32768
    s_mov_b32 s19, 0x20000
    s_min_u32 s59, s2, 64
    s_lshl_b32 s59, s59, 11
    v_lshlrev_b32 v249, 1, v249
    v_mov_b32 v247, 0
    s_waitcnt vmcnt(11)
    v_lshlrev_b32 v248, 16, v248
    buffer_store_dword v247, v249, s[16:19], s59 offen sc1
    buffer_store_dword v248, v249, s[16:19], s59 offen offset:1024 sc1
    s_add_u32 s24, s6, 65536
    s_addc_u32 s25, s7, 0
    s_mov_b32 s26, 65536
    s_mov_b32 s27, 0x20000
    s_mov_b32 s60, 0x3fb8aa3b
    s_and_b32 s53, s42, 1
    v_lshrrev_b32 v2, 2, v1
    v_lshlrev_b32 v2, 6, v2
    v_bfe_u32 v3, v1, 4, 1
    v_lshl_add_u32 v2, v3, 5, v2
    v_and_b32 v3, 3, v1
    v_lshl_add_u32 v2, v3, 3, v2
    s_lshl_b32 s59, s53, 11
    s_add_u32 s59, s59, 122880
    v_add_u32 v2, s59, v2
    v_xor_b32 v3, 32, v2
    ds_read_b64_tr_b16 v[116:117], v2 offset:0
    ds_read_b64_tr_b16 v[118:119], v2 offset:1024
    ds_read_b64_tr_b16 v[120:121], v3 offset:0
    ds_read_b64_tr_b16 v[122:123], v3 offset:1024
    s_lshl_b32 s59, s41, 1
    s_add_u32 s58, s59, s53
    s_lshl_b32 s61, s61, 14
    s_lshl_b32 s64, s64, 8
    s_add_u32 s64, s64, s61
    s_sub_u32 s61, s42, 4
    s_lshl_b32 s62, s61, 12
    s_add_u32 s62, s62, 90112
    v_lshl_add_u32 v4, v1, 4, s62
    s_sub_u32 s62, s42, 4
    v_and_b32 v2, 15, v1
    v_lshrrev_b32 v3, 4, v1
    v_lshrrev_b32 v6, 1, v2
    v_and_b32 v6, 3, v6
    v_lshlrev_b32 v6, 2, v6
    v_and_b32 v5, 1, v2
    v_or_b32 v6, v6, v5
    v_lshrrev_b32 v5, 2, v2
    v_and_b32 v5, 2, v5
    v_or_b32 v6, v6, v5
    v_xor_b32 v6, v6, v3
    v_lshlrev_b32 v2, 7, v2
    s_lshl_b32 s61, s62, 13
    s_add_u32 s61, s61, 40960
    v_add_u32 v2, s61, v2
    v_xor_b32 v5, 0, v6
    v_lshl_add_u32 v76, v5, 3, v2
    v_xor_b32 v5, 4, v6
    v_lshl_add_u32 v77, v5, 3, v2
    v_xor_b32 v5, 8, v6
    v_lshl_add_u32 v78, v5, 3, v2
    v_xor_b32 v5, 12, v6
    v_lshl_add_u32 v79, v5, 3, v2
    s_barrier
    ds_read_b128 v[60:63], v4 offset:0
    ds_read_b128 v[64:67], v4 offset:1024
    ds_read_b128 v[68:71], v4 offset:2048
    ds_read_b128 v[72:75], v4 offset:3072
    s_waitcnt lgkmcnt(2)
    v_mfma_f32_16x16x32_bf16 v[80:83], v[116:119], v[60:63], 0
    v_mfma_f32_16x16x32_bf16 v[84:87], v[120:123], v[60:63], 0
    v_mfma_f32_16x16x32_bf16 v[88:91], v[116:119], v[64:67], 0
    v_mfma_f32_16x16x32_bf16 v[92:95], v[120:123], v[64:67], 0
    s_nop 4
    v_max3_f32 v112, v80, v81, v82
    s_nop 0
    v_max3_f32 v113, v88, v89, v90
    v_max3_f32 v114, -v80, -v81, -v82
    v_max3_f32 v115, -v88, -v89, -v90
    v_max3_f32 v112, v112, v83, v84
    v_max3_f32 v113, v113, v91, v92
    v_max3_f32 v114, v114, -v83, -v84
    v_max3_f32 v115, v115, -v91, -v92
    v_max3_f32 v112, v112, v85, v86
    v_max3_f32 v113, v113, v93, v94
    v_max3_f32 v114, v114, -v85, -v86
    v_max3_f32 v115, v115, -v93, -v94
    v_max_f32 v112, v87, v112
    v_max_f32 v113, v95, v113
    v_max_f32 v114, -v87, v114
    v_max_f32 v115, -v95, v115
    v_permlane32_swap_b32 v112, v113
    s_nop 0
    v_permlane32_swap_b32 v114, v115
    v_max_f32 v112, v112, v113
    v_max_f32 v114, v114, v115
    s_nop 1
    v_permlane16_swap_b32 v112, v114
    v_max_f32 v112, v112, v114
    v_mov_b32 v114, v112
    s_nop 1
    v_permlane16_swap_b32 v112, v114
    v_mov_b32 v113, v112
    v_mov_b32 v115, v114
    s_nop 0
    v_permlane32_swap_b32 v112, v113
    v_permlane32_swap_b32 v114, v115
    v_mul_f32 v112, s60, v112
    v_mul_f32 v113, s60, v113
    v_mul_f32 v114, s60, v114
    v_mul_f32 v115, s60, v115
    v_fma_f32 v96, v80, s60, -v112
    v_fma_f32 v97, v81, s60, -v112
    v_fma_f32 v98, v82, s60, -v112
    v_fma_f32 v99, v83, s60, -v112
    v_fma_f32 v100, v84, s60, -v112
    v_fma_f32 v101, v85, s60, -v112
    v_fma_f32 v102, v86, s60, -v112
    v_fma_f32 v103, v87, s60, -v112
    v_fma_f32 v80, -v80, s60, -v114
    v_fma_f32 v81, -v81, s60, -v114
    v_fma_f32 v82, -v82, s60, -v114
    v_fma_f32 v83, -v83, s60, -v114
    v_fma_f32 v84, -v84, s60, -v114
    v_fma_f32 v85, -v85, s60, -v114
    v_fma_f32 v86, -v86, s60, -v114
    v_fma_f32 v87, -v87, s60, -v114
    v_fma_f32 v104, v88, s60, -v113
    v_fma_f32 v105, v89, s60, -v113
    v_fma_f32 v106, v90, s60, -v113
    v_fma_f32 v107, v91, s60, -v113
    v_fma_f32 v108, v92, s60, -v113
    v_fma_f32 v109, v93, s60, -v113
    v_fma_f32 v110, v94, s60, -v113
    v_fma_f32 v111, v95, s60, -v113
    v_fma_f32 v88, -v88, s60, -v115
    v_fma_f32 v89, -v89, s60, -v115
    v_fma_f32 v90, -v90, s60, -v115
    v_fma_f32 v91, -v91, s60, -v115
    v_fma_f32 v92, -v92, s60, -v115
    v_fma_f32 v93, -v93, s60, -v115
    v_fma_f32 v94, -v94, s60, -v115
    v_fma_f32 v95, -v95, s60, -v115
    v_exp_f32 v96, v96
    v_exp_f32 v80, v80
    v_exp_f32 v97, v97
    v_exp_f32 v81, v81
    v_exp_f32 v98, v98
    v_exp_f32 v82, v82
    v_exp_f32 v99, v99
    v_exp_f32 v83, v83
    v_exp_f32 v100, v100
    v_exp_f32 v84, v84
    v_exp_f32 v101, v101
    v_exp_f32 v85, v85
    v_exp_f32 v102, v102
    v_exp_f32 v86, v86
    v_exp_f32 v103, v103
    v_exp_f32 v87, v87
    v_exp_f32 v104, v104
    v_exp_f32 v88, v88
    v_exp_f32 v105, v105
    v_exp_f32 v89, v89
    v_exp_f32 v106, v106
    v_exp_f32 v90, v90
    v_exp_f32 v107, v107
    v_exp_f32 v91, v91
    v_exp_f32 v108, v108
    v_exp_f32 v92, v92
    v_exp_f32 v109, v109
    v_exp_f32 v93, v93
    v_exp_f32 v110, v110
    v_exp_f32 v94, v94
    v_exp_f32 v111, v111
    v_exp_f32 v95, v95
    v_add_f32 v112, v96, v97
    v_add_f32 v113, v104, v105
    v_add_f32 v114, v80, v81
    v_add_f32 v115, v88, v89
    v_add_f32 v112, v112, v98
    v_add_f32 v113, v113, v106
    v_add_f32 v114, v114, v82
    v_add_f32 v115, v115, v90
    v_add_f32 v112, v112, v99
    v_add_f32 v113, v113, v107
    v_add_f32 v114, v114, v83
    v_add_f32 v115, v115, v91
    v_add_f32 v112, v112, v100
    v_add_f32 v113, v113, v108
    v_add_f32 v114, v114, v84
    v_add_f32 v115, v115, v92
    v_add_f32 v112, v112, v101
    v_add_f32 v113, v113, v109
    v_add_f32 v114, v114, v85
    v_add_f32 v115, v115, v93
    v_add_f32 v112, v112, v102
    v_add_f32 v113, v113, v110
    v_add_f32 v114, v114, v86
    v_add_f32 v115, v115, v94
    v_add_f32 v112, v112, v103
    v_add_f32 v113, v113, v111
    v_add_f32 v114, v114, v87
    v_add_f32 v115, v115, v95
    v_permlane32_swap_b32 v112, v113
    s_nop 0
    v_permlane32_swap_b32 v114, v115
    v_add_f32 v112, v112, v113
    v_add_f32 v114, v114, v115
    s_nop 1
    v_permlane16_swap_b32 v112, v114
    v_add_f32 v112, v112, v114
    v_mov_b32 v114, v112
    s_nop 1
    v_permlane16_swap_b32 v112, v114
    v_mov_b32 v113, v112
    v_mov_b32 v115, v114
    s_nop 0
    v_permlane32_swap_b32 v112, v113
    v_permlane32_swap_b32 v114, v115
    v_rcp_f32 v112, v112
    v_rcp_f32 v113, v113
    v_rcp_f32 v114, v114
    v_rcp_f32 v115, v115
    v_mul_f32 v96, v96, v112
    v_mul_f32 v97, v97, v112
    v_mul_f32 v98, v98, v112
    v_mul_f32 v99, v99, v112
    v_mul_f32 v100, v100, v112
    v_mul_f32 v101, v101, v112
    v_mul_f32 v102, v102, v112
    v_mul_f32 v103, v103, v112
    v_cvt_pk_bf16_f32 v96, v96, v97
    v_cvt_pk_bf16_f32 v97, v98, v99
    v_cvt_pk_bf16_f32 v98, v100, v101
    v_cvt_pk_bf16_f32 v99, v102, v103
    ds_write_b64 v76, v[96:97] offset:4096
    ds_write_b64 v77, v[98:99] offset:4096
    v_mul_f32 v104, v104, v113
    v_mul_f32 v105, v105, v113
    v_mul_f32 v106, v106, v113
    v_mul_f32 v107, v107, v113
    v_mul_f32 v108, v108, v113
    v_mul_f32 v109, v109, v113
    v_mul_f32 v110, v110, v113
    v_mul_f32 v111, v111, v113
    v_cvt_pk_bf16_f32 v104, v104, v105
    v_cvt_pk_bf16_f32 v105, v106, v107
    v_cvt_pk_bf16_f32 v106, v108, v109
    v_cvt_pk_bf16_f32 v107, v110, v111
    ds_write_b64 v76, v[104:105] offset:6144
    ds_write_b64 v77, v[106:107] offset:6144
    v_mul_f32 v80, v80, v114
    v_mul_f32 v81, v81, v114
    v_mul_f32 v82, v82, v114
    v_mul_f32 v83, v83, v114
    v_mul_f32 v84, v84, v114
    v_mul_f32 v85, v85, v114
    v_mul_f32 v86, v86, v114
    v_mul_f32 v87, v87, v114
    v_cvt_pk_bf16_f32 v80, v80, v81
    v_cvt_pk_bf16_f32 v81, v82, v83
    v_cvt_pk_bf16_f32 v82, v84, v85
    v_cvt_pk_bf16_f32 v83, v86, v87
    ds_write_b64 v78, v[80:81] offset:4096
    ds_write_b64 v79, v[82:83] offset:4096
    v_mul_f32 v88, v88, v115
    v_mul_f32 v89, v89, v115
    v_mul_f32 v90, v90, v115
    v_mul_f32 v91, v91, v115
    v_mul_f32 v92, v92, v115
    v_mul_f32 v93, v93, v115
    v_mul_f32 v94, v94, v115
    v_mul_f32 v95, v95, v115
    v_cvt_pk_bf16_f32 v88, v88, v89
    v_cvt_pk_bf16_f32 v89, v90, v91
    v_cvt_pk_bf16_f32 v90, v92, v93
    v_cvt_pk_bf16_f32 v91, v94, v95
    ds_write_b64 v78, v[88:89] offset:6144
    ds_write_b64 v79, v[90:91] offset:6144
    s_setprio 0
    s_waitcnt lgkmcnt(0)
    s_barrier
    v_mfma_f32_16x16x32_bf16 v[80:83], v[116:119], v[68:71], 0
    v_mfma_f32_16x16x32_bf16 v[84:87], v[120:123], v[68:71], 0
    v_mfma_f32_16x16x32_bf16 v[88:91], v[116:119], v[72:75], 0
    v_mfma_f32_16x16x32_bf16 v[92:95], v[120:123], v[72:75], 0
    s_nop 4
    v_max3_f32 v112, v80, v81, v82
    s_nop 0
    v_max3_f32 v113, v88, v89, v90
    v_max3_f32 v114, -v80, -v81, -v82
    v_max3_f32 v115, -v88, -v89, -v90
    v_max3_f32 v112, v112, v83, v84
    v_max3_f32 v113, v113, v91, v92
    v_max3_f32 v114, v114, -v83, -v84
    v_max3_f32 v115, v115, -v91, -v92
    v_max3_f32 v112, v112, v85, v86
    v_max3_f32 v113, v113, v93, v94
    v_max3_f32 v114, v114, -v85, -v86
    v_max3_f32 v115, v115, -v93, -v94
    v_max_f32 v112, v87, v112
    v_max_f32 v113, v95, v113
    v_max_f32 v114, -v87, v114
    v_max_f32 v115, -v95, v115
    v_permlane32_swap_b32 v112, v113
    s_nop 0
    v_permlane32_swap_b32 v114, v115
    v_max_f32 v112, v112, v113
    v_max_f32 v114, v114, v115
    s_nop 1
    v_permlane16_swap_b32 v112, v114
    v_max_f32 v112, v112, v114
    v_mov_b32 v114, v112
    s_nop 1
    v_permlane16_swap_b32 v112, v114
    v_mov_b32 v113, v112
    v_mov_b32 v115, v114
    s_nop 0
    v_permlane32_swap_b32 v112, v113
    v_permlane32_swap_b32 v114, v115
    v_mul_f32 v112, s60, v112
    v_mul_f32 v113, s60, v113
    v_mul_f32 v114, s60, v114
    v_mul_f32 v115, s60, v115
    v_fma_f32 v96, v80, s60, -v112
    v_fma_f32 v97, v81, s60, -v112
    v_fma_f32 v98, v82, s60, -v112
    v_fma_f32 v99, v83, s60, -v112
    v_fma_f32 v100, v84, s60, -v112
    v_fma_f32 v101, v85, s60, -v112
    v_fma_f32 v102, v86, s60, -v112
    v_fma_f32 v103, v87, s60, -v112
    v_fma_f32 v80, -v80, s60, -v114
    v_fma_f32 v81, -v81, s60, -v114
    v_fma_f32 v82, -v82, s60, -v114
    v_fma_f32 v83, -v83, s60, -v114
    v_fma_f32 v84, -v84, s60, -v114
    v_fma_f32 v85, -v85, s60, -v114
    v_fma_f32 v86, -v86, s60, -v114
    v_fma_f32 v87, -v87, s60, -v114
    v_fma_f32 v104, v88, s60, -v113
    v_fma_f32 v105, v89, s60, -v113
    v_fma_f32 v106, v90, s60, -v113
    v_fma_f32 v107, v91, s60, -v113
    v_fma_f32 v108, v92, s60, -v113
    v_fma_f32 v109, v93, s60, -v113
    v_fma_f32 v110, v94, s60, -v113
    v_fma_f32 v111, v95, s60, -v113
    v_fma_f32 v88, -v88, s60, -v115
    v_fma_f32 v89, -v89, s60, -v115
    v_fma_f32 v90, -v90, s60, -v115
    v_fma_f32 v91, -v91, s60, -v115
    v_fma_f32 v92, -v92, s60, -v115
    v_fma_f32 v93, -v93, s60, -v115
    v_fma_f32 v94, -v94, s60, -v115
    v_fma_f32 v95, -v95, s60, -v115
    v_exp_f32 v96, v96
    v_exp_f32 v80, v80
    v_exp_f32 v97, v97
    v_exp_f32 v81, v81
    v_exp_f32 v98, v98
    v_exp_f32 v82, v82
    v_exp_f32 v99, v99
    v_exp_f32 v83, v83
    v_exp_f32 v100, v100
    v_exp_f32 v84, v84
    v_exp_f32 v101, v101
    v_exp_f32 v85, v85
    v_exp_f32 v102, v102
    v_exp_f32 v86, v86
    v_exp_f32 v103, v103
    v_exp_f32 v87, v87
    v_exp_f32 v104, v104
    v_exp_f32 v88, v88
    v_exp_f32 v105, v105
    v_exp_f32 v89, v89
    v_exp_f32 v106, v106
    v_exp_f32 v90, v90
    v_exp_f32 v107, v107
    v_exp_f32 v91, v91
    v_exp_f32 v108, v108
    v_exp_f32 v92, v92
    v_exp_f32 v109, v109
    v_exp_f32 v93, v93
    v_exp_f32 v110, v110
    v_exp_f32 v94, v94
    v_exp_f32 v111, v111
    v_exp_f32 v95, v95
    v_add_f32 v112, v96, v97
    v_add_f32 v113, v104, v105
    v_add_f32 v114, v80, v81
    v_add_f32 v115, v88, v89
    v_add_f32 v112, v112, v98
    v_add_f32 v113, v113, v106
    v_add_f32 v114, v114, v82
    v_add_f32 v115, v115, v90
    v_add_f32 v112, v112, v99
    v_add_f32 v113, v113, v107
    v_add_f32 v114, v114, v83
    v_add_f32 v115, v115, v91
    v_add_f32 v112, v112, v100
    v_add_f32 v113, v113, v108
    v_add_f32 v114, v114, v84
    v_add_f32 v115, v115, v92
    v_add_f32 v112, v112, v101
    v_add_f32 v113, v113, v109
    v_add_f32 v114, v114, v85
    v_add_f32 v115, v115, v93
    v_add_f32 v112, v112, v102
    v_add_f32 v113, v113, v110
    v_add_f32 v114, v114, v86
    v_add_f32 v115, v115, v94
    v_add_f32 v112, v112, v103
    v_add_f32 v113, v113, v111
    v_add_f32 v114, v114, v87
    v_add_f32 v115, v115, v95
    v_permlane32_swap_b32 v112, v113
    s_nop 0
    v_permlane32_swap_b32 v114, v115
    v_add_f32 v112, v112, v113
    v_add_f32 v114, v114, v115
    s_nop 1
    v_permlane16_swap_b32 v112, v114
    v_add_f32 v112, v112, v114
    v_mov_b32 v114, v112
    s_nop 1
    v_permlane16_swap_b32 v112, v114
    v_mov_b32 v113, v112
    v_mov_b32 v115, v114
    s_nop 0
    v_permlane32_swap_b32 v112, v113
    v_permlane32_swap_b32 v114, v115
    v_rcp_f32 v112, v112
    v_rcp_f32 v113, v113
    v_rcp_f32 v114, v114
    v_rcp_f32 v115, v115
    v_mul_f32 v96, v96, v112
    v_mul_f32 v97, v97, v112
    v_mul_f32 v98, v98, v112
    v_mul_f32 v99, v99, v112
    v_mul_f32 v100, v100, v112
    v_mul_f32 v101, v101, v112
    v_mul_f32 v102, v102, v112
    v_mul_f32 v103, v103, v112
    v_cvt_pk_bf16_f32 v96, v96, v97
    v_cvt_pk_bf16_f32 v97, v98, v99
    v_cvt_pk_bf16_f32 v98, v100, v101
    v_cvt_pk_bf16_f32 v99, v102, v103
    v_mul_f32 v104, v104, v113
    v_mul_f32 v105, v105, v113
    v_mul_f32 v106, v106, v113
    v_mul_f32 v107, v107, v113
    v_mul_f32 v108, v108, v113
    v_mul_f32 v109, v109, v113
    v_mul_f32 v110, v110, v113
    v_mul_f32 v111, v111, v113
    v_cvt_pk_bf16_f32 v104, v104, v105
    v_cvt_pk_bf16_f32 v105, v106, v107
    v_cvt_pk_bf16_f32 v106, v108, v109
    v_cvt_pk_bf16_f32 v107, v110, v111
    v_mul_f32 v80, v80, v114
    v_mul_f32 v81, v81, v114
    v_mul_f32 v82, v82, v114
    v_mul_f32 v83, v83, v114
    v_mul_f32 v84, v84, v114
    v_mul_f32 v85, v85, v114
    v_mul_f32 v86, v86, v114
    v_mul_f32 v87, v87, v114
    v_cvt_pk_bf16_f32 v80, v80, v81
    v_cvt_pk_bf16_f32 v81, v82, v83
    v_cvt_pk_bf16_f32 v82, v84, v85
    v_cvt_pk_bf16_f32 v83, v86, v87
    v_mul_f32 v88, v88, v115
    v_mul_f32 v89, v89, v115
    v_mul_f32 v90, v90, v115
    v_mul_f32 v91, v91, v115
    v_mul_f32 v92, v92, v115
    v_mul_f32 v93, v93, v115
    v_mul_f32 v94, v94, v115
    v_mul_f32 v95, v95, v115
    v_cvt_pk_bf16_f32 v88, v88, v89
    v_cvt_pk_bf16_f32 v89, v90, v91
    v_cvt_pk_bf16_f32 v90, v92, v93
    v_cvt_pk_bf16_f32 v91, v94, v95
    s_waitcnt vmcnt(0)
    s_add_u32 s84, s6, 524288
    s_addc_u32 s85, s7, 0
    s_mov_b32 s86, 327680
    s_mov_b32 s87, 0x20000
    s_lshl_b32 s88, s41, 11
    s_add_u32 s88, s88, 65536
    s_lshl_b32 s89, s41, 11
    s_add_u32 s89, s89, 65536
    s_lshl_b32 s90, s40, 7
    s_add_u32 s88, s88, s90
    v_lshlrev_b32 v252, 7, v1
    v_mov_b32 v253, s3
    s_mov_b32 s90, 200000
    s_barrier
    s_cmp_lg_u32 s42, 4
    s_cbranch_scc1 f2_s5
    s_mov_b64 exec, 1
    buffer_store_dword v253, v252, s[84:87], s88 offen sc1
    s_mov_b64 exec, -1
f2_s5:
    v_lshlrev_b32 v124, 16, v20
    v_and_b32 v125, 0xffff0000, v20
    v_lshlrev_b32 v126, 16, v21
    v_and_b32 v127, 0xffff0000, v21
    v_lshlrev_b32 v128, 16, v22
    v_and_b32 v129, 0xffff0000, v22
    v_lshlrev_b32 v130, 16, v23
    v_and_b32 v131, 0xffff0000, v23
    s_mov_b32 s59, 0x3fb8aa3b
    v_mul_f32 v132, s59, v124
    v_mul_f32 v133, s59, v125
    v_mul_f32 v134, s59, v126
    v_mul_f32 v135, s59, v127
    v_mul_f32 v136, s59, v128
    v_mul_f32 v137, s59, v129
    v_mul_f32 v138, s59, v130
    v_mul_f32 v139, s59, v131
    v_exp_f32 v132, -v132
    v_exp_f32 v133, -v133
    v_exp_f32 v134, -v134
    v_exp_f32 v135, -v135
    v_exp_f32 v136, -v136
    v_exp_f32 v137, -v137
    v_exp_f32 v138, -v138
    v_exp_f32 v139, -v139
    v_add_f32 v132, 1.0, v132
    v_add_f32 v133, 1.0, v133
    v_add_f32 v134, 1.0, v134
    v_add_f32 v135, 1.0, v135
    v_add_f32 v136, 1.0, v136
    v_add_f32 v137, 1.0, v137
    v_add_f32 v138, 1.0, v138
    v_add_f32 v139, 1.0, v139
    v_rcp_f32 v132, v132
    v_rcp_f32 v133, v133
    v_rcp_f32 v134, v134
    v_rcp_f32 v135, v135
    v_rcp_f32 v136, v136
    v_rcp_f32 v137, v137
    v_rcp_f32 v138, v138
    v_rcp_f32 v139, v139
    v_mul_f32 v124, v124, v132
    v_mul_f32 v125, v125, v133
    v_mul_f32 v126, v126, v134
    v_mul_f32 v127, v127, v135
    v_mul_f32 v128, v128, v136
    v_mul_f32 v129, v129, v137
    v_mul_f32 v130, v130, v138
    v_mul_f32 v131, v131, v139
    v_cvt_pk_bf16_f32 v132, v124, v125
    v_cvt_pk_bf16_f32 v133, v126, v127
    v_cvt_pk_bf16_f32 v134, v128, v129
    v_cvt_pk_bf16_f32 v135, v130, v131
    v_lshlrev_b32 v124, 16, v132
    v_and_b32 v125, 0xffff0000, v132
    v_lshlrev_b32 v126, 16, v133
    v_and_b32 v127, 0xffff0000, v133
    v_lshlrev_b32 v128, 16, v134
    v_and_b32 v129, 0xffff0000, v134
    v_lshlrev_b32 v130, 16, v135
    v_and_b32 v131, 0xffff0000, v135
    v_lshlrev_b32 v140, 16, v24
    v_and_b32 v141, 0xffff0000, v24
    v_lshlrev_b32 v142, 16, v25
    v_and_b32 v143, 0xffff0000, v25
    v_lshlrev_b32 v144, 16, v26
    v_and_b32 v145, 0xffff0000, v26
    v_lshlrev_b32 v146, 16, v27
    v_and_b32 v147, 0xffff0000, v27
    v_pk_mul_f32 v[132:133], v[140:141], v[124:125] op_sel_hi:[1,0]
    v_pk_mul_f32 v[134:135], v[142:143], v[124:125] op_sel_hi:[1,0]
    v_pk_mul_f32 v[136:137], v[144:145], v[124:125] op_sel_hi:[1,0]
    v_pk_mul_f32 v[138:139], v[146:147], v[124:125] op_sel_hi:[1,0]
    v_lshlrev_b32 v140, 16, v28
    v_and_b32 v141, 0xffff0000, v28
    v_lshlrev_b32 v142, 16, v29
    v_and_b32 v143, 0xffff0000, v29
    v_lshlrev_b32 v144, 16, v30
    v_and_b32 v145, 0xffff0000, v30
    v_lshlrev_b32 v146, 16, v31
    v_and_b32 v147, 0xffff0000, v31
    v_pk_fma_f32 v[132:133], v[140:141], v[124:125], v[132:133] op_sel:[0,1,0]
    v_pk_fma_f32 v[134:135], v[142:143], v[124:125], v[134:135] op_sel:[0,1,0]
    v_pk_fma_f32 v[136:137], v[144:145], v[124:125], v[136:137] op_sel:[0,1,0]
    v_pk_fma_f32 v[138:139], v[146:147], v[124:125], v[138:139] op_sel:[0,1,0]
    v_lshlrev_b32 v140, 16, v32
    v_and_b32 v141, 0xffff0000, v32
    v_lshlrev_b32 v142, 16, v33
    v_and_b32 v143, 0xffff0000, v33
    v_lshlrev_b32 v144, 16, v34
    v_and_b32 v145, 0xffff0000, v34
    v_lshlrev_b32 v146, 16, v35
    v_and_b32 v147, 0xffff0000, v35
    v_pk_fma_f32 v[132:133], v[140:141], v[126:127], v[132:133] op_sel_hi:[1,0,1]
    v_pk_fma_f32 v[134:135], v[142:143], v[126:127], v[134:135] op_sel_hi:[1,0,1]
    v_pk_fma_f32 v[136:137], v[144:145], v[126:127], v[136:137] op_sel_hi:[1,0,1]
    v_pk_fma_f32 v[138:139], v[146:147], v[126:127], v[138:139] op_sel_hi:[1,0,1]
    v_lshlrev_b32 v140, 16, v36
    v_and_b32 v141, 0xffff0000, v36
    v_lshlrev_b32 v142, 16, v37
    v_and_b32 v143, 0xffff0000, v37
    v_lshlrev_b32 v144, 16, v38
    v_and_b32 v145, 0xffff0000, v38
    v_lshlrev_b32 v146, 16, v39
    v_and_b32 v147, 0xffff0000, v39
    v_pk_fma_f32 v[132:133], v[140:141], v[126:127], v[132:133] op_sel:[0,1,0]
    v_pk_fma_f32 v[134:135], v[142:143], v[126:127], v[134:135] op_sel:[0,1,0]
    v_pk_fma_f32 v[136:137], v[144:145], v[126:127], v[136:137] op_sel:[0,1,0]
    v_pk_fma_f32 v[138:139], v[146:147], v[126:127], v[138:139] op_sel:[0,1,0]
    v_lshlrev_b32 v140, 16, v40
    v_and_b32 v141, 0xffff0000, v40
    v_lshlrev_b32 v142, 16, v41
    v_and_b32 v143, 0xffff0000, v41
    v_lshlrev_b32 v144, 16, v42
    v_and_b32 v145, 0xffff0000, v42
    v_lshlrev_b32 v146, 16, v43
    v_and_b32 v147, 0xffff0000, v43
    v_pk_fma_f32 v[132:133], v[140:141], v[128:129], v[132:133] op_sel_hi:[1,0,1]
    v_pk_fma_f32 v[134:135], v[142:143], v[128:129], v[134:135] op_sel_hi:[1,0,1]
    v_pk_fma_f32 v[136:137], v[144:145], v[128:129], v[136:137] op_sel_hi:[1,0,1]
    v_pk_fma_f32 v[138:139], v[146:147], v[128:129], v[138:139] op_sel_hi:[1,0,1]
    v_lshlrev_b32 v140, 16, v44
    v_and_b32 v141, 0xffff0000, v44
    v_lshlrev_b32 v142, 16, v45
    v_and_b32 v143, 0xffff0000, v45
    v_lshlrev_b32 v144, 16, v46
    v_and_b32 v145, 0xffff0000, v46
    v_lshlrev_b32 v146, 16, v47
    v_and_b32 v147, 0xffff0000, v47
    v_pk_fma_f32 v[132:133], v[140:141], v[128:129], v[132:133] op_sel:[0,1,0]
    v_pk_fma_f32 v[134:135], v[142:143], v[128:129], v[134:135] op_sel:[0,1,0]
    v_pk_fma_f32 v[136:137], v[144:145], v[128:129], v[136:137] op_sel:[0,1,0]
    v_pk_fma_f32 v[138:139], v[146:147], v[128:129], v[138:139] op_sel:[0,1,0]
    v_lshlrev_b32 v140, 16, v48
    v_and_b32 v141, 0xffff0000, v48
    v_lshlrev_b32 v142, 16, v49
    v_and_b32 v143, 0xffff0000, v49
    v_lshlrev_b32 v144, 16, v50
    v_and_b32 v145, 0xffff0000, v50
    v_lshlrev_b32 v146, 16, v51
    v_and_b32 v147, 0xffff0000, v51
    v_pk_fma_f32 v[132:133], v[140:141], v[130:131], v[132:133] op_sel_hi:[1,0,1]
    v_pk_fma_f32 v[134:135], v[142:143], v[130:131], v[134:135] op_sel_hi:[1,0,1]
    v_pk_fma_f32 v[136:137], v[144:145], v[130:131], v[136:137] op_sel_hi:[1,0,1]
    v_pk_fma_f32 v[138:139], v[146:147], v[130:131], v[138:139] op_sel_hi:[1,0,1]
    v_lshlrev_b32 v140, 16, v52
    v_and_b32 v141, 0xffff0000, v52
    v_lshlrev_b32 v142, 16, v53
    v_and_b32 v143, 0xffff0000, v53
    v_lshlrev_b32 v144, 16, v54
    v_and_b32 v145, 0xffff0000, v54
    v_lshlrev_b32 v146, 16, v55
    v_and_b32 v147, 0xffff0000, v55
    v_pk_fma_f32 v[132:133], v[140:141], v[130:131], v[132:133] op_sel:[0,1,0]
    v_pk_fma_f32 v[134:135], v[142:143], v[130:131], v[134:135] op_sel:[0,1,0]
    v_pk_fma_f32 v[136:137], v[144:145], v[130:131], v[136:137] op_sel:[0,1,0]
    v_pk_fma_f32 v[138:139], v[146:147], v[130:131], v[138:139] op_sel:[0,1,0]
    v_add_f32_dpp v132, v132, v132 row_ror:8 row_mask:0xf bank_mask:0xf
    v_add_f32_dpp v133, v133, v133 row_ror:8 row_mask:0xf bank_mask:0xf
    v_add_f32_dpp v134, v134, v134 row_ror:8 row_mask:0xf bank_mask:0xf
    v_add_f32_dpp v135, v135, v135 row_ror:8 row_mask:0xf bank_mask:0xf
    v_add_f32_dpp v136, v136, v136 row_ror:8 row_mask:0xf bank_mask:0xf
    v_add_f32_dpp v137, v137, v137 row_ror:8 row_mask:0xf bank_mask:0xf
    v_add_f32_dpp v138, v138, v138 row_ror:8 row_mask:0xf bank_mask:0xf
    v_add_f32_dpp v139, v139, v139 row_ror:8 row_mask:0xf bank_mask:0xf
    v_lshrrev_b32 v2, 4, v58
    v_lshlrev_b32 v2, 8, v2
    v_and_b32 v5, 7, v1
    v_lshl_add_u32 v2, v5, 5, v2
    v_add_u32 v2, 106496, v2
    ds_write_b128 v2, v[132:135]
    ds_write_b128 v2, v[136:139] offset:16
    v_mov_b32 v5, 126992
    v_mov_b32 v6, 1
    s_waitcnt lgkmcnt(0)
    s_mov_b64 exec, 1
    ds_add_rtn_u32 v6, v5, v6
    s_mov_b64 exec, -1
    s_waitcnt lgkmcnt(0)
    v_readfirstlane_b32 s59, v6
    s_nop 0
    s_cmp_lg_u32 s59, 3
    s_cbranch_scc1 qkv_gvx
    v_lshlrev_b32 v5, 2, v1
    v_add_u32 v6, 106496, v5
    ds_read_b32 v124, v6 offset:0
    ds_read_b32 v125, v6 offset:256
    ds_read_b32 v126, v6 offset:512
    ds_read_b32 v127, v6 offset:768
    ds_read_b32 v128, v6 offset:1024
    ds_read_b32 v129, v6 offset:1280
    ds_read_b32 v130, v6 offset:1536
    ds_read_b32 v131, v6 offset:1792
    ds_read_b32 v132, v6 offset:2048
    ds_read_b32 v133, v6 offset:2304
    ds_read_b32 v134, v6 offset:2560
    ds_read_b32 v135, v6 offset:2816
    ds_read_b32 v136, v6 offset:3072
    ds_read_b32 v137, v6 offset:3328
    ds_read_b32 v138, v6 offset:3584
    ds_read_b32 v139, v6 offset:3840
    s_and_b32 s59, s2, 63
    s_lshl_b32 s59, s59, 2
    s_lshr_b32 s61, s2, 6
    s_add_u32 s59, s59, s61
    s_lshl_b32 s59, s59, 7
    s_add_u32 s59, s59, 229376
    s_waitcnt lgkmcnt(0)
    v_add_f32 v124, v124, v132
    v_add_f32 v125, v125, v133
    v_add_f32 v126, v126, v134
    v_add_f32 v127, v127, v135
    v_add_f32 v128, v128, v136
    v_add_f32 v129, v129, v137
    v_add_f32 v130, v130, v138
    v_add_f32 v131, v131, v139
    v_add_f32 v124, v124, v128
    v_add_f32 v125, v125, v129
    v_add_f32 v126, v126, v130
    v_add_f32 v127, v127, v131
    v_add_f32 v124, v124, v126
    v_add_f32 v125, v125, v127
    v_add_f32 v124, v124, v125
    buffer_store_dword v124, v5, s[24:27], s64 offen sc1
    v_mov_b32 v6, s3
    s_waitcnt vmcnt(0)
    s_mov_b64 exec, 1
    buffer_store_dword v6, v252, s[84:87], s59 offen sc1
    s_mov_b64 exec, -1
qkv_gvx:
    s_cmp_lg_u32 s42, 5
    s_cbranch_scc1 f2_sx
    s_mov_b64 exec, 0xffff
    buffer_load_dword v253, v252, s[84:87], s89 offen sc1
f2_sp:
    buffer_load_dword v254, v252, s[84:87], s89 offen sc1
    s_sub_u32 s90, s90, 1
    s_waitcnt vmcnt(1)
    v_cmp_ne_u32 vcc, s3, v253
    s_nop 0
    s_cmp_eq_u64 vcc, 0
    s_cbranch_scc1 f2_sy
    buffer_load_dword v253, v252, s[84:87], s89 offen sc1
    s_waitcnt vmcnt(1)
    v_cmp_ne_u32 vcc, s3, v254
    s_nop 0
    s_cmp_eq_u64 vcc, 0
    s_cbranch_scc1 f2_sy
    s_cmp_lg_u32 s90, 0
    s_cbranch_scc1 f2_sp
f2_sy:
    s_mov_b64 exec, -1
f2_sx:
    s_barrier
    s_mov_b32 s93, s40
    s_mov_b32 s97, s41
    s_or_b32 s59, s2, s42
    s_cmp_lg_u32 s59, 4
    s_cbranch_scc1 qkv_nn
    s_mov_b32 s59, 0
    v_mov_b32 v253, s3
    s_mov_b64 exec, 1
    buffer_store_dword v253, v252, s[84:87], s59 offen sc1
    s_mov_b64 exec, -1
qkv_nn:
    s_add_u32 s16, s6, 1048576
    s_addc_u32 s17, s7, 0
    s_mov_b32 s18, 33554432
    s_mov_b32 s19, 0x20000
    s_add_u32 s20, s6, 131072
    s_addc_u32 s21, s7, 0
    s_mov_b32 s22, 2097152
    s_mov_b32 s23, 0x20000
    s_lshr_b32 s60, s42, 2
    s_lshl_b32 s61, s41, 1
    s_add_u32 s60, s60, s61
    s_and_b32 s61, s42, 3
    s_lshl_b32 s62, s60, 16
    s_lshl_b32 s63, s61, 10
    s_add_u32 s62, s62, s63
    s_lshl_b32 s63, s60, 12
    s_lshl_b32 s64, s61, 6
    s_add_u32 s63, s63, s64
    v_lshlrev_b32 v156, 4, v1
    v_lshrrev_b32 v157, 4, v1
    v_lshlrev_b32 v157, 4, v157
    v_and_b32 v158, 15, v1
    v_lshl_add_u32 v157, v158, 8, v157
    buffer_load_dwordx4 v[168:171], v157, s[20:23], s63 offen sc1
    s_lshl_b32 s64, s40, 1
    s_add_u32 s64, s64, 0
    s_and_b32 s64, s64, 15
    s_lshl_b32 s64, s64, 12
    s_add_u32 s64, s64, s62
    buffer_load_dwordx4 v[176:179], v156, s[16:19], s64 offen sc1
    s_lshl_b32 s64, s40, 1
    s_add_u32 s64, s64, 1
    s_and_b32 s64, s64, 15
    s_lshl_b32 s64, s64, 12
    s_add_u32 s64, s64, s62
    buffer_load_dwordx4 v[180:183], v156, s[16:19], s64 offen sc1
    s_lshl_b32 s64, s40, 1
    s_add_u32 s64, s64, 2
    s_and_b32 s64, s64, 15
    s_lshl_b32 s64, s64, 12
    s_add_u32 s64, s64, s62
    buffer_load_dwordx4 v[184:187], v156, s[16:19], s64 offen sc1
    s_lshl_b32 s64, s40, 1
    s_add_u32 s64, s64, 3
    s_and_b32 s64, s64, 15
    s_lshl_b32 s64, s64, 12
    s_add_u32 s64, s64, s62
    buffer_load_dwordx4 v[188:191], v156, s[16:19], s64 offen sc1
    s_lshl_b32 s64, s40, 1
    s_add_u32 s64, s64, 4
    s_and_b32 s64, s64, 15
    s_lshl_b32 s64, s64, 12
    s_add_u32 s64, s64, s62
    buffer_load_dwordx4 v[192:195], v156, s[16:19], s64 offen sc1
    s_lshl_b32 s64, s40, 1
    s_add_u32 s64, s64, 5
    s_and_b32 s64, s64, 15
    s_lshl_b32 s64, s64, 12
    s_add_u32 s64, s64, s62
    buffer_load_dwordx4 v[196:199], v156, s[16:19], s64 offen sc1
    s_lshl_b32 s64, s40, 1
    s_add_u32 s64, s64, 6
    s_and_b32 s64, s64, 15
    s_lshl_b32 s64, s64, 12
    s_add_u32 s64, s64, s62
    buffer_load_dwordx4 v[200:203], v156, s[16:19], s64 offen sc1
    s_lshl_b32 s64, s40, 1
    s_add_u32 s64, s64, 7
    s_and_b32 s64, s64, 15
    s_lshl_b32 s64, s64, 12
    s_add_u32 s64, s64, s62
    buffer_load_dwordx4 v[204:207], v156, s[16:19], s64 offen sc1
    s_lshl_b32 s64, s40, 1
    s_add_u32 s64, s64, 8
    s_and_b32 s64, s64, 15
    s_lshl_b32 s64, s64, 12
    s_add_u32 s64, s64, s62
    buffer_load_dwordx4 v[208:211], v156, s[16:19], s64 offen sc1
    s_lshl_b32 s64, s40, 1
    s_add_u32 s64, s64, 9
    s_and_b32 s64, s64, 15
    s_lshl_b32 s64, s64, 12
    s_add_u32 s64, s64, s62
    buffer_load_dwordx4 v[212:215], v156, s[16:19], s64 offen sc1
    s_lshl_b32 s64, s40, 1
    s_add_u32 s64, s64, 10
    s_and_b32 s64, s64, 15
    s_lshl_b32 s64, s64, 12
    s_add_u32 s64, s64, s62
    buffer_load_dwordx4 v[216:219], v156, s[16:19], s64 offen sc1
    s_lshl_b32 s64, s40, 1
    s_add_u32 s64, s64, 11
    s_and_b32 s64, s64, 15
    s_lshl_b32 s64, s64, 12
    s_add_u32 s64, s64, s62
    buffer_load_dwordx4 v[220:223], v156, s[16:19], s64 offen sc1
    s_lshl_b32 s64, s40, 1
    s_add_u32 s64, s64, 12
    s_and_b32 s64, s64, 15
    s_lshl_b32 s64, s64, 12
    s_add_u32 s64, s64, s62
    buffer_load_dwordx4 v[224:227], v156, s[16:19], s64 offen sc1
    s_lshl_b32 s64, s40, 1
    s_add_u32 s64, s64, 13
    s_and_b32 s64, s64, 15
    s_lshl_b32 s64, s64, 12
    s_add_u32 s64, s64, s62
    buffer_load_dwordx4 v[228:231], v156, s[16:19], s64 offen sc1
    s_lshl_b32 s64, s40, 1
    s_add_u32 s64, s64, 14
    s_and_b32 s64, s64, 15
    s_lshl_b32 s64, s64, 12
    s_add_u32 s64, s64, s62
    buffer_load_dwordx4 v[232:235], v156, s[16:19], s64 offen sc1
    s_lshl_b32 s64, s40, 1
    s_add_u32 s64, s64, 15
    s_and_b32 s64, s64, 15
    s_lshl_b32 s64, s64, 12
    s_add_u32 s64, s64, s62
    buffer_load_dwordx4 v[236:239], v156, s[16:19], s64 offen sc1
    s_load_dwordx2 s[4:5], s[0:1], 24
    s_load_dwordx2 s[32:33], s[0:1], 0
    s_load_dwordx2 s[34:35], s[0:1], 40
    s_and_b32 s36, s2, 7
    s_lshr_b32 s37, s2, 3
    s_and_b32 s38, s36, 3
    s_lshr_b32 s36, s36, 2
    s_and_b32 s39, s37, 3
    s_lshr_b32 s37, s37, 2
    s_mul_i32 s38, s38, 4
    s_add_u32 s40, s38, s39
    s_mul_i32 s36, s36, 8
    s_add_u32 s41, s36, s37
    s_add_u32 s39, s39, s37
    s_and_b32 s39, s39, 3
    s_mul_i32 s43, s41, 128
    s_sub_u32 s54, s42, 4
    s_getpc_b64 s[66:67]
wo_pc:
    s_add_u32 s66, s66, wo_tab-wo_pc
    s_addc_u32 s67, s67, 0
    s_lshl_b32 s55, s39, 6
    v_add_u32 v2, s55, v1
    global_load_ubyte v3, v2, s[66:67]
    s_mul_i32 s55, s40, 8
    s_mul_i32 s56, s54, 2
    s_add_u32 s55, s55, s56
    s_mul_i32 s55, s55, 32768
    v_lshl_add_u32 v5, v1, 4, s55
    s_mul_i32 s48, s54, 8192
    v_add_u32 v6, 32768, v5
    v_lshrrev_b32 v7, 3, v1
    v_and_b32 v10, 7, v1
    v_and_b32 v8, 6, v7
    v_xor_b32 v9, v10, v8
    v_mul_u32_u24 v8, 2048, v7
    s_mul_i32 s55, s54, 65536
    s_add_u32 s56, s55, s43
    v_add_u32 v8, s56, v8
    v_lshl_add_u32 v9, v9, 4, v8
    s_mul_i32 s49, s54, 4096
    s_add_u32 s49, s49, 32768
    v_add_u32 v11, 15360, v9
    v_add_u32 v12, 30720, v9
    v_add_u32 v13, 46080, v9
    s_mul_i32 s45, s39, 4096
    s_mul_i32 s46, s39, 262144
    s_mov_b32 s52, 1
    s_waitcnt lgkmcnt(0)
    s_add_u32 s8, s6, 25165824
    s_addc_u32 s9, s7, 0
    s_mov_b32 s10, 4194304
    s_mov_b32 s11, 0x20000
    s_mov_b32 s12, s4
    s_mov_b32 s13, s5
    s_mov_b32 s14, 2097152
    s_mov_b32 s15, 0x20000
    s_add_u32 m0, s49, 49152
    s_nop 0
    buffer_load_dwordx4 v9, s[12:15], s46 offen lds
    buffer_load_dwordx4 v11, s[12:15], s46 offen offset:1024 lds
    buffer_load_dwordx4 v12, s[12:15], s46 offen offset:2048 lds
    buffer_load_dwordx4 v13, s[12:15], s46 offen offset:3072 lds
    s_waitcnt vmcnt(4)
    v_mul_u32_u24 v4, 262144, v3
    v_mul_u32_u24 v3, 4096, v3
    v_readlane_b32 s46, v4, 1
    s_mov_b32 s52, 2
    s_add_u32 m0, s49, 98304
    s_nop 2
    buffer_load_dwordx4 v9, s[12:15], s46 offen lds
    buffer_load_dwordx4 v11, s[12:15], s46 offen offset:1024 lds
    buffer_load_dwordx4 v12, s[12:15], s46 offen offset:2048 lds
    buffer_load_dwordx4 v13, s[12:15], s46 offen offset:3072 lds
    v_readlane_b32 s37, v3, 1
    s_lshr_b32 s36, s45, 12
    s_lshr_b32 s37, s37, 12
    v_mov_b32 v244, 0
    v_mov_b32 v245, 0
    v_mov_b32 v248, 0
    v_mov_b32 v249, 0
    v_bfe_u32 v157, v1, 2, 2
    v_lshrrev_b32 v158, 4, v1
    v_cmp_eq_u32 vcc, v157, v158
    v_and_b32 v157, 1, v1
    v_lshlrev_b32 v157, 4, v157
    v_mov_b32 v158, 0x3f80
    v_lshlrev_b32 v157, v157, v158
    v_cndmask_b32 v157, 0, v157, vcc
    v_and_b32 v158, 2, v1
    v_cmp_eq_u32 vcc, 0, v158
    s_nop 1
    v_cndmask_b32 v246, 0, v157, vcc
    v_cndmask_b32 v247, v157, v244, vcc
    v_add_f32_dpp v168, v168, v168 quad_perm:[1,0,3,2] row_mask:0xf bank_mask:0xf
    v_add_f32_dpp v169, v169, v169 quad_perm:[1,0,3,2] row_mask:0xf bank_mask:0xf
    v_add_f32_dpp v170, v170, v170 quad_perm:[1,0,3,2] row_mask:0xf bank_mask:0xf
    v_add_f32_dpp v171, v171, v171 quad_perm:[1,0,3,2] row_mask:0xf bank_mask:0xf
    v_add_f32_dpp v168, v168, v168 quad_perm:[2,3,0,1] row_mask:0xf bank_mask:0xf
    v_add_f32_dpp v169, v169, v169 quad_perm:[2,3,0,1] row_mask:0xf bank_mask:0xf
    v_add_f32_dpp v170, v170, v170 quad_perm:[2,3,0,1] row_mask:0xf bank_mask:0xf
    v_add_f32_dpp v171, v171, v171 quad_perm:[2,3,0,1] row_mask:0xf bank_mask:0xf
    v_add_f32_dpp v168, v168, v168 row_half_mirror row_mask:0xf bank_mask:0xf
    v_add_f32_dpp v169, v169, v169 row_half_mirror row_mask:0xf bank_mask:0xf
    v_add_f32_dpp v170, v170, v170 row_half_mirror row_mask:0xf bank_mask:0xf
    v_add_f32_dpp v171, v171, v171 row_half_mirror row_mask:0xf bank_mask:0xf
    v_add_f32_dpp v168, v168, v168 row_mirror row_mask:0xf bank_mask:0xf
    v_add_f32_dpp v169, v169, v169 row_mirror row_mask:0xf bank_mask:0xf
    v_add_f32_dpp v170, v170, v170 row_mirror row_mask:0xf bank_mask:0xf
    v_add_f32_dpp v171, v171, v171 row_mirror row_mask:0xf bank_mask:0xf
    v_mfma_f32_16x16x32_bf16 v[160:163], v[246:249], v[176:179], 0
    v_mfma_f32_16x16x32_bf16 v[164:167], v[244:247], v[176:179], 0
    v_mfma_f32_16x16x32_bf16 v[160:163], v[246:249], v[180:183], v[160:163]
    v_mfma_f32_16x16x32_bf16 v[164:167], v[244:247], v[180:183], v[164:167]
    v_mfma_f32_16x16x32_bf16 v[160:163], v[246:249], v[184:187], v[160:163]
    v_mfma_f32_16x16x32_bf16 v[164:167], v[244:247], v[184:187], v[164:167]
    v_mfma_f32_16x16x32_bf16 v[160:163], v[246:249], v[188:191], v[160:163]
    v_mfma_f32_16x16x32_bf16 v[164:167], v[244:247], v[188:191], v[164:167]
    v_mfma_f32_16x16x32_bf16 v[160:163], v[246:249], v[192:195], v[160:163]
    v_mfma_f32_16x16x32_bf16 v[164:167], v[244:247], v[192:195], v[164:167]
    v_mfma_f32_16x16x32_bf16 v[160:163], v[246:249], v[196:199], v[160:163]
    v_mfma_f32_16x16x32_bf16 v[164:167], v[244:247], v[196:199], v[164:167]
    v_mfma_f32_16x16x32_bf16 v[160:163], v[246:249], v[200:203], v[160:163]
    v_mfma_f32_16x16x32_bf16 v[164:167], v[244:247], v[200:203], v[164:167]
    v_mfma_f32_16x16x32_bf16 v[160:163], v[246:249], v[204:207], v[160:163]
    v_mfma_f32_16x16x32_bf16 v[164:167], v[244:247], v[204:207], v[164:167]
    v_mfma_f32_16x16x32_bf16 v[160:163], v[246:249], v[208:211], v[160:163]
    v_mfma_f32_16x16x32_bf16 v[164:167], v[244:247], v[208:211], v[164:167]
    v_mfma_f32_16x16x32_bf16 v[160:163], v[246:249], v[212:215], v[160:163]
    v_mfma_f32_16x16x32_bf16 v[164:167], v[244:247], v[212:215], v[164:167]
    v_mfma_f32_16x16x32_bf16 v[160:163], v[246:249], v[216:219], v[160:163]
    v_mfma_f32_16x16x32_bf16 v[164:167], v[244:247], v[216:219], v[164:167]
    v_mfma_f32_16x16x32_bf16 v[160:163], v[246:249], v[220:223], v[160:163]
    v_mfma_f32_16x16x32_bf16 v[164:167], v[244:247], v[220:223], v[164:167]
    v_mfma_f32_16x16x32_bf16 v[160:163], v[246:249], v[224:227], v[160:163]
    v_mfma_f32_16x16x32_bf16 v[164:167], v[244:247], v[224:227], v[164:167]
    v_mfma_f32_16x16x32_bf16 v[160:163], v[246:249], v[228:231], v[160:163]
    v_mfma_f32_16x16x32_bf16 v[164:167], v[244:247], v[228:231], v[164:167]
    v_mfma_f32_16x16x32_bf16 v[160:163], v[246:249], v[232:235], v[160:163]
    v_mfma_f32_16x16x32_bf16 v[164:167], v[244:247], v[232:235], v[164:167]
    v_mfma_f32_16x16x32_bf16 v[160:163], v[246:249], v[236:239], v[160:163]
    v_mfma_f32_16x16x32_bf16 v[164:167], v[244:247], v[236:239], v[164:167]
    s_lshr_b32 s60, s42, 2
    s_mul_i32 s60, s60, 6144
    s_bfe_u32 s61, s42, 0x10001
    s_lshl_b32 s61, s61, 10
    s_add_u32 s60, s60, s61
    s_and_b32 s61, s42, 1
    s_lshl_b32 s62, s61, 11
    s_add_u32 s62, s62, s60
    s_lshl_b32 s61, s61, 3
    s_add_u32 s60, s60, s61
    v_add_u32 v157, s60, v156
    v_add_u32 v158, s62, v156
    v_cvt_pk_bf16_f32 v172, v168, v169
    v_cvt_pk_bf16_f32 v173, v170, v171
    ds_write_b64 v157, v[172:173] offset:4096
    v_cvt_pk_bf16_f32 v176, v160, v161
    v_cvt_pk_bf16_f32 v177, v162, v163
    v_cvt_pk_bf16_f32 v178, v164, v165
    v_cvt_pk_bf16_f32 v179, v166, v167
    ds_write_b128 v158, v[176:179]
    s_waitcnt lgkmcnt(0)
    s_barrier
    s_add_u32 s20, s6, 25165824
    s_addc_u32 s21, s7, 0
    s_mov_b32 s22, 4194304
    s_mov_b32 s23, 0x20000
    s_and_b32 s60, s42, 1
    s_mul_i32 s60, s60, 6144
    v_add_u32 v157, s60, v156
    ds_read_b128 v[176:179], v157 offset:0
    ds_read_b128 v[180:183], v157 offset:1024
    ds_read_b128 v[184:187], v157 offset:2048
    ds_read_b128 v[188:191], v157 offset:3072
    ds_read_b128 v[192:195], v157 offset:4096
    ds_read_b128 v[196:199], v157 offset:5120
    s_bfe_u32 s60, s42, 0x10001
    s_lshl_b32 s61, s93, 1
    s_add_u32 s60, s60, s61
    s_mul_i32 s60, s60, 131072
    s_lshl_b32 s61, s58, 10
    s_add_u32 s60, s60, s61
    s_add_u32 s60, s60, 65536
    s_waitcnt lgkmcnt(0)
    v_mfma_f32_16x16x32_bf16 v[208:211], v[192:195], v[96:99], 0
    v_mfma_f32_16x16x32_bf16 v[220:223], v[192:195], v[104:107], 0
    v_mfma_f32_16x16x32_bf16 v[200:203], v[176:179], v[96:99], 0
    v_mfma_f32_16x16x32_bf16 v[212:215], v[176:179], v[104:107], 0
    v_mfma_f32_16x16x32_bf16 v[204:207], v[184:187], v[96:99], 0
    v_mfma_f32_16x16x32_bf16 v[216:219], v[184:187], v[104:107], 0
    v_mfma_f32_16x16x32_bf16 v[208:211], v[196:199], v[80:83], v[208:211]
    v_mfma_f32_16x16x32_bf16 v[220:223], v[196:199], v[88:91], v[220:223]
    v_mfma_f32_16x16x32_bf16 v[200:203], v[180:183], v[80:83], v[200:203]
    v_mfma_f32_16x16x32_bf16 v[212:215], v[180:183], v[88:91], v[212:215]
    v_mfma_f32_16x16x32_bf16 v[204:207], v[188:191], v[80:83], v[204:207]
    v_mfma_f32_16x16x32_bf16 v[216:219], v[188:191], v[88:91], v[216:219]
    s_nop 2
    v_add_f32 v208, 0x358637bd, v208
    v_add_f32 v220, 0x358637bd, v220
    v_rcp_f32 v208, v208
    v_rcp_f32 v220, v220
    v_pk_mul_f32 v[200:201], v[200:201], v[208:209] op_sel_hi:[1,0]
    v_pk_mul_f32 v[202:203], v[202:203], v[208:209] op_sel_hi:[1,0]
    v_pk_mul_f32 v[204:205], v[204:205], v[208:209] op_sel_hi:[1,0]
    v_pk_mul_f32 v[206:207], v[206:207], v[208:209] op_sel_hi:[1,0]
    v_cvt_pk_bf16_f32 v160, v200, v201
    v_cvt_pk_bf16_f32 v161, v202, v203
    v_cvt_pk_bf16_f32 v162, v204, v205
    v_cvt_pk_bf16_f32 v163, v206, v207
    buffer_store_dwordx4 v[160:163], v156, s[20:23], s60 offen sc1
    s_add_u32 s60, s60, 32768
    v_pk_mul_f32 v[212:213], v[212:213], v[220:221] op_sel_hi:[1,0]
    v_pk_mul_f32 v[214:215], v[214:215], v[220:221] op_sel_hi:[1,0]
    v_pk_mul_f32 v[216:217], v[216:217], v[220:221] op_sel_hi:[1,0]
    v_pk_mul_f32 v[218:219], v[218:219], v[220:221] op_sel_hi:[1,0]
    v_cvt_pk_bf16_f32 v164, v212, v213
    v_cvt_pk_bf16_f32 v165, v214, v215
    v_cvt_pk_bf16_f32 v166, v216, v217
    v_cvt_pk_bf16_f32 v167, v218, v219
    buffer_store_dwordx4 v[164:167], v156, s[20:23], s60 offen sc1
    s_add_u32 s60, s60, 32768
    s_waitcnt vmcnt(0)
    s_add_u32 s84, s6, 524288
    s_addc_u32 s85, s7, 0
    s_mov_b32 s86, 327680
    s_mov_b32 s87, 0x20000
    s_lshl_b32 s88, s93, 11
    s_add_u32 s88, s88, 98304
    s_lshl_b32 s89, s40, 11
    s_add_u32 s89, s89, 98304
    s_lshl_b32 s90, s97, 7
    s_add_u32 s88, s88, s90
    v_lshlrev_b32 v252, 7, v1
    v_mov_b32 v253, s3
    s_mov_b32 s90, 200000
    s_barrier
    s_cmp_lg_u32 s42, 4
    s_cbranch_scc1 f3_s5
    s_mov_b64 exec, 1
    buffer_store_dword v253, v252, s[84:87], s88 offen sc1
    s_mov_b64 exec, -1
f3_s5:
    s_cmp_lg_u32 s42, 6
    s_cbranch_scc1 wo7_x
    s_lshr_b32 s61, s2, 3
    s_lshr_b32 s62, s61, 3
    s_add_u32 s62, s62, s61
    s_and_b32 s62, s62, 3
    s_cmp_eq_u32 s62, 0
    s_cselect_b32 s63, 4, s62
    s_lshl_b32 s64, s62, 2
    s_lshr_b32 s64, 0x1431, s64
    s_and_b32 s64, s64, 15
    s_add_u32 s65, s62, 1
    s_and_b32 s65, s65, 3
    s_add_u32 s62, s63, 3
    s_bitcmp1_b32 s61, 2
    s_cselect_b32 s64, s63, s64
    s_cselect_b32 s65, s62, s65
    s_and_b32 s61, s2, 1
    s_lshl_b32 s61, s61, 3
    s_add_u32 s65, s65, s61
    v_lshrrev_b32 v40, 2, v1
    v_cmp_gt_u32 vcc, 2, v40
    v_mov_b32 v41, s65
    v_mov_b32 v42, s41
    v_cndmask_b32 v41, v41, v42, vcc
    v_lshlrev_b32 v41, 2, v41
    v_lshlrev_b32 v40, 2, v40
    v_mov_b32 v42, 0x2120
    v_lshrrev_b32 v40, v40, v42
    v_and_b32 v40, 3, v40
    v_lshl_add_u32 v41, v40, 6, v41
    v_and_b32 v40, 3, v1
    v_add_u32 v41, v40, v41
    v_lshlrev_b32 v41, 7, v41
    s_mov_b32 s61, 229376
    s_mov_b64 exec, 0xffff
wo7_p:
    buffer_load_dword v40, v41, s[84:87], s61 offen sc1
    s_sub_u32 s90, s90, 1
    s_waitcnt vmcnt(0)
    v_cmp_ne_u32 vcc, s3, v40
    s_nop 0
    s_cmp_eq_u64 vcc, 0
    s_cbranch_scc1 wo7_y
    s_cmp_lg_u32 s90, 0
    s_cbranch_scc1 wo7_p
wo7_y:
    s_mov_b64 exec, -1
    s_add_u32 s20, s6, 65536
    s_addc_u32 s21, s7, 0
    s_mov_b32 s22, 65536
    s_mov_b32 s23, 0x20000
    v_lshrrev_b32 v161, 4, v1
    v_lshlrev_b32 v161, 14, v161
    v_and_b32 v162, 15, v1
    v_lshl_add_u32 v161, v162, 4, v161
    s_lshl_b32 s61, s41, 8
    s_add_u32 s61, s61, 0
    buffer_load_dwordx4 v[164:167], v161, s[20:23], s61 offen sc1
    s_lshl_b32 s61, s41, 8
    s_add_u32 s61, s61, 8192
    buffer_load_dwordx4 v[168:171], v161, s[20:23], s61 offen sc1
    v_lshlrev_b32 v162, 4, v162
    v_add_u32 v162, 147456, v162
    s_waitcnt vmcnt(0)
    v_mov_b32 v180, v164
    v_mov_b32 v181, v165
    v_mov_b32 v182, v166
    v_mov_b32 v183, v167
    v_mov_b32 v184, v168
    v_mov_b32 v185, v169
    v_mov_b32 v186, v170
    v_mov_b32 v187, v171
    v_permlane32_swap_b32 v164, v180
    v_permlane32_swap_b32 v165, v181
    v_permlane32_swap_b32 v166, v182
    v_permlane32_swap_b32 v167, v183
    v_permlane32_swap_b32 v168, v184
    v_permlane32_swap_b32 v169, v185
    v_permlane32_swap_b32 v170, v186
    v_permlane32_swap_b32 v171, v187
    v_add_f32 v164, v164, v180
    v_add_f32 v165, v165, v181
    v_add_f32 v166, v166, v182
    v_add_f32 v167, v167, v183
    v_add_f32 v168, v168, v184
    v_add_f32 v169, v169, v185
    v_add_f32 v170, v170, v186
    v_add_f32 v171, v171, v187
    v_mov_b32 v180, v164
    v_mov_b32 v181, v165
    v_mov_b32 v182, v166
    v_mov_b32 v183, v167
    v_mov_b32 v184, v168
    v_mov_b32 v185, v169
    v_mov_b32 v186, v170
    v_mov_b32 v187, v171
    v_permlane16_swap_b32 v164, v180
    v_permlane16_swap_b32 v165, v181
    v_permlane16_swap_b32 v166, v182
    v_permlane16_swap_b32 v167, v183
    v_permlane16_swap_b32 v168, v184
    v_permlane16_swap_b32 v169, v185
    v_permlane16_swap_b32 v170, v186
    v_permlane16_swap_b32 v171, v187
    v_add_f32 v164, v164, v180
    v_add_f32 v165, v165, v181
    v_add_f32 v166, v166, v182
    v_add_f32 v167, v167, v183
    v_add_f32 v168, v168, v184
    v_add_f32 v169, v169, v185
    v_add_f32 v170, v170, v186
    v_add_f32 v171, v171, v187
    v_cvt_pk_bf16_f32 v180, v164, v165
    v_cvt_pk_bf16_f32 v181, v166, v167
    v_cvt_pk_bf16_f32 v182, v168, v169
    v_cvt_pk_bf16_f32 v183, v170, v171
    v_lshlrev_b32 v164, 16, v180
    v_and_b32 v165, 0xffff0000, v180
    v_lshlrev_b32 v166, 16, v181
    v_and_b32 v167, 0xffff0000, v181
    v_lshlrev_b32 v168, 16, v182
    v_and_b32 v169, 0xffff0000, v182
    v_lshlrev_b32 v170, 16, v183
    v_and_b32 v171, 0xffff0000, v183
    v_add_f32 v168, 1.0, v168
    v_add_f32 v169, 1.0, v169
    v_add_f32 v170, 1.0, v170
    v_add_f32 v171, 1.0, v171
    v_cvt_pk_bf16_f32 v180, v168, v169
    v_cvt_pk_bf16_f32 v181, v170, v171
    v_lshlrev_b32 v168, 16, v180
    v_and_b32 v169, 0xffff0000, v180
    v_lshlrev_b32 v170, 16, v181
    v_and_b32 v171, 0xffff0000, v181
    ds_write_b128 v162, v[164:167] offset:0
    ds_write_b128 v162, v[168:171] offset:256
    s_waitcnt lgkmcnt(0)
wo7_x:
    s_mov_b32 s91, 0
    s_lshr_b32 s60, s45, 11
    s_lshl_b32 s60, 3, s60
f3_p0:
    s_andn2_b32 s61, s60, s91
    s_cbranch_scc0 f3_y0
    s_sub_u32 s90, s90, 1
    s_cbranch_scc1 f3_y0
    s_mov_b64 exec, 0xffff
    buffer_load_dword v253, v252, s[84:87], s89 offen sc1
    s_waitcnt vmcnt(0)
    v_cmp_eq_u32 vcc, s3, v253
    s_mov_b64 exec, -1
    s_mov_b32 s91, vcc_lo
    s_branch f3_p0
f3_y0:
    s_add_u32 m0, s48, 49152
    s_nop 0
    buffer_load_dwordx4 v5, s[8:11], s45 offen sc1 lds
    buffer_load_dwordx4 v5, s[8:11], s45 offen offset:1024 sc1 lds
    buffer_load_dwordx4 v5, s[8:11], s45 offen offset:2048 sc1 lds
    buffer_load_dwordx4 v5, s[8:11], s45 offen offset:3072 sc1 lds
    s_add_u32 m0, s48, 53248
    s_nop 0
    buffer_load_dwordx4 v6, s[8:11], s45 offen sc1 lds
    buffer_load_dwordx4 v6, s[8:11], s45 offen offset:1024 sc1 lds
    buffer_load_dwordx4 v6, s[8:11], s45 offen offset:2048 sc1 lds
    buffer_load_dwordx4 v6, s[8:11], s45 offen offset:3072 sc1 lds
    v_readlane_b32 s45, v3, 1
    s_nop 0
    s_lshr_b32 s60, s45, 11
    s_lshl_b32 s60, 3, s60
f3_p1:
    s_andn2_b32 s61, s60, s91
    s_cbranch_scc0 f3_y1
    s_sub_u32 s90, s90, 1
    s_cbranch_scc1 f3_y1
    s_mov_b64 exec, 0xffff
    buffer_load_dword v253, v252, s[84:87], s89 offen sc1
    s_waitcnt vmcnt(0)
    v_cmp_eq_u32 vcc, s3, v253
    s_mov_b64 exec, -1
    s_mov_b32 s91, vcc_lo
    s_branch f3_p1
f3_y1:
    s_add_u32 m0, s48, 98304
    s_nop 0
    buffer_load_dwordx4 v5, s[8:11], s45 offen sc1 lds
    buffer_load_dwordx4 v5, s[8:11], s45 offen offset:1024 sc1 lds
    buffer_load_dwordx4 v5, s[8:11], s45 offen offset:2048 sc1 lds
    buffer_load_dwordx4 v5, s[8:11], s45 offen offset:3072 sc1 lds
    s_waitcnt vmcnt(4)
    s_barrier
    s_add_u32 m0, s48, 102400
    s_nop 0
    buffer_load_dwordx4 v6, s[8:11], s45 offen sc1 lds
    buffer_load_dwordx4 v6, s[8:11], s45 offen offset:1024 sc1 lds
    buffer_load_dwordx4 v6, s[8:11], s45 offen offset:2048 sc1 lds
    buffer_load_dwordx4 v6, s[8:11], s45 offen offset:3072 sc1 lds
    v_readlane_b32 s45, v3, s52
    v_readlane_b32 s46, v4, s52
    s_add_u32 s52, s52, 1
    s_lshr_b32 s60, s45, 11
    s_lshl_b32 s60, 3, s60
f3_p2:
    s_andn2_b32 s61, s60, s91
    s_cbranch_scc0 f3_y2
    s_sub_u32 s90, s90, 1
    s_cbranch_scc1 f3_y2
    s_mov_b64 exec, 0xffff
    buffer_load_dword v253, v252, s[84:87], s89 offen sc1
    s_waitcnt vmcnt(0)
    v_cmp_eq_u32 vcc, s3, v253
    s_mov_b64 exec, -1
    s_mov_b32 s91, vcc_lo
    s_branch f3_p2
f3_y2:
    s_add_u32 m0, s48, 0
    s_nop 0
    buffer_load_dwordx4 v5, s[8:11], s45 offen sc1 lds
    buffer_load_dwordx4 v5, s[8:11], s45 offen offset:1024 sc1 lds
    buffer_load_dwordx4 v5, s[8:11], s45 offen offset:2048 sc1 lds
    buffer_load_dwordx4 v5, s[8:11], s45 offen offset:3072 sc1 lds
    s_add_u32 m0, s48, 4096
    s_nop 0
    buffer_load_dwordx4 v6, s[8:11], s45 offen sc1 lds
    buffer_load_dwordx4 v6, s[8:11], s45 offen offset:1024 sc1 lds
    buffer_load_dwordx4 v6, s[8:11], s45 offen offset:2048 sc1 lds
    buffer_load_dwordx4 v6, s[8:11], s45 offen offset:3072 sc1 lds
    s_add_u32 m0, s49, 0
    s_nop 0
    buffer_load_dwordx4 v9, s[12:15], s46 offen lds
    buffer_load_dwordx4 v11, s[12:15], s46 offen offset:1024 lds
    buffer_load_dwordx4 v12, s[12:15], s46 offen offset:2048 lds
    buffer_load_dwordx4 v13, s[12:15], s46 offen offset:3072 lds
    v_readlane_b32 s45, v3, s52
    v_readlane_b32 s46, v4, s52
    s_add_u32 s52, s52, 1
    s_mov_b32 s47, 49152
    s_waitcnt vmcnt(12)
    s_barrier
    s_lshr_b32 s60, s45, 11
    s_lshl_b32 s60, 3, s60
f3_p3:
    s_andn2_b32 s61, s60, s91
    s_cbranch_scc0 f3_y3
    s_sub_u32 s90, s90, 1
    s_cbranch_scc1 f3_y3
    s_mov_b64 exec, 0xffff
    buffer_load_dword v253, v252, s[84:87], s89 offen sc1
    s_waitcnt vmcnt(0)
    v_cmp_eq_u32 vcc, s3, v253
    s_mov_b64 exec, -1
    s_mov_b32 s91, vcc_lo
    s_branch f3_p3
f3_y3:
    s_add_u32 m0, s48, 49152
    s_nop 0
    buffer_load_dwordx4 v5, s[8:11], s45 offen sc1 lds
    buffer_load_dwordx4 v5, s[8:11], s45 offen offset:1024 sc1 lds
    buffer_load_dwordx4 v5, s[8:11], s45 offen offset:2048 sc1 lds
    buffer_load_dwordx4 v5, s[8:11], s45 offen offset:3072 sc1 lds
    s_add_u32 m0, s48, 53248
    s_nop 0
    buffer_load_dwordx4 v6, s[8:11], s45 offen sc1 lds
    buffer_load_dwordx4 v6, s[8:11], s45 offen offset:1024 sc1 lds
    buffer_load_dwordx4 v6, s[8:11], s45 offen offset:2048 sc1 lds
    buffer_load_dwordx4 v6, s[8:11], s45 offen offset:3072 sc1 lds
    s_add_u32 m0, s49, 49152
    s_nop 0
    buffer_load_dwordx4 v9, s[12:15], s46 offen lds
    buffer_load_dwordx4 v11, s[12:15], s46 offen offset:1024 lds
    buffer_load_dwordx4 v12, s[12:15], s46 offen offset:2048 lds
    buffer_load_dwordx4 v13, s[12:15], s46 offen offset:3072 lds
    v_readlane_b32 s45, v3, s52
    v_readlane_b32 s46, v4, s52
    s_add_u32 s52, s52, 1
    s_waitcnt vmcnt(12)
    s_barrier
    s_mov_b32 s60, 0xffff
f3_p4:
    s_andn2_b32 s61, s60, s91
    s_cbranch_scc0 f3_y4
    s_sub_u32 s90, s90, 1
    s_cbranch_scc1 f3_y4
    s_mov_b64 exec, 0xffff
    buffer_load_dword v253, v252, s[84:87], s89 offen sc1
    s_waitcnt vmcnt(0)
    v_cmp_eq_u32 vcc, s3, v253
    s_mov_b64 exec, -1
    s_mov_b32 s91, vcc_lo
    s_branch f3_p4
f3_y4:
    s_add_u32 m0, s48, 98304
    s_nop 0
    buffer_load_dwordx4 v5, s[8:11], s45 offen sc1 lds
    buffer_load_dwordx4 v5, s[8:11], s45 offen offset:1024 sc1 lds
    buffer_load_dwordx4 v5, s[8:11], s45 offen offset:2048 sc1 lds
    buffer_load_dwordx4 v5, s[8:11], s45 offen offset:3072 sc1 lds
    s_add_u32 m0, s48, 102400
    s_nop 0
    buffer_load_dwordx4 v6, s[8:11], s45 offen sc1 lds
    buffer_load_dwordx4 v6, s[8:11], s45 offen offset:1024 sc1 lds
    buffer_load_dwordx4 v6, s[8:11], s45 offen offset:2048 sc1 lds
    buffer_load_dwordx4 v6, s[8:11], s45 offen offset:3072 sc1 lds
    s_add_u32 m0, s49, 98304
    s_nop 0
    buffer_load_dwordx4 v9, s[12:15], s46 offen lds
    buffer_load_dwordx4 v11, s[12:15], s46 offen offset:1024 lds
    buffer_load_dwordx4 v12, s[12:15], s46 offen offset:2048 lds
    buffer_load_dwordx4 v13, s[12:15], s46 offen offset:3072 lds
    v_readlane_b32 s45, v3, s52
    v_readlane_b32 s46, v4, s52
    s_add_u32 s52, s52, 1
    s_waitcnt vmcnt(12)
    s_barrier
    s_add_u32 m0, s48, 0
    s_nop 0
    buffer_load_dwordx4 v5, s[8:11], s45 offen sc1 lds
    buffer_load_dwordx4 v5, s[8:11], s45 offen offset:1024 sc1 lds
    buffer_load_dwordx4 v5, s[8:11], s45 offen offset:2048 sc1 lds
    buffer_load_dwordx4 v5, s[8:11], s45 offen offset:3072 sc1 lds
    s_add_u32 m0, s48, 4096
    s_nop 0
    buffer_load_dwordx4 v6, s[8:11], s45 offen sc1 lds
    buffer_load_dwordx4 v6, s[8:11], s45 offen offset:1024 sc1 lds
    buffer_load_dwordx4 v6, s[8:11], s45 offen offset:2048 sc1 lds
    buffer_load_dwordx4 v6, s[8:11], s45 offen offset:3072 sc1 lds
    s_add_u32 m0, s49, 0
    s_nop 0
    buffer_load_dwordx4 v9, s[12:15], s46 offen lds
    buffer_load_dwordx4 v11, s[12:15], s46 offen offset:1024 lds
    buffer_load_dwordx4 v12, s[12:15], s46 offen offset:2048 lds
    buffer_load_dwordx4 v13, s[12:15], s46 offen offset:3072 lds
    v_readlane_b32 s45, v3, s52
    v_readlane_b32 s46, v4, s52
    s_add_u32 s52, s52, 1
    s_waitcnt vmcnt(12)
    s_barrier
    s_add_u32 m0, s48, 49152
    s_nop 0
    buffer_load_dwordx4 v5, s[8:11], s45 offen sc1 lds
    buffer_load_dwordx4 v5, s[8:11], s45 offen offset:1024 sc1 lds
    buffer_load_dwordx4 v5, s[8:11], s45 offen offset:2048 sc1 lds
    buffer_load_dwordx4 v5, s[8:11], s45 offen offset:3072 sc1 lds
    s_add_u32 m0, s48, 53248
    s_nop 0
    buffer_load_dwordx4 v6, s[8:11], s45 offen sc1 lds
    buffer_load_dwordx4 v6, s[8:11], s45 offen offset:1024 sc1 lds
    buffer_load_dwordx4 v6, s[8:11], s45 offen offset:2048 sc1 lds
    buffer_load_dwordx4 v6, s[8:11], s45 offen offset:3072 sc1 lds
    s_add_u32 m0, s49, 49152
    s_nop 0
    buffer_load_dwordx4 v9, s[12:15], s46 offen lds
    buffer_load_dwordx4 v11, s[12:15], s46 offen offset:1024 lds
    buffer_load_dwordx4 v12, s[12:15], s46 offen offset:2048 lds
    buffer_load_dwordx4 v13, s[12:15], s46 offen offset:3072 lds
    v_readlane_b32 s45, v3, s52
    v_readlane_b32 s46, v4, s52
    s_add_u32 s52, s52, 1
    s_waitcnt vmcnt(12)
    s_barrier
    s_add_u32 m0, s48, 98304
    s_nop 0
    buffer_load_dwordx4 v5, s[8:11], s45 offen sc1 lds
    buffer_load_dwordx4 v5, s[8:11], s45 offen offset:1024 sc1 lds
    buffer_load_dwordx4 v5, s[8:11], s45 offen offset:2048 sc1 lds
    buffer_load_dwordx4 v5, s[8:11], s45 offen offset:3072 sc1 lds
    s_add_u32 m0, s48, 102400
    s_nop 0
    buffer_load_dwordx4 v6, s[8:11], s45 offen sc1 lds
    buffer_load_dwordx4 v6, s[8:11], s45 offen offset:1024 sc1 lds
    buffer_load_dwordx4 v6, s[8:11], s45 offen offset:2048 sc1 lds
    buffer_load_dwordx4 v6, s[8:11], s45 offen offset:3072 sc1 lds
    s_add_u32 m0, s49, 98304
    s_nop 0
    buffer_load_dwordx4 v9, s[12:15], s46 offen lds
    buffer_load_dwordx4 v11, s[12:15], s46 offen offset:1024 lds
    buffer_load_dwordx4 v12, s[12:15], s46 offen offset:2048 lds
    buffer_load_dwordx4 v13, s[12:15], s46 offen offset:3072 lds
    s_mov_b32 s16, s32
    s_mov_b32 s17, s33
    s_mov_b32 s18, 4194304
    s_mov_b32 s19, 0x20000
    v_xor_b32 v14, v7, v10
    v_lshlrev_b32 v14, 4, v14
    v_lshl_add_u32 v14, v7, 11, v14
    s_sub_u32 s59, s42, 4
    s_lshl_b32 s60, s40, 2
    s_add_u32 s60, s60, s59
    s_lshl_b32 s60, s60, 16
    s_lshl_b32 s61, s41, 7
    s_add_u32 s60, s60, s61
    s_lshl_b32 s59, s59, 12
    s_add_u32 s59, s59, 147456
    s_add_u32 m0, s59, 0
    s_nop 0
    buffer_load_dwordx4 v14, s[16:19], s60 offen lds
    s_add_u32 s60, s60, 16384
    s_add_u32 m0, s59, 1024
    s_nop 0
    buffer_load_dwordx4 v14, s[16:19], s60 offen lds
    s_add_u32 s60, s60, 16384
    s_add_u32 m0, s59, 2048
    s_nop 0
    buffer_load_dwordx4 v14, s[16:19], s60 offen lds
    s_add_u32 s60, s60, 16384
    s_add_u32 m0, s59, 3072
    s_nop 0
    buffer_load_dwordx4 v14, s[16:19], s60 offen lds
    s_add_u32 s60, s60, 16384
    s_waitcnt vmcnt(16)
    s_barrier
    s_waitcnt vmcnt(4)
    s_waitcnt vmcnt(0)
    s_barrier
    s_mov_b32 s93, s40
    s_mov_b32 s97, s41
    s_load_dwordx2 s[4:5], s[0:1], 40
    s_load_dwordx2 s[34:35], s[0:1], 56
    s_and_b32 s36, s2, 7
    s_lshr_b32 s37, s2, 3
    s_and_b32 s38, s36, 1
    s_lshr_b32 s36, s36, 1
    s_and_b32 s39, s37, 7
    s_lshr_b32 s37, s37, 3
    s_mul_i32 s38, s38, 8
    s_add_u32 s40, s38, s39
    s_mul_i32 s36, s36, 4
    s_add_u32 s41, s36, s37
    s_add_u32 s39, s39, s37
    s_and_b32 s39, s39, 3
    s_mul_i32 s43, s41, 448
    s_and_b32 s36, s41, 1
    s_cmp_eq_u32 s36, 0
    s_cselect_b32 s36, 384, 0
    s_cselect_b32 s37, 0, 64
    s_add_u32 s44, s43, s36
    s_add_u32 s43, s43, s37
    s_lshr_b32 s61, s2, 3
    s_lshr_b32 s62, s61, 3
    s_add_u32 s62, s62, s61
    s_and_b32 s62, s62, 3
    s_cmp_eq_u32 s62, 0
    s_cselect_b32 s63, 4, s62
    s_lshl_b32 s64, s62, 2
    s_lshr_b32 s64, 0x1431, s64
    s_and_b32 s64, s64, 15
    s_add_u32 s65, s62, 1
    s_and_b32 s65, s65, 3
    s_add_u32 s62, s63, 3
    s_bitcmp1_b32 s61, 2
    s_cselect_b32 s64, s63, s64
    s_cselect_b32 s65, s62, s65
    s_and_b32 s61, s2, 1
    s_lshl_b32 s61, s61, 3
    s_add_u32 s65, s65, s61
    s_add_u32 s92, s64, 1
    s_lshr_b32 s38, s40, 3
    s_sub_u32 s54, s42, 4
    s_getpc_b64 s[66:67]
w1_pc:
    s_add_u32 s66, s66, w1_tab-w1_pc
    s_addc_u32 s67, s67, 0
    s_lshl_b32 s55, s39, 6
    s_lshl_b32 s56, s38, 8
    s_add_u32 s55, s55, s56
    s_mul_i32 s56, s38, 8
    s_add_u32 s39, s39, s56
    v_add_u32 v2, s55, v1
    global_load_ubyte v3, v2, s[66:67]
    s_mul_i32 s55, s40, 8
    s_mul_i32 s56, s54, 2
    s_add_u32 s55, s55, s56
    s_mul_i32 s55, s55, 32768
    v_lshl_add_u32 v5, v1, 4, s55
    s_mul_i32 s48, s54, 4096
    v_add_u32 v6, 30720, v5
    v_lshrrev_b32 v7, 3, v1
    v_and_b32 v10, 7, v1
    v_and_b32 v8, 2, v7
    v_xor_b32 v9, v10, v8
    v_mul_u32_u24 v8, 7168, v7
    s_mul_i32 s55, s54, 114688
    s_add_u32 s56, s55, s43
    v_add_u32 v8, s56, v8
    v_xor_b32 v11, 4, v9
    v_lshl_add_u32 v11, v11, 4, v8
    v_lshl_add_u32 v9, v9, 4, v8
    s_mul_i32 s49, s54, 2048
    s_add_u32 s49, s49, 16384
    v_add_u32 v12, 56320, v11
    v_add_u32 v13, 128, v9
    v_add_u32 v14, 56448, v11
    v_add_u32 v15, 256, v9
    v_add_u32 v16, 56576, v11
    v_lshrrev_b32 v18, 2, v1
    v_lshrrev_b32 v8, 4, v1
    v_and_b32 v8, 2, v8
    v_and_b32 v17, 3, v1
    v_xor_b32 v17, v17, v8
    v_mul_u32_u24 v18, 7168, v18
    v_lshl_add_u32 v17, v17, 4, v18
    s_add_u32 s56, s55, s44
    v_add_u32 v17, s56, v17
    s_mul_i32 s50, s54, 1024
    s_add_u32 s50, s50, 40960
    s_mul_i32 s45, s39, 2048
    s_mul_i32 s46, s39, 458752
    s_mov_b32 s52, 1
    s_waitcnt lgkmcnt(0)
    s_add_u32 s8, s6, 33554432
    s_addc_u32 s9, s7, 0
    s_mov_b32 s10, 4194304
    s_mov_b32 s11, 0x20000
    s_mov_b32 s12, s4
    s_mov_b32 s13, s5
    s_mov_b32 s14, 7340032
    s_mov_b32 s15, 0x20000
    s_add_u32 s84, s6, 524288
    s_addc_u32 s85, s7, 0
    s_mov_b32 s86, 327680
    s_mov_b32 s87, 0x20000
    s_lshl_b32 s88, s93, 11
    s_add_u32 s88, s88, 163840
    s_lshl_b32 s89, s40, 11
    s_add_u32 s89, s89, 163840
    s_lshl_b32 s90, s97, 7
    s_add_u32 s88, s88, s90
    v_lshlrev_b32 v252, 7, v1
    v_mov_b32 v253, s3
    s_mov_b32 s90, 200000
    s_barrier
    s_cmp_lg_u32 s42, 4
    s_cbranch_scc1 f5_s5
    s_mov_b64 exec, 1
    buffer_store_dword v253, v252, s[84:87], s88 offen sc1
    s_mov_b64 exec, -1
f5_s5:
    s_add_u32 s20, s6, 65536
    s_addc_u32 s21, s7, 0
    s_mov_b32 s22, 65536
    s_mov_b32 s23, 0x20000
    s_add_u32 s24, s6, 262144
    s_addc_u32 s25, s7, 0
    s_mov_b32 s26, 262144
    s_mov_b32 s27, 0x20000
    s_add_u32 s16, s6, 950272
    s_addc_u32 s17, s7, 0
    s_mov_b32 s18, 32768
    s_mov_b32 s19, 0x20000
    v_lshrrev_b32 v21, 4, v1
    v_lshlrev_b32 v21, 14, v21
    v_and_b32 v22, 15, v1
    v_lshl_add_u32 v21, v22, 4, v21
    s_lshl_b32 s61, s65, 8
    s_add_u32 s61, s61, 8192
    buffer_load_dwordx4 v[24:27], v21, s[20:23], s61 offen sc1
    s_lshl_b32 s61, s65, 8
    s_add_u32 s61, s61, 4096
    buffer_load_dwordx4 v[28:31], v21, s[20:23], s61 offen sc1
    s_add_u32 m0, s49, 0
    s_nop 0
    buffer_load_dwordx4 v9, s[12:15], s46 offen lds
    buffer_load_dwordx4 v12, s[12:15], s46 offen offset:1024 lds
    s_add_u32 m0, s49, 8192
    s_nop 0
    buffer_load_dwordx4 v13, s[12:15], s46 offen lds
    buffer_load_dwordx4 v14, s[12:15], s46 offen offset:1024 lds
    s_add_u32 m0, s49, 16384
    s_nop 0
    buffer_load_dwordx4 v15, s[12:15], s46 offen lds
    buffer_load_dwordx4 v16, s[12:15], s46 offen offset:1024 lds
    s_add_u32 m0, s50, 0
    s_nop 0
    buffer_load_dwordx4 v17, s[12:15], s46 offen lds
    s_waitcnt vmcnt(9)
    v_mul_u32_u24 v4, 458752, v3
    v_mul_u32_u24 v3, 2048, v3
    v_readlane_b32 s46, v4, 1
    s_mov_b32 s52, 2
    s_add_u32 m0, s49, 45056
    s_nop 2
    buffer_load_dwordx4 v9, s[12:15], s46 offen lds
    buffer_load_dwordx4 v12, s[12:15], s46 offen offset:1024 lds
    s_add_u32 m0, s49, 53248
    s_nop 0
    buffer_load_dwordx4 v13, s[12:15], s46 offen lds
    buffer_load_dwordx4 v14, s[12:15], s46 offen offset:1024 lds
    s_add_u32 m0, s49, 61440
    s_nop 0
    buffer_load_dwordx4 v15, s[12:15], s46 offen lds
    buffer_load_dwordx4 v16, s[12:15], s46 offen offset:1024 lds
    s_add_u32 m0, s50, 45056
    s_nop 0
    buffer_load_dwordx4 v17, s[12:15], s46 offen lds
    v_readlane_b32 s37, v3, 1
    s_lshr_b32 s36, s45, 11
    s_lshr_b32 s37, s37, 11
    s_waitcnt vmcnt(14)
    s_mov_b32 s28, s34
    s_mov_b32 s29, s35
    s_mov_b32 s30, 7340032
    s_mov_b32 s31, 0x20000
    v_lshlrev_b32 v19, 11, v7
    v_lshl_add_u32 v19, v10, 7, v19
    s_bfe_u32 s62, s2, 0x10002
    s_lshl_b32 s62, s62, 1
    s_and_b32 s63, s2, 1
    s_add_u32 s62, s62, s63
    s_mul_i32 s62, s62, 896
    s_lshr_b32 s61, s2, 3
    s_mul_i32 s61, s61, 28
    s_add_u32 s62, s62, s61
    s_sub_u32 s61, s42, 4
    s_lshl_b32 s61, s61, 3
    s_add_u32 s62, s62, s61
    s_lshl_b32 s62, s62, 11
    s_bfe_u32 s63, s2, 0x10001
    s_lshl_b32 s63, s63, 10
    s_add_u32 s62, s62, s63
    s_mov_b64 exec, 0xffff
    buffer_load_dword v251, v19, s[28:31], s62 offen
    s_mov_b64 exec, -1
    v_mov_b32 v40, 0
    v_mov_b32 v41, 0
    v_mov_b32 v42, 0
    v_mov_b32 v43, 0
    v_lshlrev_b32 v23, 4, v1
    v_add_u32 v23, 135168, v23
    ds_write_b128 v23, v[40:43]
    ds_write_b128 v23, v[40:43] offset:1024
    v_mov_b32 v32, v24
    v_mov_b32 v33, v25
    v_mov_b32 v34, v26
    v_mov_b32 v35, v27
    v_mov_b32 v36, v28
    v_mov_b32 v37, v29
    v_mov_b32 v38, v30
    v_mov_b32 v39, v31
    v_permlane32_swap_b32 v24, v32
    v_permlane32_swap_b32 v25, v33
    v_permlane32_swap_b32 v26, v34
    v_permlane32_swap_b32 v27, v35
    v_permlane32_swap_b32 v28, v36
    v_permlane32_swap_b32 v29, v37
    v_permlane32_swap_b32 v30, v38
    v_permlane32_swap_b32 v31, v39
    v_add_f32 v24, v24, v32
    v_add_f32 v25, v25, v33
    v_add_f32 v26, v26, v34
    v_add_f32 v27, v27, v35
    v_add_f32 v28, v28, v36
    v_add_f32 v29, v29, v37
    v_add_f32 v30, v30, v38
    v_add_f32 v31, v31, v39
    v_mov_b32 v32, v24
    v_mov_b32 v33, v25
    v_mov_b32 v34, v26
    v_mov_b32 v35, v27
    v_mov_b32 v36, v28
    v_mov_b32 v37, v29
    v_mov_b32 v38, v30
    v_mov_b32 v39, v31
    v_permlane16_swap_b32 v24, v32
    v_permlane16_swap_b32 v25, v33
    v_permlane16_swap_b32 v26, v34
    v_permlane16_swap_b32 v27, v35
    v_permlane16_swap_b32 v28, v36
    v_permlane16_swap_b32 v29, v37
    v_permlane16_swap_b32 v30, v38
    v_permlane16_swap_b32 v31, v39
    v_add_f32 v24, v24, v32
    v_add_f32 v25, v25, v33
    v_add_f32 v26, v26, v34
    v_add_f32 v27, v27, v35
    v_add_f32 v28, v28, v36
    v_add_f32 v29, v29, v37
    v_add_f32 v30, v30, v38
    v_add_f32 v31, v31, v39
    v_cvt_pk_bf16_f32 v32, v24, v25
    v_cvt_pk_bf16_f32 v33, v26, v27
    v_lshlrev_b32 v24, 16, v32
    v_and_b32 v25, 0xffff0000, v32
    v_lshlrev_b32 v26, 16, v33
    v_and_b32 v27, 0xffff0000, v33
    v_add_f32 v24, 1.0, v24
    v_add_f32 v25, 1.0, v25
    v_add_f32 v26, 1.0, v26
    v_add_f32 v27, 1.0, v27
    v_cvt_pk_bf16_f32 v32, v24, v25
    v_cvt_pk_bf16_f32 v33, v26, v27
    v_cvt_pk_bf16_f32 v34, v28, v29
    v_cvt_pk_bf16_f32 v35, v30, v31
    v_lshrrev_b32 v23, 1, v22
    v_lshlrev_b32 v23, 8, v23
    v_and_b32 v22, 1, v22
    v_lshl_add_u32 v23, v22, 3, v23
    v_add_u32 v23, 135168, v23
    ds_write_b64 v23, v[32:33]
    ds_write_b64 v23, v[34:35] offset:16
    s_waitcnt lgkmcnt(0)
    s_cmp_lg_u32 s42, 5
    s_cbranch_scc1 f5_sx
    s_mov_b64 exec, 0xffff
    buffer_load_dword v253, v252, s[84:87], s89 offen sc1
f5_sp:
    buffer_load_dword v254, v252, s[84:87], s89 offen sc1
    s_sub_u32 s90, s90, 1
    s_waitcnt vmcnt(1)
    v_cmp_ne_u32 vcc, s3, v253
    s_nop 0
    s_cmp_eq_u64 vcc, 0
    s_cbranch_scc1 f5_sy
    buffer_load_dword v253, v252, s[84:87], s89 offen sc1
    s_waitcnt vmcnt(1)
    v_cmp_ne_u32 vcc, s3, v254
    s_nop 0
    s_cmp_eq_u64 vcc, 0
    s_cbranch_scc1 f5_sy
    s_cmp_lg_u32 s90, 0
    s_cbranch_scc1 f5_sp
f5_sy:
    s_mov_b64 exec, -1
f5_sx:
    s_barrier
    s_add_u32 m0, s48, 0
    s_nop 0
    buffer_load_dwordx4 v5, s[8:11], s45 offen sc1 lds
    buffer_load_dwordx4 v5, s[8:11], s45 offen offset:1024 sc1 lds
    buffer_load_dwordx4 v6, s[8:11], s45 offen offset:2048 sc1 lds
    buffer_load_dwordx4 v6, s[8:11], s45 offen offset:3072 sc1 lds
    v_readlane_b32 s45, v3, 1
    s_add_u32 m0, s48, 45056
    s_nop 3
    buffer_load_dwordx4 v5, s[8:11], s45 offen sc1 lds
    buffer_load_dwordx4 v5, s[8:11], s45 offen offset:1024 sc1 lds
    buffer_load_dwordx4 v6, s[8:11], s45 offen offset:2048 sc1 lds
    buffer_load_dwordx4 v6, s[8:11], s45 offen offset:3072 sc1 lds
    s_waitcnt vmcnt(4)
    s_barrier
    v_readlane_b32 s45, v3, s52
    v_readlane_b32 s46, v4, s52
    s_add_u32 s52, s52, 1
    s_add_u32 m0, s48, 90112
    s_nop 1
    buffer_load_dwordx4 v5, s[8:11], s45 offen sc1 lds
    buffer_load_dwordx4 v5, s[8:11], s45 offen offset:1024 sc1 lds
    buffer_load_dwordx4 v6, s[8:11], s45 offen offset:2048 sc1 lds
    buffer_load_dwordx4 v6, s[8:11], s45 offen offset:3072 sc1 lds
    s_add_u32 m0, s49, 90112
    s_nop 0
    buffer_load_dwordx4 v9, s[12:15], s46 offen lds
    buffer_load_dwordx4 v12, s[12:15], s46 offen offset:1024 lds
    s_add_u32 m0, s49, 98304
    s_nop 0
    buffer_load_dwordx4 v13, s[12:15], s46 offen lds
    buffer_load_dwordx4 v14, s[12:15], s46 offen offset:1024 lds
    s_add_u32 m0, s49, 106496
    s_nop 0
    buffer_load_dwordx4 v15, s[12:15], s46 offen lds
    buffer_load_dwordx4 v16, s[12:15], s46 offen offset:1024 lds
    s_add_u32 m0, s50, 90112
    s_nop 0
    buffer_load_dwordx4 v17, s[12:15], s46 offen lds
    v_readlane_b32 s45, v3, s52
    v_readlane_b32 s46, v4, s52
    s_add_u32 s52, s52, 1
    s_mov_b32 s47, 0
    s_waitcnt vmcnt(11)
    s_barrier
    s_lshl_b32 s95, s41, 11
    s_add_u32 s95, s95, 131072
    s_lshl_b32 s94, s40, 7
    s_add_u32 s95, s95, s94
    v_mov_b32 v253, s3
    s_sub_u32 s94, s42, 4
    s_lshl_b32 s94, s94, 9
    v_lshl_add_u32 v68, v1, 2, s94
    v_add_u32 v69, 138240, v68
    s_lshl_b32 s94, s41, 11
    s_add_u32 s96, s92, 1
    s_sub_u32 s60, s42, 4
    s_lshl_b32 s60, s60, 5
    s_add_u32 s95, s95, s60
    s_add_u32 m0, s48, 0
    s_nop 0
    buffer_load_dwordx4 v5, s[8:11], s45 offen sc1 lds
    buffer_load_dwordx4 v5, s[8:11], s45 offen offset:1024 sc1 lds
    buffer_load_dwordx4 v6, s[8:11], s45 offen offset:2048 sc1 lds
    buffer_load_dwordx4 v6, s[8:11], s45 offen offset:3072 sc1 lds
    s_add_u32 m0, s49, 0
    s_nop 0
    buffer_load_dwordx4 v9, s[12:15], s46 offen lds
    buffer_load_dwordx4 v12, s[12:15], s46 offen offset:1024 lds
    s_add_u32 m0, s49, 8192
    s_nop 0
    buffer_load_dwordx4 v13, s[12:15], s46 offen lds
    buffer_load_dwordx4 v14, s[12:15], s46 offen offset:1024 lds
    s_add_u32 m0, s49, 16384
    s_nop 0
    buffer_load_dwordx4 v15, s[12:15], s46 offen lds
    buffer_load_dwordx4 v16, s[12:15], s46 offen offset:1024 lds
    s_add_u32 m0, s50, 0
    s_nop 0
    buffer_load_dwordx4 v17, s[12:15], s46 offen lds
    v_readlane_b32 s45, v3, s52
    v_readlane_b32 s46, v4, s52
    s_add_u32 s52, s52, 1
    s_waitcnt vmcnt(11)
    s_barrier
    s_cmp_lg_u32 s92, 2
    s_cbranch_scc1 w1_np2
    ds_read_b32 v70, v69
    ds_read_b32 v71, v69 offset:256
    s_waitcnt lgkmcnt(0)
    buffer_atomic_add_f32 v70, v68, s[16:19], s94 offen
    buffer_atomic_add_f32 v71, v68, s[16:19], s94 offen offset:256
w1_np2:
    s_add_u32 m0, s48, 45056
    s_nop 0
    buffer_load_dwordx4 v5, s[8:11], s45 offen sc1 lds
    buffer_load_dwordx4 v5, s[8:11], s45 offen offset:1024 sc1 lds
    buffer_load_dwordx4 v6, s[8:11], s45 offen offset:2048 sc1 lds
    buffer_load_dwordx4 v6, s[8:11], s45 offen offset:3072 sc1 lds
    s_add_u32 m0, s49, 45056
    s_nop 0
    buffer_load_dwordx4 v9, s[12:15], s46 offen lds
    buffer_load_dwordx4 v12, s[12:15], s46 offen offset:1024 lds
    s_add_u32 m0, s49, 53248
    s_nop 0
    buffer_load_dwordx4 v13, s[12:15], s46 offen lds
    buffer_load_dwordx4 v14, s[12:15], s46 offen offset:1024 lds
    s_add_u32 m0, s49, 61440
    s_nop 0
    buffer_load_dwordx4 v15, s[12:15], s46 offen lds
    buffer_load_dwordx4 v16, s[12:15], s46 offen offset:1024 lds
    s_add_u32 m0, s50, 45056
    s_nop 0
    buffer_load_dwordx4 v17, s[12:15], s46 offen lds
    v_readlane_b32 s45, v3, s52
    v_readlane_b32 s46, v4, s52
    s_add_u32 s52, s52, 1
    s_waitcnt vmcnt(11)
    s_barrier
    s_cmp_lg_u32 s92, 3
    s_cbranch_scc1 w1_np3
    ds_read_b32 v70, v69
    ds_read_b32 v71, v69 offset:256
    s_waitcnt lgkmcnt(0)
    buffer_atomic_add_f32 v70, v68, s[16:19], s94 offen
    buffer_atomic_add_f32 v71, v68, s[16:19], s94 offen offset:256
w1_np3:
    s_add_u32 m0, s48, 90112
    s_nop 0
    buffer_load_dwordx4 v5, s[8:11], s45 offen sc1 lds
    buffer_load_dwordx4 v5, s[8:11], s45 offen offset:1024 sc1 lds
    buffer_load_dwordx4 v6, s[8:11], s45 offen offset:2048 sc1 lds
    buffer_load_dwordx4 v6, s[8:11], s45 offen offset:3072 sc1 lds
    s_add_u32 m0, s49, 90112
    s_nop 0
    buffer_load_dwordx4 v9, s[12:15], s46 offen lds
    buffer_load_dwordx4 v12, s[12:15], s46 offen offset:1024 lds
    s_add_u32 m0, s49, 98304
    s_nop 0
    buffer_load_dwordx4 v13, s[12:15], s46 offen lds
    buffer_load_dwordx4 v14, s[12:15], s46 offen offset:1024 lds
    s_add_u32 m0, s49, 106496
    s_nop 0
    buffer_load_dwordx4 v15, s[12:15], s46 offen lds
    buffer_load_dwordx4 v16, s[12:15], s46 offen offset:1024 lds
    s_add_u32 m0, s50, 90112
    s_nop 0
    buffer_load_dwordx4 v17, s[12:15], s46 offen lds
    v_readlane_b32 s45, v3, s52
    v_readlane_b32 s46, v4, s52
    s_add_u32 s52, s52, 1
    s_waitcnt vmcnt(11)
    s_barrier
    s_cmp_lg_u32 s92, 4
    s_cbranch_scc1 w1_np4
    ds_read_b32 v70, v69
    ds_read_b32 v71, v69 offset:256
    s_waitcnt lgkmcnt(0)
    buffer_atomic_add_f32 v70, v68, s[16:19], s94 offen
    buffer_atomic_add_f32 v71, v68, s[16:19], s94 offen offset:256
w1_np4:
    s_cmp_lg_u32 s96, 3
    s_cbranch_scc1 w1_ns4
    s_mov_b64 exec, 1
    buffer_store_dword v253, v252, s[84:87], s95 offen sc1
    s_mov_b64 exec, -1
w1_ns4:
    s_add_u32 m0, s48, 0
    s_nop 0
    buffer_load_dwordx4 v5, s[8:11], s45 offen sc1 lds
    buffer_load_dwordx4 v5, s[8:11], s45 offen offset:1024 sc1 lds
    buffer_load_dwordx4 v6, s[8:11], s45 offen offset:2048 sc1 lds
    buffer_load_dwordx4 v6, s[8:11], s45 offen offset:3072 sc1 lds
    s_add_u32 m0, s49, 0
    s_nop 0
    buffer_load_dwordx4 v9, s[12:15], s46 offen lds
    buffer_load_dwordx4 v12, s[12:15], s46 offen offset:1024 lds
    s_add_u32 m0, s49, 8192
    s_nop 0
    buffer_load_dwordx4 v13, s[12:15], s46 offen lds
    buffer_load_dwordx4 v14, s[12:15], s46 offen offset:1024 lds
    s_add_u32 m0, s49, 16384
    s_nop 0
    buffer_load_dwordx4 v15, s[12:15], s46 offen lds
    buffer_load_dwordx4 v16, s[12:15], s46 offen offset:1024 lds
    s_add_u32 m0, s50, 0
    s_nop 0
    buffer_load_dwordx4 v17, s[12:15], s46 offen lds
    v_readlane_b32 s45, v3, s52
    v_readlane_b32 s46, v4, s52
    s_add_u32 s52, s52, 1
    s_waitcnt vmcnt(11)
    s_barrier
    s_cmp_lg_u32 s92, 5
    s_cbranch_scc1 w1_np5
    ds_read_b32 v70, v69
    ds_read_b32 v71, v69 offset:256
    s_waitcnt lgkmcnt(0)
    buffer_atomic_add_f32 v70, v68, s[16:19], s94 offen
    buffer_atomic_add_f32 v71, v68, s[16:19], s94 offen offset:256
w1_np5:
    s_cmp_lg_u32 s96, 4
    s_cbranch_scc1 w1_ns5
    s_mov_b64 exec, 1
    buffer_store_dword v253, v252, s[84:87], s95 offen sc1
    s_mov_b64 exec, -1
w1_ns5:
    s_add_u32 m0, s48, 45056
    s_nop 0
    buffer_load_dwordx4 v5, s[8:11], s45 offen sc1 lds
    buffer_load_dwordx4 v5, s[8:11], s45 offen offset:1024 sc1 lds
    buffer_load_dwordx4 v6, s[8:11], s45 offen offset:2048 sc1 lds
    buffer_load_dwordx4 v6, s[8:11], s45 offen offset:3072 sc1 lds
    s_add_u32 m0, s49, 45056
    s_nop 0
    buffer_load_dwordx4 v9, s[12:15], s46 offen lds
    buffer_load_dwordx4 v12, s[12:15], s46 offen offset:1024 lds
    s_add_u32 m0, s49, 53248
    s_nop 0
    buffer_load_dwordx4 v13, s[12:15], s46 offen lds
    buffer_load_dwordx4 v14, s[12:15], s46 offen offset:1024 lds
    s_add_u32 m0, s49, 61440
    s_nop 0
    buffer_load_dwordx4 v15, s[12:15], s46 offen lds
    buffer_load_dwordx4 v16, s[12:15], s46 offen offset:1024 lds
    s_add_u32 m0, s50, 45056
    s_nop 0
    buffer_load_dwordx4 v17, s[12:15], s46 offen lds
    v_readlane_b32 s45, v3, s52
    v_readlane_b32 s46, v4, s52
    s_add_u32 s52, s52, 1
    s_waitcnt vmcnt(11)
    s_barrier
    s_cmp_lg_u32 s96, 5
    s_cbranch_scc1 w1_ns6
    s_mov_b64 exec, 1
    buffer_store_dword v253, v252, s[84:87], s95 offen sc1
    s_mov_b64 exec, -1
w1_ns6:
    s_add_u32 m0, s48, 90112
    s_nop 0
    buffer_load_dwordx4 v5, s[8:11], s45 offen sc1 lds
    buffer_load_dwordx4 v5, s[8:11], s45 offen offset:1024 sc1 lds
    buffer_load_dwordx4 v6, s[8:11], s45 offen offset:2048 sc1 lds
    buffer_load_dwordx4 v6, s[8:11], s45 offen offset:3072 sc1 lds
    s_add_u32 m0, s49, 90112
    s_nop 0
    buffer_load_dwordx4 v9, s[12:15], s46 offen lds
    buffer_load_dwordx4 v12, s[12:15], s46 offen offset:1024 lds
    s_add_u32 m0, s49, 98304
    s_nop 0
    buffer_load_dwordx4 v13, s[12:15], s46 offen lds
    buffer_load_dwordx4 v14, s[12:15], s46 offen offset:1024 lds
    s_add_u32 m0, s49, 106496
    s_nop 0
    buffer_load_dwordx4 v15, s[12:15], s46 offen lds
    buffer_load_dwordx4 v16, s[12:15], s46 offen offset:1024 lds
    s_add_u32 m0, s50, 90112
    s_nop 0
    buffer_load_dwordx4 v17, s[12:15], s46 offen lds
    v_readlane_b32 s45, v3, s52
    v_readlane_b32 s46, v4, s52
    s_add_u32 s52, s52, 1
    s_waitcnt vmcnt(11)
    s_barrier
    s_cmp_lg_u32 s96, 6
    s_cbranch_scc1 w1_ns7
    s_mov_b64 exec, 1
    buffer_store_dword v253, v252, s[84:87], s95 offen sc1
    s_mov_b64 exec, -1
w1_ns7:
    s_add_u32 m0, s48, 0
    s_nop 0
    buffer_load_dwordx4 v5, s[8:11], s45 offen sc1 lds
    buffer_load_dwordx4 v5, s[8:11], s45 offen offset:1024 sc1 lds
    buffer_load_dwordx4 v6, s[8:11], s45 offen offset:2048 sc1 lds
    buffer_load_dwordx4 v6, s[8:11], s45 offen offset:3072 sc1 lds
    s_add_u32 m0, s49, 0
    s_nop 0
    buffer_load_dwordx4 v9, s[12:15], s46 offen lds
    buffer_load_dwordx4 v12, s[12:15], s46 offen offset:1024 lds
    s_add_u32 m0, s49, 8192
    s_nop 0
    buffer_load_dwordx4 v13, s[12:15], s46 offen lds
    buffer_load_dwordx4 v14, s[12:15], s46 offen offset:1024 lds
    s_add_u32 m0, s49, 16384
    s_nop 0
    buffer_load_dwordx4 v15, s[12:15], s46 offen lds
    buffer_load_dwordx4 v16, s[12:15], s46 offen offset:1024 lds
    s_add_u32 m0, s50, 0
    s_nop 0
    buffer_load_dwordx4 v17, s[12:15], s46 offen lds
    v_readlane_b32 s45, v3, s52
    v_readlane_b32 s46, v4, s52
    s_add_u32 s52, s52, 1
    s_add_u32 s28, s6, 29360128
    s_addc_u32 s29, s7, 0
    s_mov_b32 s30, 4194304
    s_mov_b32 s31, 0x20000
    s_sub_u32 s60, s42, 4
    s_lshl_b32 s61, s60, 12
    s_add_u32 s61, s61, 147456
    v_lshl_add_u32 v72, v1, 4, s61
    v_lshlrev_b32 v73, 4, v1
    ds_read_b128 v[76:79], v72 offset:0
    ds_read_b128 v[80:83], v72 offset:1024
    ds_read_b128 v[84:87], v72 offset:2048
    ds_read_b128 v[88:91], v72 offset:3072
    s_lshl_b32 s61, s93, 2
    s_add_u32 s60, s60, s61
    s_lshl_b32 s60, s60, 16
    s_lshl_b32 s61, s97, 11
    s_add_u32 s60, s60, s61
    s_add_u32 s61, s60, 32768
    s_waitcnt lgkmcnt(0)
    buffer_store_dwordx4 v[76:79], v73, s[28:31], s60 offen offset:0 sc1
    buffer_store_dwordx4 v[80:83], v73, s[28:31], s60 offen offset:1024 sc1
    buffer_store_dwordx4 v[84:87], v73, s[28:31], s61 offen offset:0 sc1
    buffer_store_dwordx4 v[88:91], v73, s[28:31], s61 offen offset:1024 sc1
    s_waitcnt vmcnt(15)
    s_barrier
    s_add_u32 m0, s48, 45056
    s_nop 0
    buffer_load_dwordx4 v5, s[8:11], s45 offen sc1 lds
    buffer_load_dwordx4 v5, s[8:11], s45 offen offset:1024 sc1 lds
    buffer_load_dwordx4 v6, s[8:11], s45 offen offset:2048 sc1 lds
    buffer_load_dwordx4 v6, s[8:11], s45 offen offset:3072 sc1 lds
    s_add_u32 m0, s49, 45056
    s_nop 0
    buffer_load_dwordx4 v9, s[12:15], s46 offen lds
    buffer_load_dwordx4 v12, s[12:15], s46 offen offset:1024 lds
    s_add_u32 m0, s49, 53248
    s_nop 0
    buffer_load_dwordx4 v13, s[12:15], s46 offen lds
    buffer_load_dwordx4 v14, s[12:15], s46 offen offset:1024 lds
    s_add_u32 m0, s49, 61440
    s_nop 0
    buffer_load_dwordx4 v15, s[12:15], s46 offen lds
    buffer_load_dwordx4 v16, s[12:15], s46 offen offset:1024 lds
    s_add_u32 m0, s50, 45056
    s_nop 0
    buffer_load_dwordx4 v17, s[12:15], s46 offen lds
    v_readlane_b32 s45, v3, s52
    v_readlane_b32 s46, v4, s52
    s_add_u32 s52, s52, 1
    s_waitcnt vmcnt(15)
    s_barrier
    s_add_u32 m0, s48, 90112
    s_nop 0
    buffer_load_dwordx4 v5, s[8:11], s45 offen sc1 lds
    buffer_load_dwordx4 v5, s[8:11], s45 offen offset:1024 sc1 lds
    buffer_load_dwordx4 v6, s[8:11], s45 offen offset:2048 sc1 lds
    buffer_load_dwordx4 v6, s[8:11], s45 offen offset:3072 sc1 lds
    s_add_u32 m0, s49, 90112
    s_nop 0
    buffer_load_dwordx4 v9, s[12:15], s46 offen lds
    buffer_load_dwordx4 v12, s[12:15], s46 offen offset:1024 lds
    s_add_u32 m0, s49, 98304
    s_nop 0
    buffer_load_dwordx4 v13, s[12:15], s46 offen lds
    buffer_load_dwordx4 v14, s[12:15], s46 offen offset:1024 lds
    s_add_u32 m0, s49, 106496
    s_nop 0
    buffer_load_dwordx4 v15, s[12:15], s46 offen lds
    buffer_load_dwordx4 v16, s[12:15], s46 offen offset:1024 lds
    s_add_u32 m0, s50, 90112
    s_nop 0
    buffer_load_dwordx4 v17, s[12:15], s46 offen lds
    v_readlane_b32 s45, v3, s52
    v_readlane_b32 s46, v4, s52
    s_add_u32 s52, s52, 1
    s_waitcnt vmcnt(11)
    s_barrier
    s_cmp_lg_u32 s42, 4
    s_cbranch_scc1 w1_nx
    s_lshl_b32 s61, s93, 4
    s_add_u32 s61, s61, s97
    s_lshl_b32 s61, s61, 7
    s_add_u32 s61, s61, 294912
    v_mov_b32 v253, s3
    s_mov_b64 exec, 1
    buffer_store_dword v253, v252, s[84:87], s61 offen sc1
    s_mov_b64 exec, -1
w1_nx:
    s_add_u32 m0, s48, 0
    s_nop 0
    buffer_load_dwordx4 v5, s[8:11], s45 offen sc1 lds
    buffer_load_dwordx4 v5, s[8:11], s45 offen offset:1024 sc1 lds
    buffer_load_dwordx4 v6, s[8:11], s45 offen offset:2048 sc1 lds
    buffer_load_dwordx4 v6, s[8:11], s45 offen offset:3072 sc1 lds
    s_add_u32 m0, s49, 0
    s_nop 0
    buffer_load_dwordx4 v9, s[12:15], s46 offen lds
    buffer_load_dwordx4 v12, s[12:15], s46 offen offset:1024 lds
    s_add_u32 m0, s49, 8192
    s_nop 0
    buffer_load_dwordx4 v13, s[12:15], s46 offen lds
    buffer_load_dwordx4 v14, s[12:15], s46 offen offset:1024 lds
    s_add_u32 m0, s49, 16384
    s_nop 0
    buffer_load_dwordx4 v15, s[12:15], s46 offen lds
    buffer_load_dwordx4 v16, s[12:15], s46 offen offset:1024 lds
    s_add_u32 m0, s50, 0
    s_nop 0
    buffer_load_dwordx4 v17, s[12:15], s46 offen lds
    v_readlane_b32 s45, v3, s52
    v_readlane_b32 s46, v4, s52
    s_add_u32 s52, s52, 1
    s_waitcnt vmcnt(11)
    s_barrier
    s_add_u32 m0, s48, 45056
    s_nop 0
    buffer_load_dwordx4 v5, s[8:11], s45 offen sc1 lds
    buffer_load_dwordx4 v5, s[8:11], s45 offen offset:1024 sc1 lds
    buffer_load_dwordx4 v6, s[8:11], s45 offen offset:2048 sc1 lds
    buffer_load_dwordx4 v6, s[8:11], s45 offen offset:3072 sc1 lds
    s_add_u32 m0, s49, 45056
    s_nop 0
    buffer_load_dwordx4 v9, s[12:15], s46 offen lds
    buffer_load_dwordx4 v12, s[12:15], s46 offen offset:1024 lds
    s_add_u32 m0, s49, 53248
    s_nop 0
    buffer_load_dwordx4 v13, s[12:15], s46 offen lds
    buffer_load_dwordx4 v14, s[12:15], s46 offen offset:1024 lds
    s_add_u32 m0, s49, 61440
    s_nop 0
    buffer_load_dwordx4 v15, s[12:15], s46 offen lds
    buffer_load_dwordx4 v16, s[12:15], s46 offen offset:1024 lds
    s_add_u32 m0, s50, 45056
    s_nop 0
    buffer_load_dwordx4 v17, s[12:15], s46 offen lds
    v_readlane_b32 s45, v3, s52
    v_readlane_b32 s46, v4, s52
    s_add_u32 s52, s52, 1
    s_lshl_b32 s60, s41, 11
    s_add_u32 s60, s60, 131072
    v_lshlrev_b32 v67, 5, v1
    buffer_load_dword v66, v67, s[84:87], s60 offen sc1
    s_waitcnt vmcnt(12)
    s_barrier
    s_add_u32 m0, s48, 90112
    s_nop 0
    buffer_load_dwordx4 v5, s[8:11], s45 offen sc1 lds
    buffer_load_dwordx4 v5, s[8:11], s45 offen offset:1024 sc1 lds
    buffer_load_dwordx4 v6, s[8:11], s45 offen offset:2048 sc1 lds
    buffer_load_dwordx4 v6, s[8:11], s45 offen offset:3072 sc1 lds
    s_add_u32 m0, s49, 90112
    s_nop 0
    buffer_load_dwordx4 v9, s[12:15], s46 offen lds
    buffer_load_dwordx4 v12, s[12:15], s46 offen offset:1024 lds
    s_add_u32 m0, s49, 98304
    s_nop 0
    buffer_load_dwordx4 v13, s[12:15], s46 offen lds
    buffer_load_dwordx4 v14, s[12:15], s46 offen offset:1024 lds
    s_add_u32 m0, s49, 106496
    s_nop 0
    buffer_load_dwordx4 v15, s[12:15], s46 offen lds
    buffer_load_dwordx4 v16, s[12:15], s46 offen offset:1024 lds
    s_add_u32 m0, s50, 90112
    s_nop 0
    buffer_load_dwordx4 v17, s[12:15], s46 offen lds
    v_readlane_b32 s45, v3, s52
    v_readlane_b32 s46, v4, s52
    s_add_u32 s52, s52, 1
    s_waitcnt vmcnt(12)
    s_barrier
    s_add_u32 m0, s48, 0
    s_nop 0
    buffer_load_dwordx4 v5, s[8:11], s45 offen sc1 lds
    buffer_load_dwordx4 v5, s[8:11], s45 offen offset:1024 sc1 lds
    buffer_load_dwordx4 v6, s[8:11], s45 offen offset:2048 sc1 lds
    buffer_load_dwordx4 v6, s[8:11], s45 offen offset:3072 sc1 lds
    s_add_u32 m0, s49, 0
    s_nop 0
    buffer_load_dwordx4 v9, s[12:15], s46 offen lds
    buffer_load_dwordx4 v12, s[12:15], s46 offen offset:1024 lds
    s_add_u32 m0, s49, 8192
    s_nop 0
    buffer_load_dwordx4 v13, s[12:15], s46 offen lds
    buffer_load_dwordx4 v14, s[12:15], s46 offen offset:1024 lds
    s_add_u32 m0, s49, 16384
    s_nop 0
    buffer_load_dwordx4 v15, s[12:15], s46 offen lds
    buffer_load_dwordx4 v16, s[12:15], s46 offen offset:1024 lds
    s_add_u32 m0, s50, 0
    s_nop 0
    buffer_load_dwordx4 v17, s[12:15], s46 offen lds
    s_waitcnt vmcnt(22)
    s_mov_b32 s90, 200000
w19_p:
    v_cmp_ne_u32 vcc, s3, v66
    s_nop 0
    s_cmp_eq_u64 vcc, 0
    s_cbranch_scc1 w19_y
    buffer_load_dword v66, v67, s[84:87], s60 offen sc1
    s_sub_u32 s90, s90, 1
    s_waitcnt vmcnt(0)
    s_cmp_lg_u32 s90, 0
    s_cbranch_scc1 w19_p
w19_y:
    v_lshlrev_b32 v44, 4, v1
    s_lshl_b32 s60, s41, 11
    s_mov_b32 m0, 140288
    s_nop 0
    buffer_load_dwordx4 v44, s[16:19], s60 offen sc1 lds
    buffer_load_dwordx4 v44, s[16:19], s60 offen offset:1024 sc1 lds
    v_and_b32 v44, 15, v1
    v_lshlrev_b32 v44, 4, v44
    v_lshrrev_b32 v45, 4, v1
    v_lshl_add_u32 v45, v45, 14, v44
    s_lshl_b32 s60, s40, 2
    s_add_u32 s60, s60, s42
    s_sub_u32 s60, s60, 4
    s_lshl_b32 s60, s60, 8
    buffer_load_dwordx4 v[48:51], v45, s[24:27], s60 offen sc1
    s_add_u32 s60, s60, 65536
    buffer_load_dwordx4 v[52:55], v45, s[24:27], s60 offen sc1
    s_add_u32 s60, s60, 65536
    buffer_load_dwordx4 v[56:59], v45, s[24:27], s60 offen sc1
    s_add_u32 s60, s60, 65536
    buffer_load_dwordx4 v[60:63], v45, s[24:27], s60 offen sc1
    s_add_u32 s60, s60, 65536
    s_mov_b32 s28, s34
    s_mov_b32 s29, s35
    s_mov_b32 s30, 7340032
    s_mov_b32 s31, 0x20000
    v_lshlrev_b32 v19, 11, v7
    v_lshl_add_u32 v19, v10, 7, v19
    s_bfe_u32 s62, s2, 0x10002
    s_lshl_b32 s62, s62, 1
    s_and_b32 s63, s2, 1
    s_add_u32 s62, s62, s63
    s_mul_i32 s62, s62, 896
    s_lshr_b32 s61, s2, 3
    s_mul_i32 s61, s61, 28
    s_add_u32 s62, s62, s61
    s_sub_u32 s61, s42, 4
    s_lshl_b32 s61, s61, 3
    s_add_u32 s62, s62, s61
    s_lshl_b32 s62, s62, 11
    s_bfe_u32 s63, s2, 0x10001
    s_lshl_b32 s63, s63, 10
    s_add_u32 s62, s62, s63
    s_lshl_b64 exec, -1, 16
    buffer_load_dword v251, v19, s[28:31], s62 offen
    s_mov_b64 exec, -1
    s_waitcnt vmcnt(18)
    s_barrier
    s_waitcnt vmcnt(7)
    s_barrier
    s_mov_b32 s93, s40
    s_mov_b32 s97, s41
    s_load_dwordx2 s[4:5], s[0:1], 56
    s_load_dwordx2 s[32:33], s[0:1], 64
    s_and_b32 s36, s2, 7
    s_lshr_b32 s37, s2, 3
    s_and_b32 s38, s36, 1
    s_lshr_b32 s36, s36, 1
    s_and_b32 s39, s37, 7
    s_lshr_b32 s37, s37, 3
    s_mul_i32 s38, s38, 8
    s_add_u32 s40, s38, s39
    s_mul_i32 s36, s36, 4
    s_add_u32 s41, s36, s37
    s_add_u32 s39, s39, s37
    s_and_b32 s39, s39, 3
    s_mul_i32 s43, s41, 0
    s_mov_b32 s38, s41
    s_and_b32 s36, s38, 7
    s_lshl_b32 s36, s36, 1
    s_lshr_b32 s37, s38, 3
    s_add_u32 s41, s36, s37
    s_lshl_b32 s43, s41, 7
    s_mul_i32 s37, s38, 7
    s_and_b32 s36, s38, 1
    s_add_u32 s37, s37, s36
    s_lshr_b32 s37, s37, 1
    s_and_b32 s58, s41, 1
    s_mov_b32 s59, 128
    s_cmp_eq_u32 s58, 0
    s_cselect_b32 s59, s59, -128
    s_sub_u32 s54, s42, 4
    s_getpc_b64 s[66:67]
w2_pc:
    s_add_u32 s66, s66, w2_tab-w2_pc
    s_addc_u32 s67, s67, 0
    s_lshl_b32 s55, s39, 6
    s_lshl_b32 s55, s39, 4
    s_add_u32 s55, s55, s38
    s_lshl_b32 s55, s55, 5
    s_mov_b32 s39, s37
    v_add_u32 v2, s55, v1
    global_load_ubyte v3, v2, s[66:67]
    s_mul_i32 s55, s40, 8
    s_mul_i32 s56, s54, 2
    s_mul_i32 s55, s55, 114688
    s_mul_i32 s56, s56, 2048
    s_add_u32 s55, s55, s56
    v_lshl_add_u32 v5, v1, 4, s55
    s_mul_i32 s48, s54, 4096
    v_lshrrev_b32 v6, 3, v1
    v_and_b32 v9, 7, v1
    v_and_b32 v7, 6, v6
    v_xor_b32 v8, v9, v7
    v_mul_u32_u24 v7, 2048, v6
    s_mul_i32 s55, s54, 32768
    s_add_u32 s56, s55, s43
    v_add_u32 v7, s56, v7
    v_lshl_add_u32 v8, v8, 4, v7
    s_mul_i32 s49, s54, 2048
    s_add_u32 s49, s49, 16384
    v_add_u32 v10, 15360, v8
    v_add_u32 v11, 0, v8
    v_add_u32 v11, s59, v11
    v_add_u32 v12, 15360, v8
    v_add_u32 v12, s59, v12
    s_mul_i32 s45, s39, 16384
    s_mul_i32 s46, s39, 131072
    s_mov_b32 s52, 1
    s_waitcnt lgkmcnt(0)
    s_add_u32 s8, s6, 41943040
    s_addc_u32 s9, s7, 0
    s_mov_b32 s10, 14680064
    s_mov_b32 s11, 0x20000
    s_mov_b32 s12, s4
    s_mov_b32 s13, s5
    s_mov_b32 s14, 7340032
    s_mov_b32 s15, 0x20000
    s_add_u32 m0, s49, 32768
    s_nop 0
    buffer_load_dwordx4 v8, s[12:15], s46 offen lds
    buffer_load_dwordx4 v10, s[12:15], s46 offen offset:1024 lds
    s_add_u32 m0, s49, 40960
    s_nop 0
    buffer_load_dwordx4 v11, s[12:15], s46 offen lds
    buffer_load_dwordx4 v12, s[12:15], s46 offen offset:1024 lds
    s_waitcnt vmcnt(4)
    v_mul_u32_u24 v4, 131072, v3
    v_mul_u32_u24 v3, 16384, v3
    v_readlane_b32 s46, v4, 1
    s_mov_b32 s52, 2
    s_add_u32 m0, s49, 65536
    s_nop 2
    buffer_load_dwordx4 v8, s[12:15], s46 offen lds
    buffer_load_dwordx4 v10, s[12:15], s46 offen offset:1024 lds
    s_add_u32 m0, s49, 73728
    s_nop 0
    buffer_load_dwordx4 v11, s[12:15], s46 offen lds
    buffer_load_dwordx4 v12, s[12:15], s46 offen offset:1024 lds
    v_readlane_b32 s46, v4, 2
    s_nop 4
    s_add_u32 m0, s49, 98304
    s_nop 0
    buffer_load_dwordx4 v8, s[12:15], s46 offen lds
    buffer_load_dwordx4 v10, s[12:15], s46 offen offset:1024 lds
    s_add_u32 m0, s49, 106496
    s_nop 0
    buffer_load_dwordx4 v11, s[12:15], s46 offen lds
    buffer_load_dwordx4 v12, s[12:15], s46 offen offset:1024 lds
    v_pk_add_f32 v[48:49], v[48:49], v[56:57]
    v_pk_add_f32 v[50:51], v[50:51], v[58:59]
    v_pk_add_f32 v[52:53], v[52:53], v[60:61]
    v_pk_add_f32 v[54:55], v[54:55], v[62:63]
    v_pk_add_f32 v[48:49], v[48:49], v[52:53]
    v_pk_add_f32 v[50:51], v[50:51], v[54:55]
    v_mov_b32 v52, v48
    v_mov_b32 v53, v49
    v_mov_b32 v54, v50
    v_mov_b32 v55, v51
    v_permlane32_swap_b32 v48, v52
    v_permlane32_swap_b32 v49, v53
    v_permlane32_swap_b32 v50, v54
    v_permlane32_swap_b32 v51, v55
    v_add_f32 v48, v48, v52
    v_add_f32 v49, v49, v53
    v_add_f32 v50, v50, v54
    v_add_f32 v51, v51, v55
    v_mov_b32 v52, v48
    v_mov_b32 v53, v49
    v_mov_b32 v54, v50
    v_mov_b32 v55, v51
    v_permlane16_swap_b32 v48, v52
    v_permlane16_swap_b32 v49, v53
    v_permlane16_swap_b32 v50, v54
    v_permlane16_swap_b32 v51, v55
    v_add_f32 v48, v48, v52
    v_add_f32 v49, v49, v53
    v_add_f32 v50, v50, v54
    v_add_f32 v51, v51, v55
    v_mov_b32 v56, 0x3a800000
    v_mul_f32 v53, v48, v56
    v_mul_f32 v52, v53, v53
    v_fma_f32 v52, v49, v56, -v52
    v_max_f32 v52, 0, v52
    v_add_f32 v52, 0x3727c5ac, v52
    v_rsq_f32 v52, v52
    s_nop 0
    v_mul_f32 v53, -v53, v52
    v_mul_f32 v55, v50, v56
    v_mul_f32 v54, v55, v55
    v_fma_f32 v54, v51, v56, -v54
    v_max_f32 v54, 0, v54
    v_add_f32 v54, 0x3727c5ac, v54
    v_rsq_f32 v54, v54
    s_nop 0
    v_mul_f32 v55, -v55, v54
    s_sub_u32 s60, s42, 4
    s_lshl_b32 s60, s60, 8
    s_add_u32 s60, s60, 137216
    v_add_u32 v44, s60, v44
    ds_write_b128 v44, v[52:55]
    s_waitcnt lgkmcnt(0)
    s_barrier
    s_cmp_lg_u32 s42, 6
    s_cbranch_scc1 w2_ng
    s_add_u32 s20, s6, 65536
    s_addc_u32 s21, s7, 0
    s_mov_b32 s22, 65536
    s_mov_b32 s23, 0x20000
    v_lshrrev_b32 v161, 4, v1
    v_lshlrev_b32 v161, 14, v161
    v_and_b32 v162, 15, v1
    v_lshl_add_u32 v161, v162, 4, v161
    s_lshl_b32 s61, s41, 8
    s_add_u32 s61, s61, 12288
    buffer_load_dwordx4 v[164:167], v161, s[20:23], s61 offen sc1
    s_mov_b32 s20, s32
    s_mov_b32 s21, s33
    s_mov_b32 s22, 2048
    s_mov_b32 s23, 0x20000
    v_lshlrev_b32 v163, 3, v162
    s_lshl_b32 s61, s41, 7
    buffer_load_dwordx2 v[176:177], v163, s[20:23], s61 offen
    v_lshlrev_b32 v162, 4, v162
    v_add_u32 v162, 131072, v162
    s_waitcnt vmcnt(0)
    v_mov_b32 v180, v164
    v_mov_b32 v181, v165
    v_mov_b32 v182, v166
    v_mov_b32 v183, v167
    v_permlane32_swap_b32 v164, v180
    v_permlane32_swap_b32 v165, v181
    v_permlane32_swap_b32 v166, v182
    v_permlane32_swap_b32 v167, v183
    v_add_f32 v164, v164, v180
    v_add_f32 v165, v165, v181
    v_add_f32 v166, v166, v182
    v_add_f32 v167, v167, v183
    v_mov_b32 v180, v164
    v_mov_b32 v181, v165
    v_mov_b32 v182, v166
    v_mov_b32 v183, v167
    v_permlane16_swap_b32 v164, v180
    v_permlane16_swap_b32 v165, v181
    v_permlane16_swap_b32 v166, v182
    v_permlane16_swap_b32 v167, v183
    v_add_f32 v164, v164, v180
    v_add_f32 v165, v165, v181
    v_add_f32 v166, v166, v182
    v_add_f32 v167, v167, v183
    v_cvt_pk_bf16_f32 v180, v164, v165
    v_cvt_pk_bf16_f32 v181, v166, v167
    v_lshlrev_b32 v164, 16, v180
    v_and_b32 v165, 0xffff0000, v180
    v_lshlrev_b32 v166, 16, v181
    v_and_b32 v167, 0xffff0000, v181
    v_lshlrev_b32 v168, 16, v176
    v_and_b32 v169, 0xffff0000, v176
    v_lshlrev_b32 v170, 16, v177
    v_and_b32 v171, 0xffff0000, v177
    v_mul_f32 v168, v168, v164
    v_mul_f32 v169, v169, v165
    v_mul_f32 v170, v170, v166
    v_mul_f32 v171, v171, v167
    ds_write_b128 v162, v[164:167] offset:0
    ds_write_b128 v162, v[168:171] offset:256
    s_waitcnt lgkmcnt(0)
w2_ng:
    s_lshl_b32 s62, s40, 4
    s_add_u32 s62, s62, s41
    s_lshl_b32 s62, s62, 7
    s_add_u32 s62, s62, 294912
    v_mov_b32 v243, 0
    buffer_load_dword v242, v243, s[84:87], s62 offen sc1
    v_readlane_b32 s46, v4, 3
    v_readlane_b32 s45, v3, 3
    s_mov_b32 s52, 4
    s_waitcnt vmcnt(9)
    s_barrier
    s_waitcnt vmcnt(5)
    s_add_u32 s84, s6, 524288
    s_addc_u32 s85, s7, 0
    s_mov_b32 s86, 327680
    s_mov_b32 s87, 0x20000
    s_lshl_b32 s88, s93, 11
    s_add_u32 s88, s88, 196608
    s_lshl_b32 s89, s40, 11
    s_add_u32 s89, s89, 196608
    s_lshl_b32 s90, s97, 7
    s_add_u32 s88, s88, s90
    v_lshlrev_b32 v252, 7, v1
    v_mov_b32 v253, s3
    s_mov_b32 s90, 200000
    s_barrier
    s_cmp_lg_u32 s42, 4
    s_cbranch_scc1 f6_s5
    s_mov_b64 exec, 1
    buffer_store_dword v253, v252, s[84:87], s88 offen sc1
    s_mov_b64 exec, -1
f6_s5:
    s_add_u32 m0, s49, 0
    s_nop 0
    buffer_load_dwordx4 v8, s[12:15], s46 offen lds
    buffer_load_dwordx4 v10, s[12:15], s46 offen offset:1024 lds
    s_add_u32 m0, s49, 8192
    s_nop 0
    buffer_load_dwordx4 v11, s[12:15], s46 offen lds
    buffer_load_dwordx4 v12, s[12:15], s46 offen offset:1024 lds
    s_waitcnt vmcnt(5)
    s_barrier
    s_mov_b32 s91, 0
    s_lshr_b32 s60, s45, 13
    s_mul_i32 s61, s60, 9363
    s_lshr_b32 s61, s61, 16
    s_lshl_b32 s61, 1, s61
    s_add_u32 s60, s60, 1
    s_mul_i32 s60, s60, 9363
    s_lshr_b32 s60, s60, 16
    s_lshl_b32 s60, 1, s60
    s_or_b32 s60, s60, s61
f6_p3:
    s_andn2_b32 s61, s60, s91
    s_cbranch_scc0 f6_y3
    s_sub_u32 s90, s90, 1
    s_cbranch_scc1 f6_y3
    s_mov_b64 exec, 0xffff
    buffer_load_dword v253, v252, s[84:87], s89 offen sc1
    s_waitcnt vmcnt(0)
    v_cmp_eq_u32 vcc, s3, v253
    s_mov_b64 exec, -1
    s_mov_b32 s91, vcc_lo
    s_branch f6_p3
f6_y3:
    s_add_u32 m0, s48, 0
    s_nop 0
    buffer_load_dwordx4 v5, s[8:11], s45 offen sc1 lds
    buffer_load_dwordx4 v5, s[8:11], s45 offen offset:1024 sc1 lds
    buffer_load_dwordx4 v5, s[8:11], s45 offen offset:2048 sc1 lds
    buffer_load_dwordx4 v5, s[8:11], s45 offen offset:3072 sc1 lds
    v_readlane_b32 s45, v3, s52
    v_readlane_b32 s46, v4, s52
    s_add_u32 s52, s52, 1
    s_lshr_b32 s60, s45, 13
    s_mul_i32 s61, s60, 9363
    s_lshr_b32 s61, s61, 16
    s_lshl_b32 s61, 1, s61
    s_add_u32 s60, s60, 1
    s_mul_i32 s60, s60, 9363
    s_lshr_b32 s60, s60, 16
    s_lshl_b32 s60, 1, s60
    s_or_b32 s60, s60, s61
f6_p4:
    s_andn2_b32 s61, s60, s91
    s_cbranch_scc0 f6_y4
    s_sub_u32 s90, s90, 1
    s_cbranch_scc1 f6_y4
    s_mov_b64 exec, 0xffff
    buffer_load_dword v253, v252, s[84:87], s89 offen sc1
    s_waitcnt vmcnt(0)
    v_cmp_eq_u32 vcc, s3, v253
    s_mov_b64 exec, -1
    s_mov_b32 s91, vcc_lo
    s_branch f6_p4
f6_y4:
    s_add_u32 m0, s48, 32768
    s_nop 0
    buffer_load_dwordx4 v5, s[8:11], s45 offen sc1 lds
    buffer_load_dwordx4 v5, s[8:11], s45 offen offset:1024 sc1 lds
    buffer_load_dwordx4 v5, s[8:11], s45 offen offset:2048 sc1 lds
    buffer_load_dwordx4 v5, s[8:11], s45 offen offset:3072 sc1 lds
    s_add_u32 m0, s49, 32768
    s_nop 0
    buffer_load_dwordx4 v8, s[12:15], s46 offen lds
    buffer_load_dwordx4 v10, s[12:15], s46 offen offset:1024 lds
    s_add_u32 m0, s49, 40960
    s_nop 0
    buffer_load_dwordx4 v11, s[12:15], s46 offen lds
    buffer_load_dwordx4 v12, s[12:15], s46 offen offset:1024 lds
    v_readlane_b32 s45, v3, s52
    v_readlane_b32 s46, v4, s52
    s_add_u32 s52, s52, 1
    s_lshr_b32 s60, s45, 13
    s_mul_i32 s61, s60, 9363
    s_lshr_b32 s61, s61, 16
    s_lshl_b32 s61, 1, s61
    s_add_u32 s60, s60, 1
    s_mul_i32 s60, s60, 9363
    s_lshr_b32 s60, s60, 16
    s_lshl_b32 s60, 1, s60
    s_or_b32 s60, s60, s61
f6_p5:
    s_andn2_b32 s61, s60, s91
    s_cbranch_scc0 f6_y5
    s_sub_u32 s90, s90, 1
    s_cbranch_scc1 f6_y5
    s_mov_b64 exec, 0xffff
    buffer_load_dword v253, v252, s[84:87], s89 offen sc1
    s_waitcnt vmcnt(0)
    v_cmp_eq_u32 vcc, s3, v253
    s_mov_b64 exec, -1
    s_mov_b32 s91, vcc_lo
    s_branch f6_p5
f6_y5:
    s_add_u32 m0, s48, 65536
    s_nop 0
    buffer_load_dwordx4 v5, s[8:11], s45 offen sc1 lds
    buffer_load_dwordx4 v5, s[8:11], s45 offen offset:1024 sc1 lds
    buffer_load_dwordx4 v5, s[8:11], s45 offen offset:2048 sc1 lds
    buffer_load_dwordx4 v5, s[8:11], s45 offen offset:3072 sc1 lds
    s_add_u32 m0, s49, 65536
    s_nop 0
    buffer_load_dwordx4 v8, s[12:15], s46 offen lds
    buffer_load_dwordx4 v10, s[12:15], s46 offen offset:1024 lds
    s_add_u32 m0, s49, 73728
    s_nop 0
    buffer_load_dwordx4 v11, s[12:15], s46 offen lds
    buffer_load_dwordx4 v12, s[12:15], s46 offen offset:1024 lds
    v_readlane_b32 s45, v3, s52
    v_readlane_b32 s46, v4, s52
    s_add_u32 s52, s52, 1
    s_mov_b32 s47, 98304
    s_waitcnt vmcnt(16)
    s_barrier
    s_lshr_b32 s60, s45, 13
    s_mul_i32 s61, s60, 9363
    s_lshr_b32 s61, s61, 16
    s_lshl_b32 s61, 1, s61
    s_add_u32 s60, s60, 1
    s_mul_i32 s60, s60, 9363
    s_lshr_b32 s60, s60, 16
    s_lshl_b32 s60, 1, s60
    s_or_b32 s60, s60, s61
f6_p6:
    s_andn2_b32 s61, s60, s91
    s_cbranch_scc0 f6_y6
    s_sub_u32 s90, s90, 1
    s_cbranch_scc1 f6_y6
    s_mov_b64 exec, 0xffff
    buffer_load_dword v253, v252, s[84:87], s89 offen sc1
    s_waitcnt vmcnt(0)
    v_cmp_eq_u32 vcc, s3, v253
    s_mov_b64 exec, -1
    s_mov_b32 s91, vcc_lo
    s_branch f6_p6
f6_y6:
    s_add_u32 m0, s48, 98304
    s_nop 0
    buffer_load_dwordx4 v5, s[8:11], s45 offen sc1 lds
    buffer_load_dwordx4 v5, s[8:11], s45 offen offset:1024 sc1 lds
    buffer_load_dwordx4 v5, s[8:11], s45 offen offset:2048 sc1 lds
    buffer_load_dwordx4 v5, s[8:11], s45 offen offset:3072 sc1 lds
    s_add_u32 m0, s49, 98304
    s_nop 0
    buffer_load_dwordx4 v8, s[12:15], s46 offen lds
    buffer_load_dwordx4 v10, s[12:15], s46 offen offset:1024 lds
    s_add_u32 m0, s49, 106496
    s_nop 0
    buffer_load_dwordx4 v11, s[12:15], s46 offen lds
    buffer_load_dwordx4 v12, s[12:15], s46 offen offset:1024 lds
    v_readlane_b32 s45, v3, s52
    v_readlane_b32 s46, v4, s52
    s_add_u32 s52, s52, 1
    s_waitcnt vmcnt(16)
    s_barrier
    s_lshr_b32 s60, s45, 13
    s_mul_i32 s61, s60, 9363
    s_lshr_b32 s61, s61, 16
    s_lshl_b32 s61, 1, s61
    s_add_u32 s60, s60, 1
    s_mul_i32 s60, s60, 9363
    s_lshr_b32 s60, s60, 16
    s_lshl_b32 s60, 1, s60
    s_or_b32 s60, s60, s61
f6_p7:
    s_andn2_b32 s61, s60, s91
    s_cbranch_scc0 f6_y7
    s_sub_u32 s90, s90, 1
    s_cbranch_scc1 f6_y7
    s_mov_b64 exec, 0xffff
    buffer_load_dword v253, v252, s[84:87], s89 offen sc1
    s_waitcnt vmcnt(0)
    v_cmp_eq_u32 vcc, s3, v253
    s_mov_b64 exec, -1
    s_mov_b32 s91, vcc_lo
    s_branch f6_p7
f6_y7:
    s_add_u32 m0, s48, 0
    s_nop 0
    buffer_load_dwordx4 v5, s[8:11], s45 offen sc1 lds
    buffer_load_dwordx4 v5, s[8:11], s45 offen offset:1024 sc1 lds
    buffer_load_dwordx4 v5, s[8:11], s45 offen offset:2048 sc1 lds
    buffer_load_dwordx4 v5, s[8:11], s45 offen offset:3072 sc1 lds
    s_add_u32 m0, s49, 0
    s_nop 0
    buffer_load_dwordx4 v8, s[12:15], s46 offen lds
    buffer_load_dwordx4 v10, s[12:15], s46 offen offset:1024 lds
    s_add_u32 m0, s49, 8192
    s_nop 0
    buffer_load_dwordx4 v11, s[12:15], s46 offen lds
    buffer_load_dwordx4 v12, s[12:15], s46 offen offset:1024 lds
    v_readlane_b32 s45, v3, s52
    v_readlane_b32 s46, v4, s52
    s_add_u32 s52, s52, 1
    s_waitcnt vmcnt(16)
    s_barrier
    s_lshr_b32 s60, s45, 13
    s_mul_i32 s61, s60, 9363
    s_lshr_b32 s61, s61, 16
    s_lshl_b32 s61, 1, s61
    s_add_u32 s60, s60, 1
    s_mul_i32 s60, s60, 9363
    s_lshr_b32 s60, s60, 16
    s_lshl_b32 s60, 1, s60
    s_or_b32 s60, s60, s61
f6_p8:
    s_andn2_b32 s61, s60, s91
    s_cbranch_scc0 f6_y8
    s_sub_u32 s90, s90, 1
    s_cbranch_scc1 f6_y8
    s_mov_b64 exec, 0xffff
    buffer_load_dword v253, v252, s[84:87], s89 offen sc1
    s_waitcnt vmcnt(0)
    v_cmp_eq_u32 vcc, s3, v253
    s_mov_b64 exec, -1
    s_mov_b32 s91, vcc_lo
    s_branch f6_p8
f6_y8:
    s_add_u32 m0, s48, 32768
    s_nop 0
    buffer_load_dwordx4 v5, s[8:11], s45 offen sc1 lds
    buffer_load_dwordx4 v5, s[8:11], s45 offen offset:1024 sc1 lds
    buffer_load_dwordx4 v5, s[8:11], s45 offen offset:2048 sc1 lds
    buffer_load_dwordx4 v5, s[8:11], s45 offen offset:3072 sc1 lds
    s_add_u32 m0, s49, 32768
    s_nop 0
    buffer_load_dwordx4 v8, s[12:15], s46 offen lds
    buffer_load_dwordx4 v10, s[12:15], s46 offen offset:1024 lds
    s_add_u32 m0, s49, 40960
    s_nop 0
    buffer_load_dwordx4 v11, s[12:15], s46 offen lds
    buffer_load_dwordx4 v12, s[12:15], s46 offen offset:1024 lds
    v_readlane_b32 s45, v3, s52
    v_readlane_b32 s46, v4, s52
    s_add_u32 s52, s52, 1
    s_waitcnt vmcnt(16)
    s_barrier
    s_lshr_b32 s60, s45, 13
    s_mul_i32 s61, s60, 9363
    s_lshr_b32 s61, s61, 16
    s_lshl_b32 s61, 1, s61
    s_add_u32 s60, s60, 1
    s_mul_i32 s60, s60, 9363
    s_lshr_b32 s60, s60, 16
    s_lshl_b32 s60, 1, s60
    s_or_b32 s60, s60, s61
f6_p9:
    s_andn2_b32 s61, s60, s91
    s_cbranch_scc0 f6_y9
    s_sub_u32 s90, s90, 1
    s_cbranch_scc1 f6_y9
    s_mov_b64 exec, 0xffff
    buffer_load_dword v253, v252, s[84:87], s89 offen sc1
    s_waitcnt vmcnt(0)
    v_cmp_eq_u32 vcc, s3, v253
    s_mov_b64 exec, -1
    s_mov_b32 s91, vcc_lo
    s_branch f6_p9
f6_y9:
    s_add_u32 m0, s48, 65536
    s_nop 0
    buffer_load_dwordx4 v5, s[8:11], s45 offen sc1 lds
    buffer_load_dwordx4 v5, s[8:11], s45 offen offset:1024 sc1 lds
    buffer_load_dwordx4 v5, s[8:11], s45 offen offset:2048 sc1 lds
    buffer_load_dwordx4 v5, s[8:11], s45 offen offset:3072 sc1 lds
    s_add_u32 m0, s49, 65536
    s_nop 0
    buffer_load_dwordx4 v8, s[12:15], s46 offen lds
    buffer_load_dwordx4 v10, s[12:15], s46 offen offset:1024 lds
    s_add_u32 m0, s49, 73728
    s_nop 0
    buffer_load_dwordx4 v11, s[12:15], s46 offen lds
    buffer_load_dwordx4 v12, s[12:15], s46 offen offset:1024 lds
    v_readlane_b32 s45, v3, s52
    v_readlane_b32 s46, v4, s52
    s_add_u32 s52, s52, 1
    s_waitcnt vmcnt(16)
    s_barrier
    s_lshr_b32 s60, s45, 13
    s_mul_i32 s61, s60, 9363
    s_lshr_b32 s61, s61, 16
    s_lshl_b32 s61, 1, s61
    s_add_u32 s60, s60, 1
    s_mul_i32 s60, s60, 9363
    s_lshr_b32 s60, s60, 16
    s_lshl_b32 s60, 1, s60
    s_or_b32 s60, s60, s61
f6_p10:
    s_andn2_b32 s61, s60, s91
    s_cbranch_scc0 f6_y10
    s_sub_u32 s90, s90, 1
    s_cbranch_scc1 f6_y10
    s_mov_b64 exec, 0xffff
    buffer_load_dword v253, v252, s[84:87], s89 offen sc1
    s_waitcnt vmcnt(0)
    v_cmp_eq_u32 vcc, s3, v253
    s_mov_b64 exec, -1
    s_mov_b32 s91, vcc_lo
    s_branch f6_p10
f6_y10:
    s_add_u32 m0, s48, 98304
    s_nop 0
    buffer_load_dwordx4 v5, s[8:11], s45 offen sc1 lds
    buffer_load_dwordx4 v5, s[8:11], s45 offen offset:1024 sc1 lds
    buffer_load_dwordx4 v5, s[8:11], s45 offen offset:2048 sc1 lds
    buffer_load_dwordx4 v5, s[8:11], s45 offen offset:3072 sc1 lds
    s_add_u32 m0, s49, 98304
    s_nop 0
    buffer_load_dwordx4 v8, s[12:15], s46 offen lds
    buffer_load_dwordx4 v10, s[12:15], s46 offen offset:1024 lds
    s_add_u32 m0, s49, 106496
    s_nop 0
    buffer_load_dwordx4 v11, s[12:15], s46 offen lds
    buffer_load_dwordx4 v12, s[12:15], s46 offen offset:1024 lds
    v_readlane_b32 s45, v3, s52
    v_readlane_b32 s46, v4, s52
    s_add_u32 s52, s52, 1
    s_waitcnt vmcnt(16)
    s_barrier
    s_lshr_b32 s60, s45, 13
    s_mul_i32 s61, s60, 9363
    s_lshr_b32 s61, s61, 16
    s_lshl_b32 s61, 1, s61
    s_add_u32 s60, s60, 1
    s_mul_i32 s60, s60, 9363
    s_lshr_b32 s60, s60, 16
    s_lshl_b32 s60, 1, s60
    s_or_b32 s60, s60, s61
f6_p11:
    s_andn2_b32 s61, s60, s91
    s_cbranch_scc0 f6_y11
    s_sub_u32 s90, s90, 1
    s_cbranch_scc1 f6_y11
    s_mov_b64 exec, 0xffff
    buffer_load_dword v253, v252, s[84:87], s89 offen sc1
    s_waitcnt vmcnt(0)
    v_cmp_eq_u32 vcc, s3, v253
    s_mov_b64 exec, -1
    s_mov_b32 s91, vcc_lo
    s_branch f6_p11
f6_y11:
    s_add_u32 m0, s48, 0
    s_nop 0
    buffer_load_dwordx4 v5, s[8:11], s45 offen sc1 lds
    buffer_load_dwordx4 v5, s[8:11], s45 offen offset:1024 sc1 lds
    buffer_load_dwordx4 v5, s[8:11], s45 offen offset:2048 sc1 lds
    buffer_load_dwordx4 v5, s[8:11], s45 offen offset:3072 sc1 lds
    s_add_u32 m0, s49, 0
    s_nop 0
    buffer_load_dwordx4 v8, s[12:15], s46 offen lds
    buffer_load_dwordx4 v10, s[12:15], s46 offen offset:1024 lds
    s_add_u32 m0, s49, 8192
    s_nop 0
    buffer_load_dwordx4 v11, s[12:15], s46 offen lds
    buffer_load_dwordx4 v12, s[12:15], s46 offen offset:1024 lds
    v_readlane_b32 s45, v3, s52
    v_readlane_b32 s46, v4, s52
    s_add_u32 s52, s52, 1
    s_waitcnt vmcnt(16)
    s_barrier
    s_mov_b32 s60, 0xffff
f6_p12:
    s_andn2_b32 s61, s60, s91
    s_cbranch_scc0 f6_y12
    s_sub_u32 s90, s90, 1
    s_cbranch_scc1 f6_y12
    s_mov_b64 exec, 0xffff
    buffer_load_dword v253, v252, s[84:87], s89 offen sc1
    s_waitcnt vmcnt(0)
    v_cmp_eq_u32 vcc, s3, v253
    s_mov_b64 exec, -1
    s_mov_b32 s91, vcc_lo
    s_branch f6_p12
f6_y12:
    s_add_u32 m0, s48, 32768
    s_nop 0
    buffer_load_dwordx4 v5, s[8:11], s45 offen sc1 lds
    buffer_load_dwordx4 v5, s[8:11], s45 offen offset:1024 sc1 lds
    buffer_load_dwordx4 v5, s[8:11], s45 offen offset:2048 sc1 lds
    buffer_load_dwordx4 v5, s[8:11], s45 offen offset:3072 sc1 lds
    s_add_u32 m0, s49, 32768
    s_nop 0
    buffer_load_dwordx4 v8, s[12:15], s46 offen lds
    buffer_load_dwordx4 v10, s[12:15], s46 offen offset:1024 lds
    s_add_u32 m0, s49, 40960
    s_nop 0
    buffer_load_dwordx4 v11, s[12:15], s46 offen lds
    buffer_load_dwordx4 v12, s[12:15], s46 offen offset:1024 lds
    v_readlane_b32 s45, v3, s52
    v_readlane_b32 s46, v4, s52
    s_add_u32 s52, s52, 1
    s_mov_b32 s47, 65536
    s_mov_b32 s51, 10
w2_ploop:
    s_waitcnt vmcnt(16)
    s_barrier
    s_add_u32 s54, s48, s47
    s_mov_b32 m0, s54
    s_nop 0
    buffer_load_dwordx4 v5, s[8:11], s45 offen sc1 lds
    buffer_load_dwordx4 v5, s[8:11], s45 offen offset:1024 sc1 lds
    buffer_load_dwordx4 v5, s[8:11], s45 offen offset:2048 sc1 lds
    buffer_load_dwordx4 v5, s[8:11], s45 offen offset:3072 sc1 lds
    s_add_u32 s54, s49, s47
    s_mov_b32 m0, s54
    s_nop 0
    buffer_load_dwordx4 v8, s[12:15], s46 offen lds
    buffer_load_dwordx4 v10, s[12:15], s46 offen offset:1024 lds
    s_add_u32 s54, s49, s47
    s_add_u32 m0, s54, 8192
    s_nop 0
    buffer_load_dwordx4 v11, s[12:15], s46 offen lds
    buffer_load_dwordx4 v12, s[12:15], s46 offen offset:1024 lds
    v_readlane_b32 s45, v3, s52
    v_readlane_b32 s46, v4, s52
    s_add_u32 s52, s52, 1
    s_add_u32 s47, s47, 32768
    s_cmp_ge_u32 s47, 131072
    s_cselect_b32 s47, 0, s47
    s_sub_u32 s51, s51, 1
    s_cmp_lg_u32 s51, 0
    s_cbranch_scc1 w2_ploop
    s_waitcnt vmcnt(16)
    s_barrier
    s_add_u32 m0, s48, 0
    s_nop 0
    buffer_load_dwordx4 v5, s[8:11], s45 offen sc1 lds
    buffer_load_dwordx4 v5, s[8:11], s45 offen offset:1024 sc1 lds
    buffer_load_dwordx4 v5, s[8:11], s45 offen offset:2048 sc1 lds
    buffer_load_dwordx4 v5, s[8:11], s45 offen offset:3072 sc1 lds
    s_add_u32 m0, s49, 0
    s_nop 0
    buffer_load_dwordx4 v8, s[12:15], s46 offen lds
    buffer_load_dwordx4 v10, s[12:15], s46 offen offset:1024 lds
    s_add_u32 m0, s49, 8192
    s_nop 0
    buffer_load_dwordx4 v11, s[12:15], s46 offen lds
    buffer_load_dwordx4 v12, s[12:15], s46 offen offset:1024 lds
    v_readlane_b32 s45, v3, s52
    v_readlane_b32 s46, v4, s52
    s_add_u32 s52, s52, 1
    s_waitcnt vmcnt(16)
    s_barrier
    s_add_u32 m0, s48, 32768
    s_nop 0
    buffer_load_dwordx4 v5, s[8:11], s45 offen sc1 lds
    buffer_load_dwordx4 v5, s[8:11], s45 offen offset:1024 sc1 lds
    buffer_load_dwordx4 v5, s[8:11], s45 offen offset:2048 sc1 lds
    buffer_load_dwordx4 v5, s[8:11], s45 offen offset:3072 sc1 lds
    s_add_u32 m0, s49, 32768
    s_nop 0
    buffer_load_dwordx4 v8, s[12:15], s46 offen lds
    buffer_load_dwordx4 v10, s[12:15], s46 offen offset:1024 lds
    s_add_u32 m0, s49, 40960
    s_nop 0
    buffer_load_dwordx4 v11, s[12:15], s46 offen lds
    buffer_load_dwordx4 v12, s[12:15], s46 offen offset:1024 lds
    v_readlane_b32 s45, v3, s52
    v_readlane_b32 s46, v4, s52
    s_add_u32 s52, s52, 1
    s_waitcnt vmcnt(16)
    s_barrier
    s_add_u32 m0, s48, 65536
    s_nop 0
    buffer_load_dwordx4 v5, s[8:11], s45 offen sc1 lds
    buffer_load_dwordx4 v5, s[8:11], s45 offen offset:1024 sc1 lds
    buffer_load_dwordx4 v5, s[8:11], s45 offen offset:2048 sc1 lds
    buffer_load_dwordx4 v5, s[8:11], s45 offen offset:3072 sc1 lds
    s_add_u32 m0, s49, 65536
    s_nop 0
    buffer_load_dwordx4 v8, s[12:15], s46 offen lds
    buffer_load_dwordx4 v10, s[12:15], s46 offen offset:1024 lds
    v_readlane_b32 s45, v3, s52
    v_readlane_b32 s46, v4, s52
    s_add_u32 s52, s52, 1
    s_waitcnt vmcnt(14)
    s_barrier
    s_add_u32 m0, s48, 98304
    s_nop 0
    buffer_load_dwordx4 v5, s[8:11], s45 offen sc1 lds
    buffer_load_dwordx4 v5, s[8:11], s45 offen offset:1024 sc1 lds
    buffer_load_dwordx4 v5, s[8:11], s45 offen offset:2048 sc1 lds
    buffer_load_dwordx4 v5, s[8:11], s45 offen offset:3072 sc1 lds
    s_add_u32 m0, s49, 98304
    s_nop 0
    buffer_load_dwordx4 v8, s[12:15], s46 offen lds
    buffer_load_dwordx4 v10, s[12:15], s46 offen offset:1024 lds
    v_readlane_b32 s45, v3, s52
    v_readlane_b32 s46, v4, s52
    s_add_u32 s52, s52, 1
    s_waitcnt vmcnt(12)
    s_barrier
    s_add_u32 m0, s48, 0
    s_nop 0
    buffer_load_dwordx4 v5, s[8:11], s45 offen sc1 lds
    buffer_load_dwordx4 v5, s[8:11], s45 offen offset:1024 sc1 lds
    buffer_load_dwordx4 v5, s[8:11], s45 offen offset:2048 sc1 lds
    buffer_load_dwordx4 v5, s[8:11], s45 offen offset:3072 sc1 lds
    s_add_u32 m0, s49, 0
    s_nop 0
    buffer_load_dwordx4 v8, s[12:15], s46 offen lds
    buffer_load_dwordx4 v10, s[12:15], s46 offen offset:1024 lds
    v_readlane_b32 s45, v3, s52
    v_readlane_b32 s46, v4, s52
    s_add_u32 s52, s52, 1
    s_waitcnt vmcnt(12)
    s_barrier
    s_add_u32 m0, s48, 32768
    s_nop 0
    buffer_load_dwordx4 v5, s[8:11], s45 offen sc1 lds
    buffer_load_dwordx4 v5, s[8:11], s45 offen offset:1024 sc1 lds
    buffer_load_dwordx4 v5, s[8:11], s45 offen offset:2048 sc1 lds
    buffer_load_dwordx4 v5, s[8:11], s45 offen offset:3072 sc1 lds
    s_add_u32 m0, s49, 32768
    s_nop 0
    buffer_load_dwordx4 v8, s[12:15], s46 offen lds
    buffer_load_dwordx4 v10, s[12:15], s46 offen offset:1024 lds
    v_readlane_b32 s45, v3, s52
    v_readlane_b32 s46, v4, s52
    s_add_u32 s52, s52, 1
    s_waitcnt vmcnt(12)
    s_barrier
    s_add_u32 m0, s48, 65536
    s_nop 0
    buffer_load_dwordx4 v5, s[8:11], s45 offen sc1 lds
    buffer_load_dwordx4 v5, s[8:11], s45 offen offset:1024 sc1 lds
    buffer_load_dwordx4 v5, s[8:11], s45 offen offset:2048 sc1 lds
    buffer_load_dwordx4 v5, s[8:11], s45 offen offset:3072 sc1 lds
    s_add_u32 m0, s49, 65536
    s_nop 0
    buffer_load_dwordx4 v8, s[12:15], s46 offen lds
    buffer_load_dwordx4 v10, s[12:15], s46 offen offset:1024 lds
    v_readlane_b32 s45, v3, s52
    v_readlane_b32 s46, v4, s52
    s_add_u32 s52, s52, 1
    s_waitcnt vmcnt(12)
    s_barrier
    s_add_u32 m0, s48, 98304
    s_nop 0
    buffer_load_dwordx4 v5, s[8:11], s45 offen sc1 lds
    buffer_load_dwordx4 v5, s[8:11], s45 offen offset:1024 sc1 lds
    buffer_load_dwordx4 v5, s[8:11], s45 offen offset:2048 sc1 lds
    buffer_load_dwordx4 v5, s[8:11], s45 offen offset:3072 sc1 lds
    s_add_u32 m0, s49, 98304
    s_nop 0
    buffer_load_dwordx4 v8, s[12:15], s46 offen lds
    buffer_load_dwordx4 v10, s[12:15], s46 offen offset:1024 lds
    s_mov_b32 s90, 200000
fx_p:
    v_cmp_ne_u32 vcc, s3, v242
    s_nop 0
    s_cmp_eq_u64 vcc, 0
    s_cbranch_scc1 fx_y
    buffer_load_dword v242, v243, s[84:87], s62 offen sc1
    s_sub_u32 s90, s90, 1
    s_waitcnt vmcnt(0)
    s_cmp_lg_u32 s90, 0
    s_cbranch_scc1 fx_p
fx_y:
    s_add_u32 s16, s6, 29360128
    s_addc_u32 s17, s7, 0
    s_mov_b32 s18, 4194304
    s_mov_b32 s19, 0x20000
    s_sub_u32 s59, s42, 4
    s_lshl_b32 s60, s40, 2
    s_add_u32 s60, s60, s59
    s_lshl_b32 s60, s60, 16
    s_lshl_b32 s61, s41, 11
    s_add_u32 s60, s60, s61
    s_add_u32 s61, s60, 30720
    s_lshl_b32 s59, s59, 12
    s_add_u32 m0, s59, 147456
    v_lshlrev_b32 v13, 4, v1
    buffer_load_dwordx4 v13, s[16:19], s60 offen offset:0 sc1 lds
    buffer_load_dwordx4 v13, s[16:19], s60 offen offset:1024 sc1 lds
    buffer_load_dwordx4 v13, s[16:19], s61 offen offset:2048 sc1 lds
    buffer_load_dwordx4 v13, s[16:19], s61 offen offset:3072 sc1 lds
    s_waitcnt vmcnt(16)
    s_barrier
    s_cmp_lg_u32 s42, 4
    s_cbranch_scc1 f8_ns
    s_lshl_b32 s88, s2, 7
    s_add_u32 s88, s88, 262144
    v_mov_b32 v253, s3
    s_mov_b64 exec, 1
    buffer_store_dword v253, v252, s[84:87], s88 offen sc1
    s_mov_b64 exec, -1
f8_ns:
    s_waitcnt vmcnt(10)
    s_xor_b32 s89, s2, 4
    s_lshl_b32 s89, s89, 7
    s_add_u32 s89, s89, 262144
    s_mov_b32 s90, 200000
    v_mov_b32 v241, 0
    buffer_load_dword v240, v241, s[84:87], s89 offen sc1
    s_barrier
    s_waitcnt vmcnt(5)
    s_waitcnt vmcnt(1)
    s_waitcnt vmcnt(0)
f8_p:
    v_cmp_ne_u32 vcc, s3, v240
    s_nop 0
    s_cmp_eq_u64 vcc, 0
    s_cbranch_scc1 f8_y
    buffer_load_dword v240, v241, s[84:87], s89 offen sc1
    s_sub_u32 s90, s90, 1
    s_waitcnt vmcnt(0)
    s_cmp_lg_u32 s90, 0
    s_cbranch_scc1 f8_p
f8_y:
    s_barrier
    s_endpgm
mega_cons:
    s_load_dwordx2 s[6:7], s[0:1], 104
    s_load_dwordx2 s[34:35], s[0:1], 0
    s_and_b32 s36, s2, 7
    s_lshr_b32 s37, s2, 3
    s_and_b32 s38, s36, 1
    s_lshr_b32 s36, s36, 1
    s_and_b32 s39, s37, 7
    s_lshr_b32 s37, s37, 3
    s_mul_i32 s38, s38, 8
    s_add_u32 s40, s38, s39
    s_mul_i32 s36, s36, 4
    s_add_u32 s41, s36, s37
    s_add_u32 s39, s39, s37
    s_and_b32 s39, s39, 3
    s_mul_i32 s43, s41, 128
    s_lshl_b32 s20, s40, 3
    s_lshr_b32 s21, s41, 1
    s_add_u32 s20, s20, s21
    s_and_b32 s21, s41, 1
    v_lshrrev_b32 v2, 6, v0
    v_and_b32 v3, 15, v0
    v_bfe_u32 v4, v0, 4, 2
    v_lshlrev_b32 v5, 11, v3
    v_lshl_add_u32 v5, v2, 8, v5
    v_lshl_add_u32 v5, v4, 4, v5
    s_lshl_b32 s22, s20, 15
    s_lshl_b32 s23, s21, 10
    s_add_u32 s23, s23, s22
    s_xor_b32 s25, s23, 1024
    s_waitcnt lgkmcnt(0)
    s_load_dword s3, s[6:7], 524288
    s_mov_b32 s8, s34
    s_mov_b32 s9, s35
    s_mov_b32 s10, 4194304
    s_mov_b32 s11, 0x20000
    s_barrier
    buffer_load_dwordx4 v[32:35], v5, s[8:11], s23 offen offset:0
    buffer_load_dwordx4 v[36:39], v5, s[8:11], s23 offen offset:64
    buffer_load_dwordx4 v[40:43], v5, s[8:11], s23 offen offset:128
    buffer_load_dwordx4 v[44:47], v5, s[8:11], s23 offen offset:192
    buffer_load_dwordx4 v[144:147], v5, s[8:11], s25 offen offset:0
    buffer_load_dwordx4 v[148:151], v5, s[8:11], s25 offen offset:64
    buffer_load_dwordx4 v[152:155], v5, s[8:11], s25 offen offset:128
    buffer_load_dwordx4 v[156:159], v5, s[8:11], s25 offen offset:192
    s_add_u32 s12, s6, 983040
    s_addc_u32 s13, s7, 0
    s_mov_b32 s14, 65536
    s_mov_b32 s15, 0x20000
    s_add_u32 s28, s6, 8388608
    s_addc_u32 s29, s7, 0
    s_mov_b32 s30, 4194304
    s_mov_b32 s31, 0x20000
    v_lshlrev_b32 v7, 4, v0
    s_lshl_b32 s24, s21, 12
    v_mov_b32 v12, 0x3f803f80
    v_lshlrev_b32 v6, 5, v3
    v_add_u32 v6, 90112, v6
    v_lshl_add_u32 v10, v2, 3, v6
    s_waitcnt vmcnt(7)
    v_dot2_f32_bf16 v16, v32, v12, 0
    v_dot2_f32_bf16 v20, v32, v32, 0
    v_dot2_f32_bf16 v17, v33, v12, 0
    v_dot2_f32_bf16 v21, v33, v33, 0
    v_dot2_f32_bf16 v18, v34, v12, 0
    v_dot2_f32_bf16 v22, v34, v34, 0
    v_dot2_f32_bf16 v19, v35, v12, 0
    v_dot2_f32_bf16 v23, v35, v35, 0
    s_waitcnt vmcnt(6)
    v_dot2_f32_bf16 v16, v36, v12, v16
    v_dot2_f32_bf16 v20, v36, v36, v20
    v_dot2_f32_bf16 v17, v37, v12, v17
    v_dot2_f32_bf16 v21, v37, v37, v21
    v_dot2_f32_bf16 v18, v38, v12, v18
    v_dot2_f32_bf16 v22, v38, v38, v22
    v_dot2_f32_bf16 v19, v39, v12, v19
    v_dot2_f32_bf16 v23, v39, v39, v23
    s_waitcnt vmcnt(5)
    v_dot2_f32_bf16 v16, v40, v12, v16
    v_dot2_f32_bf16 v20, v40, v40, v20
    v_dot2_f32_bf16 v17, v41, v12, v17
    v_dot2_f32_bf16 v21, v41, v41, v21
    v_dot2_f32_bf16 v18, v42, v12, v18
    v_dot2_f32_bf16 v22, v42, v42, v22
    v_dot2_f32_bf16 v19, v43, v12, v19
    v_dot2_f32_bf16 v23, v43, v43, v23
    s_waitcnt vmcnt(4)
    v_dot2_f32_bf16 v16, v44, v12, v16
    v_dot2_f32_bf16 v20, v44, v44, v20
    v_dot2_f32_bf16 v17, v45, v12, v17
    v_dot2_f32_bf16 v21, v45, v45, v21
    v_dot2_f32_bf16 v18, v46, v12, v18
    v_dot2_f32_bf16 v22, v46, v46, v22
    v_dot2_f32_bf16 v19, v47, v12, v19
    v_dot2_f32_bf16 v23, v47, v47, v23
    s_waitcnt vmcnt(3)
    v_dot2_f32_bf16 v16, v144, v12, v16
    v_dot2_f32_bf16 v20, v144, v144, v20
    v_dot2_f32_bf16 v17, v145, v12, v17
    v_dot2_f32_bf16 v21, v145, v145, v21
    v_dot2_f32_bf16 v18, v146, v12, v18
    v_dot2_f32_bf16 v22, v146, v146, v22
    v_dot2_f32_bf16 v19, v147, v12, v19
    v_dot2_f32_bf16 v23, v147, v147, v23
    s_waitcnt vmcnt(2)
    v_dot2_f32_bf16 v16, v148, v12, v16
    v_dot2_f32_bf16 v20, v148, v148, v20
    v_dot2_f32_bf16 v17, v149, v12, v17
    v_dot2_f32_bf16 v21, v149, v149, v21
    v_dot2_f32_bf16 v18, v150, v12, v18
    v_dot2_f32_bf16 v22, v150, v150, v22
    v_dot2_f32_bf16 v19, v151, v12, v19
    v_dot2_f32_bf16 v23, v151, v151, v23
    s_waitcnt vmcnt(1)
    v_dot2_f32_bf16 v16, v152, v12, v16
    v_dot2_f32_bf16 v20, v152, v152, v20
    v_dot2_f32_bf16 v17, v153, v12, v17
    v_dot2_f32_bf16 v21, v153, v153, v21
    v_dot2_f32_bf16 v18, v154, v12, v18
    v_dot2_f32_bf16 v22, v154, v154, v22
    v_dot2_f32_bf16 v19, v155, v12, v19
    v_dot2_f32_bf16 v23, v155, v155, v23
    s_waitcnt vmcnt(0)
    v_dot2_f32_bf16 v16, v156, v12, v16
    v_dot2_f32_bf16 v20, v156, v156, v20
    v_dot2_f32_bf16 v17, v157, v12, v17
    v_dot2_f32_bf16 v21, v157, v157, v21
    v_dot2_f32_bf16 v18, v158, v12, v18
    v_dot2_f32_bf16 v22, v158, v158, v22
    v_dot2_f32_bf16 v19, v159, v12, v19
    v_dot2_f32_bf16 v23, v159, v159, v23
    v_add_f32 v16, v16, v17
    s_nop 0
    v_add_f32 v18, v18, v19
    v_add_f32 v20, v20, v21
    v_add_f32 v22, v22, v23
    v_add_f32 v16, v16, v18
    v_add_f32 v17, v20, v22
    v_mov_b32 v18, v16
    v_mov_b32 v19, v17
    s_nop 0
    v_permlane32_swap_b32 v16, v18
    v_permlane32_swap_b32 v17, v19
    v_add_f32 v16, v16, v18
    v_add_f32 v17, v17, v19
    v_mov_b32 v18, v16
    v_mov_b32 v19, v17
    s_nop 0
    v_permlane16_swap_b32 v16, v18
    v_permlane16_swap_b32 v17, v19
    v_add_f32 v16, v16, v18
    v_add_f32 v17, v17, v19
    ds_write_b64 v10, v[16:17]
    v_lshlrev_b32 v48, 16, v32
    v_and_b32 v49, 0xffff0000, v32
    v_lshlrev_b32 v50, 16, v33
    v_and_b32 v51, 0xffff0000, v33
    v_lshlrev_b32 v52, 16, v34
    v_and_b32 v53, 0xffff0000, v34
    v_lshlrev_b32 v54, 16, v35
    v_and_b32 v55, 0xffff0000, v35
    v_lshlrev_b32 v56, 16, v36
    v_and_b32 v57, 0xffff0000, v36
    v_lshlrev_b32 v58, 16, v37
    v_and_b32 v59, 0xffff0000, v37
    v_lshlrev_b32 v60, 16, v38
    v_and_b32 v61, 0xffff0000, v38
    v_lshlrev_b32 v62, 16, v39
    v_and_b32 v63, 0xffff0000, v39
    v_lshlrev_b32 v64, 16, v40
    v_and_b32 v65, 0xffff0000, v40
    v_lshlrev_b32 v66, 16, v41
    v_and_b32 v67, 0xffff0000, v41
    v_lshlrev_b32 v68, 16, v42
    v_and_b32 v69, 0xffff0000, v42
    v_lshlrev_b32 v70, 16, v43
    v_and_b32 v71, 0xffff0000, v43
    v_lshlrev_b32 v72, 16, v44
    v_and_b32 v73, 0xffff0000, v44
    v_lshlrev_b32 v74, 16, v45
    v_and_b32 v75, 0xffff0000, v45
    v_lshlrev_b32 v76, 16, v46
    v_and_b32 v77, 0xffff0000, v46
    v_lshlrev_b32 v78, 16, v47
    v_and_b32 v79, 0xffff0000, v47
    s_waitcnt lgkmcnt(0)
    s_mul_i32 s3, s3, 0x9e3779b1
    s_add_u32 s3, s3, 0x7f4a7c15
    s_mov_b32 s27, 200000
    s_barrier
    ds_read_b128 v[16:19], v6
    ds_read_b128 v[20:23], v6 offset:16
ln1_poll:
    s_add_u32 s26, s24, 8192
    buffer_load_dwordx4 v[144:147], v7, s[12:15], s26 offen sc1
    s_add_u32 s26, s24, 0
    buffer_load_dwordx4 v[148:151], v7, s[12:15], s26 offen sc1
    s_add_u32 s26, s24, 24576
    buffer_load_dwordx4 v[152:155], v7, s[12:15], s26 offen sc1
    s_add_u32 s26, s24, 16384
    buffer_load_dwordx4 v[156:159], v7, s[12:15], s26 offen sc1
    s_add_u32 s26, s24, 40960
    buffer_load_dwordx4 v[160:163], v7, s[12:15], s26 offen sc1
    s_add_u32 s26, s24, 32768
    buffer_load_dwordx4 v[164:167], v7, s[12:15], s26 offen sc1
    s_add_u32 s26, s24, 57344
    buffer_load_dwordx4 v[168:171], v7, s[12:15], s26 offen sc1
    s_add_u32 s26, s24, 49152
    buffer_load_dwordx4 v[172:175], v7, s[12:15], s26 offen sc1
ln1_chk:
    s_sub_u32 s27, s27, 1
    s_waitcnt vmcnt(0)
    v_min3_u32 v24, v145, v147, v149
    v_min3_u32 v24, v24, v151, v153
    v_min3_u32 v24, v24, v155, v157
    v_min3_u32 v24, v24, v159, v161
    v_min3_u32 v24, v24, v163, v165
    v_min3_u32 v24, v24, v167, v169
    v_min3_u32 v24, v24, v171, v173
    v_min3_u32 v24, v24, v175, v175
    v_max3_u32 v25, v145, v147, v149
    v_max3_u32 v25, v25, v151, v153
    v_max3_u32 v25, v25, v155, v157
    v_max3_u32 v25, v25, v159, v161
    v_max3_u32 v25, v25, v163, v165
    v_max3_u32 v25, v25, v167, v169
    v_max3_u32 v25, v25, v171, v173
    v_max3_u32 v25, v25, v175, v175
    v_xor_b32 v24, s3, v24
    v_xor_b32 v25, s3, v25
    v_or_b32 v24, v24, v25
    v_cmp_ne_u32 vcc, 0, v24
    s_nop 0
    s_cmp_eq_u64 vcc, 0
    s_cbranch_scc1 ln1_ok
    s_cmp_lg_u32 s27, 0
    s_cbranch_scc1 ln1_poll
ln1_ok:
    v_lshrrev_b32 v6, 2, v0
    v_lshlrev_b32 v6, 6, v6
    v_and_b32 v7, 3, v0
    v_lshl_add_u32 v6, v7, 3, v6
    v_add_u32 v6, 81920, v6
    v_add_f32 v144, v144, v152
    v_add_f32 v160, v160, v168
    v_add_f32 v146, v146, v154
    v_add_f32 v162, v162, v170
    v_add_f32 v148, v148, v156
    v_add_f32 v164, v164, v172
    v_add_f32 v150, v150, v158
    v_add_f32 v166, v166, v174
    v_add_f32 v24, v144, v160
    v_add_f32 v25, v146, v162
    v_add_f32 v26, v148, v164
    v_add_f32 v27, v150, v166
    v_cvt_pk_bf16_f32 v28, v24, v25
    v_cvt_pk_bf16_f32 v29, v26, v27
    v_lshlrev_b32 v24, 16, v28
    v_and_b32 v25, 0xffff0000, v28
    v_lshlrev_b32 v26, 16, v29
    v_and_b32 v27, 0xffff0000, v29
    v_add_f32 v24, 1.0, v24
    v_add_f32 v25, 1.0, v25
    v_cvt_pk_bf16_f32 v28, v24, v25
    v_lshlrev_b32 v24, 16, v28
    v_and_b32 v25, 0xffff0000, v28
    ds_write_b64 v6, v[24:25]
    ds_write_b64 v6, v[26:27] offset:32
    s_waitcnt lgkmcnt(2)
    v_pk_add_f32 v[16:17], v[16:17], v[18:19]
    v_pk_add_f32 v[20:21], v[20:21], v[22:23]
    v_pk_add_f32 v[16:17], v[16:17], v[20:21]
    v_mul_f32 v9, 0x3a800000, v16
    v_mov_b32 v18, 0x3a800000
    v_mul_f32 v8, v9, v9
    v_fma_f32 v8, v17, v18, -v8
    v_max_f32 v8, 0, v8
    v_add_f32 v8, 0x3727c5ac, v8
    v_rsq_f32 v8, v8
    v_lshlrev_b32 v6, 10, v2
    v_lshl_add_u32 v6, v4, 6, v6
    v_add_u32 v6, 81920, v6
    v_lshlrev_b32 v5, 12, v2
    v_lshl_add_u32 v5, v1, 4, v5
    s_lshl_b32 s23, s21, 14
    s_mul_i32 s22, s20, 32768
    s_add_u32 s23, s23, s22
    s_waitcnt lgkmcnt(0)
    s_barrier
    ds_read_b128 v[80:83], v6 offset:0
    ds_read_b128 v[84:87], v6 offset:16
    ds_read_b128 v[88:91], v6 offset:32
    ds_read_b128 v[92:95], v6 offset:48
    ds_read_b128 v[96:99], v6 offset:256
    ds_read_b128 v[100:103], v6 offset:272
    ds_read_b128 v[104:107], v6 offset:288
    ds_read_b128 v[108:111], v6 offset:304
    ds_read_b128 v[112:115], v6 offset:512
    ds_read_b128 v[116:119], v6 offset:528
    ds_read_b128 v[120:123], v6 offset:544
    ds_read_b128 v[124:127], v6 offset:560
    ds_read_b128 v[128:131], v6 offset:768
    ds_read_b128 v[132:135], v6 offset:784
    ds_read_b128 v[136:139], v6 offset:800
    ds_read_b128 v[140:143], v6 offset:816
    v_mul_f32 v9, -v9, v8
    v_pk_fma_f32 v[48:49], v[48:49], v[8:9], v[8:9] op_sel:[0,0,1] op_sel_hi:[1,0,1]
    v_pk_fma_f32 v[50:51], v[50:51], v[8:9], v[8:9] op_sel:[0,0,1] op_sel_hi:[1,0,1]
    v_pk_fma_f32 v[52:53], v[52:53], v[8:9], v[8:9] op_sel:[0,0,1] op_sel_hi:[1,0,1]
    v_pk_fma_f32 v[54:55], v[54:55], v[8:9], v[8:9] op_sel:[0,0,1] op_sel_hi:[1,0,1]
    v_pk_fma_f32 v[56:57], v[56:57], v[8:9], v[8:9] op_sel:[0,0,1] op_sel_hi:[1,0,1]
    v_pk_fma_f32 v[58:59], v[58:59], v[8:9], v[8:9] op_sel:[0,0,1] op_sel_hi:[1,0,1]
    v_pk_fma_f32 v[60:61], v[60:61], v[8:9], v[8:9] op_sel:[0,0,1] op_sel_hi:[1,0,1]
    v_pk_fma_f32 v[62:63], v[62:63], v[8:9], v[8:9] op_sel:[0,0,1] op_sel_hi:[1,0,1]
    v_pk_fma_f32 v[64:65], v[64:65], v[8:9], v[8:9] op_sel:[0,0,1] op_sel_hi:[1,0,1]
    v_pk_fma_f32 v[66:67], v[66:67], v[8:9], v[8:9] op_sel:[0,0,1] op_sel_hi:[1,0,1]
    v_pk_fma_f32 v[68:69], v[68:69], v[8:9], v[8:9] op_sel:[0,0,1] op_sel_hi:[1,0,1]
    v_pk_fma_f32 v[70:71], v[70:71], v[8:9], v[8:9] op_sel:[0,0,1] op_sel_hi:[1,0,1]
    v_pk_fma_f32 v[72:73], v[72:73], v[8:9], v[8:9] op_sel:[0,0,1] op_sel_hi:[1,0,1]
    v_pk_fma_f32 v[74:75], v[74:75], v[8:9], v[8:9] op_sel:[0,0,1] op_sel_hi:[1,0,1]
    v_pk_fma_f32 v[76:77], v[76:77], v[8:9], v[8:9] op_sel:[0,0,1] op_sel_hi:[1,0,1]
    v_pk_fma_f32 v[78:79], v[78:79], v[8:9], v[8:9] op_sel:[0,0,1] op_sel_hi:[1,0,1]
    s_waitcnt lgkmcnt(12)
    v_pk_fma_f32 v[48:49], v[48:49], v[80:81], v[88:89]
    v_pk_fma_f32 v[50:51], v[50:51], v[82:83], v[90:91]
    v_pk_fma_f32 v[52:53], v[52:53], v[84:85], v[92:93]
    v_pk_fma_f32 v[54:55], v[54:55], v[86:87], v[94:95]
    v_cvt_pk_bf16_f32 v32, v48, v49
    v_cvt_pk_bf16_f32 v33, v50, v51
    v_cvt_pk_bf16_f32 v34, v52, v53
    v_cvt_pk_bf16_f32 v35, v54, v55
    buffer_store_dwordx4 v[32:35], v5, s[28:31], s23 offen offset:0 sc1
    s_waitcnt lgkmcnt(8)
    v_pk_fma_f32 v[56:57], v[56:57], v[96:97], v[104:105]
    v_pk_fma_f32 v[58:59], v[58:59], v[98:99], v[106:107]
    v_pk_fma_f32 v[60:61], v[60:61], v[100:101], v[108:109]
    v_pk_fma_f32 v[62:63], v[62:63], v[102:103], v[110:111]
    v_cvt_pk_bf16_f32 v36, v56, v57
    v_cvt_pk_bf16_f32 v37, v58, v59
    v_cvt_pk_bf16_f32 v38, v60, v61
    v_cvt_pk_bf16_f32 v39, v62, v63
    buffer_store_dwordx4 v[36:39], v5, s[28:31], s23 offen offset:1024 sc1
    s_waitcnt lgkmcnt(4)
    v_pk_fma_f32 v[64:65], v[64:65], v[112:113], v[120:121]
    v_pk_fma_f32 v[66:67], v[66:67], v[114:115], v[122:123]
    v_pk_fma_f32 v[68:69], v[68:69], v[116:117], v[124:125]
    v_pk_fma_f32 v[70:71], v[70:71], v[118:119], v[126:127]
    v_cvt_pk_bf16_f32 v40, v64, v65
    v_cvt_pk_bf16_f32 v41, v66, v67
    v_cvt_pk_bf16_f32 v42, v68, v69
    v_cvt_pk_bf16_f32 v43, v70, v71
    buffer_store_dwordx4 v[40:43], v5, s[28:31], s23 offen offset:2048 sc1
    s_waitcnt lgkmcnt(0)
    v_pk_fma_f32 v[72:73], v[72:73], v[128:129], v[136:137]
    v_pk_fma_f32 v[74:75], v[74:75], v[130:131], v[138:139]
    v_pk_fma_f32 v[76:77], v[76:77], v[132:133], v[140:141]
    v_pk_fma_f32 v[78:79], v[78:79], v[134:135], v[142:143]
    v_cvt_pk_bf16_f32 v44, v72, v73
    v_cvt_pk_bf16_f32 v45, v74, v75
    v_cvt_pk_bf16_f32 v46, v76, v77
    v_cvt_pk_bf16_f32 v47, v78, v79
    buffer_store_dwordx4 v[44:47], v5, s[28:31], s23 offen offset:3072 sc1
    s_waitcnt vmcnt(0)
    s_barrier
    s_add_u32 s24, s6, 1048576
    s_addc_u32 s25, s7, 0
    s_mov_b32 s26, 33554432
    s_mov_b32 s27, 0x20000
    s_add_u32 s28, s6, 131072
    s_addc_u32 s29, s7, 0
    s_mov_b32 s30, 2097152
    s_mov_b32 s31, 0x20000
    s_lshr_b32 s52, s42, 1
    s_and_b32 s53, s42, 1
    s_mul_i32 s54, s52, 8192
    v_lshl_add_u32 v4, v1, 4, s54
    v_bfe_u32 v2, v1, 2, 2
    v_lshrrev_b32 v3, 4, v1
    v_lshl_add_u32 v2, v3, 3, v2
    v_bfe_u32 v3, v1, 3, 2
    s_lshl_b32 s54, s53, 1
    v_xor_b32 v6, s54, v3
    v_lshlrev_b32 v6, 5, v6
    v_lshl_add_u32 v6, v2, 7, v6
    v_and_b32 v3, 3, v1
    v_lshlrev_b32 v3, 3, v3
    v_add_u32 v3, 16384, v3
    v_add_u32 v6, v6, v3
    v_xor_b32 v7, 32, v6
    s_mov_b32 s47, 0
    s_mov_b32 s55, 40960
    v_and_b32 v2, 15, v1
    v_lshrrev_b32 v3, 4, v1
    v_lshrrev_b32 v15, 1, v2
    v_and_b32 v15, 3, v15
    v_lshlrev_b32 v15, 2, v15
    v_and_b32 v14, 1, v2
    v_or_b32 v15, v15, v14
    v_lshrrev_b32 v14, 2, v2
    v_and_b32 v14, 2, v14
    v_or_b32 v15, v15, v14
    v_xor_b32 v15, v15, v3
    v_lshlrev_b32 v2, 7, v2
    s_lshl_b32 s61, s42, 13
    s_add_u32 s61, s61, 40960
    v_add_u32 v2, s61, v2
    v_xor_b32 v14, 0, v15
    v_lshl_add_u32 v232, v14, 3, v2
    v_xor_b32 v14, 4, v15
    v_lshl_add_u32 v233, v14, 3, v2
    v_xor_b32 v14, 8, v15
    v_lshl_add_u32 v234, v14, 3, v2
    v_xor_b32 v14, 12, v15
    v_lshl_add_u32 v235, v14, 3, v2
    v_lshrrev_b32 v2, 2, v1
    v_and_b32 v3, 3, v1
    v_lshrrev_b32 v15, 1, v2
    v_and_b32 v15, 3, v15
    v_lshlrev_b32 v15, 2, v15
    v_and_b32 v14, 1, v2
    v_or_b32 v15, v15, v14
    v_lshrrev_b32 v14, 2, v2
    v_and_b32 v14, 2, v14
    v_or_b32 v15, v15, v14
    v_xor_b32 v15, v15, v3
    v_lshlrev_b32 v2, 7, v2
    s_lshl_b32 s61, s53, 13
    s_add_u32 s61, s61, 40960
    v_add_u32 v2, s61, v2
    s_lshl_b32 s61, s52, 3
    v_xor_b32 v15, s61, v15
    v_xor_b32 v14, 0, v15
    v_lshl_add_u32 v236, v14, 3, v2
    v_xor_b32 v14, 4, v15
    v_lshl_add_u32 v237, v14, 3, v2
    v_lshlrev_b32 v2, 2, v1
    v_add_u32 v2, 126976, v2
    v_mov_b32 v3, 0
    ds_write_b32 v2, v3
    s_waitcnt lgkmcnt(0)
    s_barrier
    s_barrier
    ds_read_b64_tr_b16 v[28:29], v6 offset:0
    ds_read_b64_tr_b16 v[30:31], v6 offset:512
    ds_read_b128 v[12:15], v4 offset:0
    ds_read_b128 v[16:19], v4 offset:2048
    ds_read_b128 v[20:23], v4 offset:4096
    ds_read_b128 v[24:27], v4 offset:6144
    ds_read_b64_tr_b16 v[32:33], v7 offset:0
    ds_read_b64_tr_b16 v[34:35], v7 offset:512
    ds_read_b64_tr_b16 v[36:37], v6 offset:8192
    ds_read_b64_tr_b16 v[38:39], v6 offset:8704
    ds_read_b64_tr_b16 v[40:41], v7 offset:8192
    ds_read_b64_tr_b16 v[42:43], v7 offset:8704
    ds_read_b64_tr_b16 v[44:45], v6 offset:16384
    ds_read_b64_tr_b16 v[46:47], v6 offset:16896
    ds_read_b64_tr_b16 v[48:49], v7 offset:16384
    ds_read_b64_tr_b16 v[50:51], v7 offset:16896
    s_waitcnt lgkmcnt(0)
    v_mfma_f32_16x16x32_bf16 v[92:95], v[28:31], v[12:15], 0
    ds_read_b64_tr_b16 v[68:69], v6 offset:4096
    v_mfma_f32_16x16x32_bf16 v[96:99], v[28:31], v[16:19], 0
    ds_read_b64_tr_b16 v[70:71], v6 offset:4608
    v_mfma_f32_16x16x32_bf16 v[100:103], v[28:31], v[20:23], 0
    ds_read_b128 v[52:55], v4 offset:1024
    v_mfma_f32_16x16x32_bf16 v[104:107], v[28:31], v[24:27], 0
    ds_read_b128 v[56:59], v4 offset:3072
    v_mfma_f32_16x16x32_bf16 v[108:111], v[32:35], v[12:15], 0
    ds_read_b128 v[60:63], v4 offset:5120
    v_mfma_f32_16x16x32_bf16 v[112:115], v[32:35], v[16:19], 0
    ds_read_b128 v[64:67], v4 offset:7168
    v_mfma_f32_16x16x32_bf16 v[116:119], v[32:35], v[20:23], 0
    ds_read_b64_tr_b16 v[72:73], v7 offset:4096
    v_mfma_f32_16x16x32_bf16 v[120:123], v[32:35], v[24:27], 0
    ds_read_b64_tr_b16 v[74:75], v7 offset:4608
    v_mfma_f32_16x16x32_bf16 v[124:127], v[36:39], v[12:15], 0
    ds_read_b64_tr_b16 v[76:77], v6 offset:12288
    v_mfma_f32_16x16x32_bf16 v[128:131], v[36:39], v[16:19], 0
    ds_read_b64_tr_b16 v[78:79], v6 offset:12800
    v_mfma_f32_16x16x32_bf16 v[132:135], v[36:39], v[20:23], 0
    ds_read_b64_tr_b16 v[80:81], v7 offset:12288
    v_mfma_f32_16x16x32_bf16 v[136:139], v[36:39], v[24:27], 0
    ds_read_b64_tr_b16 v[82:83], v7 offset:12800
    v_mfma_f32_16x16x32_bf16 v[140:143], v[40:43], v[12:15], 0
    ds_read_b64_tr_b16 v[84:85], v6 offset:20480
    v_mfma_f32_16x16x32_bf16 v[144:147], v[40:43], v[16:19], 0
    ds_read_b64_tr_b16 v[86:87], v6 offset:20992
    v_mfma_f32_16x16x32_bf16 v[148:151], v[40:43], v[20:23], 0
    ds_read_b64_tr_b16 v[88:89], v7 offset:20480
    v_mfma_f32_16x16x32_bf16 v[152:155], v[40:43], v[24:27], 0
    ds_read_b64_tr_b16 v[90:91], v7 offset:20992
    v_mfma_f32_16x16x32_bf16 v[156:159], v[12:15], v[44:47], 0
    s_add_u32 s47, s47, 1
    s_cmp_eq_u32 s47, 3
    v_mfma_f32_16x16x32_bf16 v[160:163], v[16:19], v[44:47], 0
    s_cselect_b32 s47, 0, s47
    s_cselect_b32 s54, -81920, s55
    v_mfma_f32_16x16x32_bf16 v[164:167], v[20:23], v[44:47], 0
    v_add_u32 v4, s54, v4
    v_mfma_f32_16x16x32_bf16 v[168:171], v[24:27], v[44:47], 0
    v_add_u32 v6, s54, v6
    v_mfma_f32_16x16x32_bf16 v[172:175], v[12:15], v[48:51], 0
    v_add_u32 v7, s54, v7
    v_mfma_f32_16x16x32_bf16 v[176:179], v[16:19], v[48:51], 0
    v_mfma_f32_16x16x32_bf16 v[180:183], v[20:23], v[48:51], 0
    v_mfma_f32_16x16x32_bf16 v[184:187], v[24:27], v[48:51], 0
    s_waitcnt lgkmcnt(0)
    v_mfma_f32_16x16x32_bf16 v[92:95], v[68:71], v[52:55], v[92:95]
    v_mfma_f32_16x16x32_bf16 v[96:99], v[68:71], v[56:59], v[96:99]
    s_barrier
    v_mfma_f32_16x16x32_bf16 v[100:103], v[68:71], v[60:63], v[100:103]
    ds_read_b64_tr_b16 v[28:29], v6 offset:0
    v_mfma_f32_16x16x32_bf16 v[104:107], v[68:71], v[64:67], v[104:107]
    ds_read_b64_tr_b16 v[30:31], v6 offset:512
    v_mfma_f32_16x16x32_bf16 v[108:111], v[72:75], v[52:55], v[108:111]
    ds_read_b128 v[12:15], v4 offset:0
    v_mfma_f32_16x16x32_bf16 v[112:115], v[72:75], v[56:59], v[112:115]
    ds_read_b128 v[16:19], v4 offset:2048
    v_mfma_f32_16x16x32_bf16 v[116:119], v[72:75], v[60:63], v[116:119]
    ds_read_b128 v[20:23], v4 offset:4096
    v_mfma_f32_16x16x32_bf16 v[120:123], v[72:75], v[64:67], v[120:123]
    ds_read_b128 v[24:27], v4 offset:6144
    v_mfma_f32_16x16x32_bf16 v[124:127], v[76:79], v[52:55], v[124:127]
    ds_read_b64_tr_b16 v[32:33], v7 offset:0
    v_mfma_f32_16x16x32_bf16 v[128:131], v[76:79], v[56:59], v[128:131]
    ds_read_b64_tr_b16 v[34:35], v7 offset:512
    v_mfma_f32_16x16x32_bf16 v[132:135], v[76:79], v[60:63], v[132:135]
    ds_read_b64_tr_b16 v[36:37], v6 offset:8192
    v_mfma_f32_16x16x32_bf16 v[136:139], v[76:79], v[64:67], v[136:139]
    ds_read_b64_tr_b16 v[38:39], v6 offset:8704
    v_mfma_f32_16x16x32_bf16 v[140:143], v[80:83], v[52:55], v[140:143]
    ds_read_b64_tr_b16 v[40:41], v7 offset:8192
    v_mfma_f32_16x16x32_bf16 v[144:147], v[80:83], v[56:59], v[144:147]
    ds_read_b64_tr_b16 v[42:43], v7 offset:8704
    v_mfma_f32_16x16x32_bf16 v[148:151], v[80:83], v[60:63], v[148:151]
    ds_read_b64_tr_b16 v[44:45], v6 offset:16384
    v_mfma_f32_16x16x32_bf16 v[152:155], v[80:83], v[64:67], v[152:155]
    ds_read_b64_tr_b16 v[46:47], v6 offset:16896
    v_mfma_f32_16x16x32_bf16 v[156:159], v[52:55], v[84:87], v[156:159]
    ds_read_b64_tr_b16 v[48:49], v7 offset:16384
    v_mfma_f32_16x16x32_bf16 v[160:163], v[56:59], v[84:87], v[160:163]
    ds_read_b64_tr_b16 v[50:51], v7 offset:16896
    v_mfma_f32_16x16x32_bf16 v[164:167], v[60:63], v[84:87], v[164:167]
    v_mfma_f32_16x16x32_bf16 v[168:171], v[64:67], v[84:87], v[168:171]
    v_mfma_f32_16x16x32_bf16 v[172:175], v[52:55], v[88:91], v[172:175]
    v_mfma_f32_16x16x32_bf16 v[176:179], v[56:59], v[88:91], v[176:179]
    v_mfma_f32_16x16x32_bf16 v[180:183], v[60:63], v[88:91], v[180:183]
    v_mfma_f32_16x16x32_bf16 v[184:187], v[64:67], v[88:91], v[184:187]
    s_mov_b32 s51, 14
    .p2align 3
qkv_cloop:
    s_waitcnt lgkmcnt(0)
    v_mfma_f32_16x16x32_bf16 v[92:95], v[28:31], v[12:15], v[92:95]
    ds_read_b64_tr_b16 v[68:69], v6 offset:4096
    v_mfma_f32_16x16x32_bf16 v[96:99], v[28:31], v[16:19], v[96:99]
    ds_read_b64_tr_b16 v[70:71], v6 offset:4608
    v_mfma_f32_16x16x32_bf16 v[100:103], v[28:31], v[20:23], v[100:103]
    ds_read_b128 v[52:55], v4 offset:1024
    v_mfma_f32_16x16x32_bf16 v[104:107], v[28:31], v[24:27], v[104:107]
    ds_read_b128 v[56:59], v4 offset:3072
    v_mfma_f32_16x16x32_bf16 v[108:111], v[32:35], v[12:15], v[108:111]
    ds_read_b128 v[60:63], v4 offset:5120
    v_mfma_f32_16x16x32_bf16 v[112:115], v[32:35], v[16:19], v[112:115]
    ds_read_b128 v[64:67], v4 offset:7168
    v_mfma_f32_16x16x32_bf16 v[116:119], v[32:35], v[20:23], v[116:119]
    ds_read_b64_tr_b16 v[72:73], v7 offset:4096
    v_mfma_f32_16x16x32_bf16 v[120:123], v[32:35], v[24:27], v[120:123]
    ds_read_b64_tr_b16 v[74:75], v7 offset:4608
    v_mfma_f32_16x16x32_bf16 v[124:127], v[36:39], v[12:15], v[124:127]
    ds_read_b64_tr_b16 v[76:77], v6 offset:12288
    v_mfma_f32_16x16x32_bf16 v[128:131], v[36:39], v[16:19], v[128:131]
    ds_read_b64_tr_b16 v[78:79], v6 offset:12800
    v_mfma_f32_16x16x32_bf16 v[132:135], v[36:39], v[20:23], v[132:135]
    ds_read_b64_tr_b16 v[80:81], v7 offset:12288
    v_mfma_f32_16x16x32_bf16 v[136:139], v[36:39], v[24:27], v[136:139]
    ds_read_b64_tr_b16 v[82:83], v7 offset:12800
    v_mfma_f32_16x16x32_bf16 v[140:143], v[40:43], v[12:15], v[140:143]
    ds_read_b64_tr_b16 v[84:85], v6 offset:20480
    v_mfma_f32_16x16x32_bf16 v[144:147], v[40:43], v[16:19], v[144:147]
    ds_read_b64_tr_b16 v[86:87], v6 offset:20992
    v_mfma_f32_16x16x32_bf16 v[148:151], v[40:43], v[20:23], v[148:151]
    ds_read_b64_tr_b16 v[88:89], v7 offset:20480
    v_mfma_f32_16x16x32_bf16 v[152:155], v[40:43], v[24:27], v[152:155]
    ds_read_b64_tr_b16 v[90:91], v7 offset:20992
    v_mfma_f32_16x16x32_bf16 v[156:159], v[12:15], v[44:47], v[156:159]
    s_add_u32 s47, s47, 1
    s_cmp_eq_u32 s47, 3
    v_mfma_f32_16x16x32_bf16 v[160:163], v[16:19], v[44:47], v[160:163]
    s_cselect_b32 s47, 0, s47
    s_cselect_b32 s54, -81920, s55
    v_mfma_f32_16x16x32_bf16 v[164:167], v[20:23], v[44:47], v[164:167]
    v_add_u32 v4, s54, v4
    v_mfma_f32_16x16x32_bf16 v[168:171], v[24:27], v[44:47], v[168:171]
    v_add_u32 v6, s54, v6
    v_mfma_f32_16x16x32_bf16 v[172:175], v[12:15], v[48:51], v[172:175]
    v_add_u32 v7, s54, v7
    v_mfma_f32_16x16x32_bf16 v[176:179], v[16:19], v[48:51], v[176:179]
    v_mfma_f32_16x16x32_bf16 v[180:183], v[20:23], v[48:51], v[180:183]
    v_mfma_f32_16x16x32_bf16 v[184:187], v[24:27], v[48:51], v[184:187]
    s_waitcnt lgkmcnt(0)
    v_mfma_f32_16x16x32_bf16 v[92:95], v[68:71], v[52:55], v[92:95]
    v_mfma_f32_16x16x32_bf16 v[96:99], v[68:71], v[56:59], v[96:99]
    s_barrier
    v_mfma_f32_16x16x32_bf16 v[100:103], v[68:71], v[60:63], v[100:103]
    ds_read_b64_tr_b16 v[28:29], v6 offset:0
    v_mfma_f32_16x16x32_bf16 v[104:107], v[68:71], v[64:67], v[104:107]
    ds_read_b64_tr_b16 v[30:31], v6 offset:512
    v_mfma_f32_16x16x32_bf16 v[108:111], v[72:75], v[52:55], v[108:111]
    ds_read_b128 v[12:15], v4 offset:0
    v_mfma_f32_16x16x32_bf16 v[112:115], v[72:75], v[56:59], v[112:115]
    ds_read_b128 v[16:19], v4 offset:2048
    v_mfma_f32_16x16x32_bf16 v[116:119], v[72:75], v[60:63], v[116:119]
    ds_read_b128 v[20:23], v4 offset:4096
    v_mfma_f32_16x16x32_bf16 v[120:123], v[72:75], v[64:67], v[120:123]
    ds_read_b128 v[24:27], v4 offset:6144
    v_mfma_f32_16x16x32_bf16 v[124:127], v[76:79], v[52:55], v[124:127]
    ds_read_b64_tr_b16 v[32:33], v7 offset:0
    v_mfma_f32_16x16x32_bf16 v[128:131], v[76:79], v[56:59], v[128:131]
    ds_read_b64_tr_b16 v[34:35], v7 offset:512
    v_mfma_f32_16x16x32_bf16 v[132:135], v[76:79], v[60:63], v[132:135]
    ds_read_b64_tr_b16 v[36:37], v6 offset:8192
    v_mfma_f32_16x16x32_bf16 v[136:139], v[76:79], v[64:67], v[136:139]
    ds_read_b64_tr_b16 v[38:39], v6 offset:8704
    v_mfma_f32_16x16x32_bf16 v[140:143], v[80:83], v[52:55], v[140:143]
    ds_read_b64_tr_b16 v[40:41], v7 offset:8192
    v_mfma_f32_16x16x32_bf16 v[144:147], v[80:83], v[56:59], v[144:147]
    ds_read_b64_tr_b16 v[42:43], v7 offset:8704
    v_mfma_f32_16x16x32_bf16 v[148:151], v[80:83], v[60:63], v[148:151]
    ds_read_b64_tr_b16 v[44:45], v6 offset:16384
    v_mfma_f32_16x16x32_bf16 v[152:155], v[80:83], v[64:67], v[152:155]
    ds_read_b64_tr_b16 v[46:47], v6 offset:16896
    v_mfma_f32_16x16x32_bf16 v[156:159], v[52:55], v[84:87], v[156:159]
    ds_read_b64_tr_b16 v[48:49], v7 offset:16384
    v_mfma_f32_16x16x32_bf16 v[160:163], v[56:59], v[84:87], v[160:163]
    ds_read_b64_tr_b16 v[50:51], v7 offset:16896
    v_mfma_f32_16x16x32_bf16 v[164:167], v[60:63], v[84:87], v[164:167]
    v_mfma_f32_16x16x32_bf16 v[168:171], v[64:67], v[84:87], v[168:171]
    v_mfma_f32_16x16x32_bf16 v[172:175], v[52:55], v[88:91], v[172:175]
    v_mfma_f32_16x16x32_bf16 v[176:179], v[56:59], v[88:91], v[176:179]
    v_mfma_f32_16x16x32_bf16 v[180:183], v[60:63], v[88:91], v[180:183]
    v_mfma_f32_16x16x32_bf16 v[184:187], v[64:67], v[88:91], v[184:187]
    s_sub_u32 s51, s51, 1
    s_cmp_lg_u32 s51, 0
    s_cbranch_scc1 qkv_cloop
    s_waitcnt lgkmcnt(0)
    v_mfma_f32_16x16x32_bf16 v[92:95], v[28:31], v[12:15], v[92:95]
    ds_read_b64_tr_b16 v[68:69], v6 offset:4096
    v_mfma_f32_16x16x32_bf16 v[96:99], v[28:31], v[16:19], v[96:99]
    ds_read_b64_tr_b16 v[70:71], v6 offset:4608
    v_mfma_f32_16x16x32_bf16 v[100:103], v[28:31], v[20:23], v[100:103]
    ds_read_b128 v[52:55], v4 offset:1024
    v_mfma_f32_16x16x32_bf16 v[104:107], v[28:31], v[24:27], v[104:107]
    ds_read_b128 v[56:59], v4 offset:3072
    v_mfma_f32_16x16x32_bf16 v[108:111], v[32:35], v[12:15], v[108:111]
    ds_read_b128 v[60:63], v4 offset:5120
    v_mfma_f32_16x16x32_bf16 v[112:115], v[32:35], v[16:19], v[112:115]
    ds_read_b128 v[64:67], v4 offset:7168
    v_mfma_f32_16x16x32_bf16 v[116:119], v[32:35], v[20:23], v[116:119]
    ds_read_b64_tr_b16 v[72:73], v7 offset:4096
    v_mfma_f32_16x16x32_bf16 v[120:123], v[32:35], v[24:27], v[120:123]
    ds_read_b64_tr_b16 v[74:75], v7 offset:4608
    v_mfma_f32_16x16x32_bf16 v[124:127], v[36:39], v[12:15], v[124:127]
    ds_read_b64_tr_b16 v[76:77], v6 offset:12288
    v_mfma_f32_16x16x32_bf16 v[128:131], v[36:39], v[16:19], v[128:131]
    ds_read_b64_tr_b16 v[78:79], v6 offset:12800
    v_mfma_f32_16x16x32_bf16 v[132:135], v[36:39], v[20:23], v[132:135]
    ds_read_b64_tr_b16 v[80:81], v7 offset:12288
    v_mfma_f32_16x16x32_bf16 v[136:139], v[36:39], v[24:27], v[136:139]
    ds_read_b64_tr_b16 v[82:83], v7 offset:12800
    v_mfma_f32_16x16x32_bf16 v[140:143], v[40:43], v[12:15], v[140:143]
    ds_read_b64_tr_b16 v[84:85], v6 offset:20480
    v_mfma_f32_16x16x32_bf16 v[144:147], v[40:43], v[16:19], v[144:147]
    ds_read_b64_tr_b16 v[86:87], v6 offset:20992
    v_mfma_f32_16x16x32_bf16 v[148:151], v[40:43], v[20:23], v[148:151]
    ds_read_b64_tr_b16 v[88:89], v7 offset:20480
    v_mfma_f32_16x16x32_bf16 v[152:155], v[40:43], v[24:27], v[152:155]
    ds_read_b64_tr_b16 v[90:91], v7 offset:20992
    v_mfma_f32_16x16x32_bf16 v[156:159], v[12:15], v[44:47], v[156:159]
    v_mfma_f32_16x16x32_bf16 v[160:163], v[16:19], v[44:47], v[160:163]
    v_mfma_f32_16x16x32_bf16 v[164:167], v[20:23], v[44:47], v[164:167]
    v_mfma_f32_16x16x32_bf16 v[168:171], v[24:27], v[44:47], v[168:171]
    v_mfma_f32_16x16x32_bf16 v[172:175], v[12:15], v[48:51], v[172:175]
    v_mfma_f32_16x16x32_bf16 v[176:179], v[16:19], v[48:51], v[176:179]
    v_mfma_f32_16x16x32_bf16 v[180:183], v[20:23], v[48:51], v[180:183]
    v_mfma_f32_16x16x32_bf16 v[184:187], v[24:27], v[48:51], v[184:187]
    s_waitcnt lgkmcnt(0)
    v_mfma_f32_16x16x32_bf16 v[92:95], v[68:71], v[52:55], v[92:95]
    v_mfma_f32_16x16x32_bf16 v[96:99], v[68:71], v[56:59], v[96:99]
    v_mfma_f32_16x16x32_bf16 v[100:103], v[68:71], v[60:63], v[100:103]
    v_mfma_f32_16x16x32_bf16 v[104:107], v[68:71], v[64:67], v[104:107]
    v_mfma_f32_16x16x32_bf16 v[108:111], v[72:75], v[52:55], v[108:111]
    v_mfma_f32_16x16x32_bf16 v[112:115], v[72:75], v[56:59], v[112:115]
    v_mfma_f32_16x16x32_bf16 v[116:119], v[72:75], v[60:63], v[116:119]
    v_mfma_f32_16x16x32_bf16 v[120:123], v[72:75], v[64:67], v[120:123]
    v_mfma_f32_16x16x32_bf16 v[124:127], v[76:79], v[52:55], v[124:127]
    v_mfma_f32_16x16x32_bf16 v[128:131], v[76:79], v[56:59], v[128:131]
    v_mfma_f32_16x16x32_bf16 v[132:135], v[76:79], v[60:63], v[132:135]
    v_mfma_f32_16x16x32_bf16 v[136:139], v[76:79], v[64:67], v[136:139]
    v_mfma_f32_16x16x32_bf16 v[140:143], v[80:83], v[52:55], v[140:143]
    v_mfma_f32_16x16x32_bf16 v[144:147], v[80:83], v[56:59], v[144:147]
    v_mfma_f32_16x16x32_bf16 v[148:151], v[80:83], v[60:63], v[148:151]
    v_mfma_f32_16x16x32_bf16 v[152:155], v[80:83], v[64:67], v[152:155]
    v_mfma_f32_16x16x32_bf16 v[156:159], v[52:55], v[84:87], v[156:159]
    v_mfma_f32_16x16x32_bf16 v[160:163], v[56:59], v[84:87], v[160:163]
    v_mfma_f32_16x16x32_bf16 v[164:167], v[60:63], v[84:87], v[164:167]
    v_mfma_f32_16x16x32_bf16 v[168:171], v[64:67], v[84:87], v[168:171]
    v_mfma_f32_16x16x32_bf16 v[172:175], v[52:55], v[88:91], v[172:175]
    v_mfma_f32_16x16x32_bf16 v[176:179], v[56:59], v[88:91], v[176:179]
    v_mfma_f32_16x16x32_bf16 v[180:183], v[60:63], v[88:91], v[180:183]
    v_mfma_f32_16x16x32_bf16 v[184:187], v[64:67], v[88:91], v[184:187]
    s_lshl_b32 s58, s41, 1
    s_add_u32 s58, s58, s53
    v_lshrrev_b32 v2, 2, v1
    v_lshlrev_b32 v2, 6, v2
    v_bfe_u32 v3, v1, 4, 1
    v_lshl_add_u32 v2, v3, 5, v2
    v_and_b32 v3, 3, v1
    v_lshl_add_u32 v2, v3, 3, v2
    s_lshl_b32 s59, s53, 11
    s_add_u32 s59, s59, 122880
    v_add_u32 v2, s59, v2
    v_xor_b32 v3, 32, v2
    ds_read_b64_tr_b16 v[188:189], v2 offset:0
    ds_read_b64_tr_b16 v[190:191], v2 offset:1024
    ds_read_b64_tr_b16 v[192:193], v3 offset:0
    ds_read_b64_tr_b16 v[194:195], v3 offset:1024
    s_mov_b32 s60, 0x3fb8aa3b
    v_lshlrev_b32 v4, 4, v1
    s_lshl_b32 s61, s42, 12
    s_add_u32 s61, s61, 90112
    v_add_u32 v3, s61, v4
    v_cvt_pk_bf16_f32 v28, v132, v133
    v_cvt_pk_bf16_f32 v29, v134, v135
    v_cvt_pk_bf16_f32 v30, v148, v149
    v_cvt_pk_bf16_f32 v31, v150, v151
    ds_write_b128 v3, v[28:31] offset:0
    v_cvt_pk_bf16_f32 v32, v136, v137
    v_cvt_pk_bf16_f32 v33, v138, v139
    v_cvt_pk_bf16_f32 v34, v152, v153
    v_cvt_pk_bf16_f32 v35, v154, v155
    ds_write_b128 v3, v[32:35] offset:1024
    v_cvt_pk_bf16_f32 v36, v100, v101
    v_cvt_pk_bf16_f32 v37, v102, v103
    v_cvt_pk_bf16_f32 v38, v116, v117
    v_cvt_pk_bf16_f32 v39, v118, v119
    ds_write_b128 v3, v[36:39] offset:2048
    v_cvt_pk_bf16_f32 v40, v104, v105
    v_cvt_pk_bf16_f32 v41, v106, v107
    v_cvt_pk_bf16_f32 v42, v120, v121
    v_cvt_pk_bf16_f32 v43, v122, v123
    ds_write_b128 v3, v[40:43] offset:3072
    v_cvt_pk_bf16_f32 v12, v124, v125
    v_cvt_pk_bf16_f32 v13, v126, v127
    v_cvt_pk_bf16_f32 v14, v140, v141
    v_cvt_pk_bf16_f32 v15, v142, v143
    v_cvt_pk_bf16_f32 v16, v128, v129
    v_cvt_pk_bf16_f32 v17, v130, v131
    v_cvt_pk_bf16_f32 v18, v144, v145
    v_cvt_pk_bf16_f32 v19, v146, v147
    s_waitcnt lgkmcnt(0)
    s_barrier
    v_mfma_f32_16x16x32_bf16 v[196:199], v[188:191], v[12:15], 0
    v_mfma_f32_16x16x32_bf16 v[200:203], v[192:195], v[12:15], 0
    v_mfma_f32_16x16x32_bf16 v[204:207], v[188:191], v[16:19], 0
    v_mfma_f32_16x16x32_bf16 v[208:211], v[192:195], v[16:19], 0
    v_cvt_pk_bf16_f32 v240, v92, v93
    v_cvt_pk_bf16_f32 v241, v94, v95
    v_cvt_pk_bf16_f32 v242, v108, v109
    v_cvt_pk_bf16_f32 v243, v110, v111
    v_cvt_pk_bf16_f32 v244, v96, v97
    v_cvt_pk_bf16_f32 v245, v98, v99
    v_max3_f32 v228, v196, v197, v198
    v_max3_f32 v229, v204, v205, v206
    v_max3_f32 v230, -v196, -v197, -v198
    v_max3_f32 v231, -v204, -v205, -v206
    v_max3_f32 v228, v228, v199, v200
    v_max3_f32 v229, v229, v207, v208
    v_max3_f32 v230, v230, -v199, -v200
    v_max3_f32 v231, v231, -v207, -v208
    v_max3_f32 v228, v228, v201, v202
    v_max3_f32 v229, v229, v209, v210
    v_max3_f32 v230, v230, -v201, -v202
    v_max3_f32 v231, v231, -v209, -v210
    v_max_f32 v228, v203, v228
    v_max_f32 v229, v211, v229
    v_max_f32 v230, -v203, v230
    v_max_f32 v231, -v211, v231
    v_cvt_pk_bf16_f32 v246, v112, v113
    v_cvt_pk_bf16_f32 v247, v114, v115
    v_permlane32_swap_b32 v228, v229
    v_permlane32_swap_b32 v230, v231
    s_lshl_b32 s61, s53, 1
    s_add_u32 s61, s61, s52
    v_max_f32 v228, v228, v229
    v_max_f32 v230, v230, v231
    s_lshl_b32 s61, s61, 12
    s_add_u32 s61, s61, 73728
    v_permlane16_swap_b32 v228, v230
    v_add_u32 v3, s61, v4
    v_cvt_pk_bf16_f32 v92, v156, v157
    v_max_f32 v228, v228, v230
    v_cvt_pk_bf16_f32 v93, v158, v159
    v_cvt_pk_bf16_f32 v94, v160, v161
    v_mov_b32 v230, v228
    v_cvt_pk_bf16_f32 v95, v162, v163
    ds_write_b128 v3, v[92:95] offset:0
    v_permlane16_swap_b32 v228, v230
    v_cvt_pk_bf16_f32 v96, v172, v173
    v_cvt_pk_bf16_f32 v97, v174, v175
    v_mov_b32 v229, v228
    v_mov_b32 v231, v230
    v_cvt_pk_bf16_f32 v98, v176, v177
    v_cvt_pk_bf16_f32 v99, v178, v179
    v_permlane32_swap_b32 v228, v229
    v_permlane32_swap_b32 v230, v231
    v_mul_f32 v228, s60, v228
    v_mul_f32 v229, s60, v229
    v_mul_f32 v230, s60, v230
    v_mul_f32 v231, s60, v231
    v_fma_f32 v212, v196, s60, -v228
    v_fma_f32 v213, v197, s60, -v228
    v_fma_f32 v214, v198, s60, -v228
    v_fma_f32 v215, v199, s60, -v228
    v_fma_f32 v216, v200, s60, -v228
    v_fma_f32 v217, v201, s60, -v228
    v_fma_f32 v218, v202, s60, -v228
    v_fma_f32 v219, v203, s60, -v228
    v_fma_f32 v196, -v196, s60, -v230
    v_fma_f32 v197, -v197, s60, -v230
    v_fma_f32 v198, -v198, s60, -v230
    v_fma_f32 v199, -v199, s60, -v230
    v_fma_f32 v200, -v200, s60, -v230
    v_fma_f32 v201, -v201, s60, -v230
    v_fma_f32 v202, -v202, s60, -v230
    v_fma_f32 v203, -v203, s60, -v230
    v_fma_f32 v220, v204, s60, -v229
    v_fma_f32 v221, v205, s60, -v229
    v_fma_f32 v222, v206, s60, -v229
    v_fma_f32 v223, v207, s60, -v229
    v_fma_f32 v224, v208, s60, -v229
    v_fma_f32 v225, v209, s60, -v229
    v_fma_f32 v226, v210, s60, -v229
    v_fma_f32 v227, v211, s60, -v229
    v_fma_f32 v204, -v204, s60, -v231
    v_fma_f32 v205, -v205, s60, -v231
    v_fma_f32 v206, -v206, s60, -v231
    v_fma_f32 v207, -v207, s60, -v231
    v_fma_f32 v208, -v208, s60, -v231
    v_fma_f32 v209, -v209, s60, -v231
    v_fma_f32 v210, -v210, s60, -v231
    v_fma_f32 v211, -v211, s60, -v231
    v_exp_f32 v212, v212
    v_exp_f32 v196, v196
    v_exp_f32 v213, v213
    v_exp_f32 v197, v197
    v_exp_f32 v214, v214
    v_exp_f32 v198, v198
    v_exp_f32 v215, v215
    v_exp_f32 v199, v199
    v_exp_f32 v216, v216
    v_exp_f32 v200, v200
    v_exp_f32 v217, v217
    v_exp_f32 v201, v201
    v_exp_f32 v218, v218
    v_exp_f32 v202, v202
    v_exp_f32 v219, v219
    v_exp_f32 v203, v203
    v_exp_f32 v220, v220
    v_exp_f32 v204, v204
    v_exp_f32 v221, v221
    v_exp_f32 v205, v205
    v_exp_f32 v222, v222
    v_exp_f32 v206, v206
    v_exp_f32 v223, v223
    v_exp_f32 v207, v207
    v_exp_f32 v224, v224
    v_exp_f32 v208, v208
    v_exp_f32 v225, v225
    v_exp_f32 v209, v209
    v_exp_f32 v226, v226
    v_exp_f32 v210, v210
    v_exp_f32 v227, v227
    v_exp_f32 v211, v211
    v_add_f32 v228, v212, v213
    v_add_f32 v229, v220, v221
    v_add_f32 v230, v196, v197
    v_add_f32 v231, v204, v205
    v_add_f32 v228, v228, v214
    v_add_f32 v229, v229, v222
    v_add_f32 v230, v230, v198
    v_add_f32 v231, v231, v206
    v_add_f32 v228, v228, v215
    v_add_f32 v229, v229, v223
    v_add_f32 v230, v230, v199
    v_add_f32 v231, v231, v207
    v_add_f32 v228, v228, v216
    v_add_f32 v229, v229, v224
    v_add_f32 v230, v230, v200
    v_add_f32 v231, v231, v208
    v_add_f32 v228, v228, v217
    v_add_f32 v229, v229, v225
    v_add_f32 v230, v230, v201
    v_add_f32 v231, v231, v209
    v_add_f32 v228, v228, v218
    v_add_f32 v229, v229, v226
    v_add_f32 v230, v230, v202
    v_add_f32 v231, v231, v210
    v_add_f32 v228, v228, v219
    v_add_f32 v229, v229, v227
    v_add_f32 v230, v230, v203
    v_add_f32 v231, v231, v211
    ds_write_b128 v3, v[96:99] offset:1024
    v_cvt_pk_bf16_f32 v100, v164, v165
    v_permlane32_swap_b32 v228, v229
    v_permlane32_swap_b32 v230, v231
    v_cvt_pk_bf16_f32 v101, v166, v167
    v_cvt_pk_bf16_f32 v102, v168, v169
    v_add_f32 v228, v228, v229
    v_add_f32 v230, v230, v231
    v_cvt_pk_bf16_f32 v103, v170, v171
    ds_write_b128 v3, v[100:103] offset:2048
    v_permlane16_swap_b32 v228, v230
    v_cvt_pk_bf16_f32 v104, v180, v181
    v_cvt_pk_bf16_f32 v105, v182, v183
    v_add_f32 v228, v228, v230
    v_cvt_pk_bf16_f32 v106, v184, v185
    v_cvt_pk_bf16_f32 v107, v186, v187
    v_mov_b32 v230, v228
    ds_write_b128 v3, v[104:107] offset:3072
    v_mov_b32 v76, 0x3f803f80
    v_permlane16_swap_b32 v228, v230
    v_mov_b32 v77, 0x3f803f80
    v_mov_b32 v78, 0x3f803f80
    v_mov_b32 v229, v228
    v_mov_b32 v231, v230
    v_mov_b32 v79, 0x3f803f80
    v_permlane32_swap_b32 v228, v229
    v_permlane32_swap_b32 v230, v231
    v_rcp_f32 v228, v228
    v_rcp_f32 v229, v229
    v_rcp_f32 v230, v230
    v_rcp_f32 v231, v231
    v_mul_f32 v212, v212, v228
    v_mul_f32 v213, v213, v228
    v_mul_f32 v214, v214, v228
    v_mul_f32 v215, v215, v228
    v_mul_f32 v216, v216, v228
    v_mul_f32 v217, v217, v228
    v_mul_f32 v218, v218, v228
    v_mul_f32 v219, v219, v228
    v_cvt_pk_bf16_f32 v212, v212, v213
    v_cvt_pk_bf16_f32 v213, v214, v215
    v_cvt_pk_bf16_f32 v214, v216, v217
    v_cvt_pk_bf16_f32 v215, v218, v219
    ds_write_b64 v232, v[212:213] offset:0
    ds_write_b64 v233, v[214:215] offset:0
    v_mul_f32 v220, v220, v229
    v_mul_f32 v221, v221, v229
    v_mul_f32 v222, v222, v229
    v_mul_f32 v223, v223, v229
    v_mul_f32 v224, v224, v229
    v_mul_f32 v225, v225, v229
    v_mul_f32 v226, v226, v229
    v_mul_f32 v227, v227, v229
    v_cvt_pk_bf16_f32 v220, v220, v221
    v_cvt_pk_bf16_f32 v221, v222, v223
    v_cvt_pk_bf16_f32 v222, v224, v225
    v_cvt_pk_bf16_f32 v223, v226, v227
    ds_write_b64 v232, v[220:221] offset:2048
    ds_write_b64 v233, v[222:223] offset:2048
    v_mul_f32 v196, v196, v230
    v_mul_f32 v197, v197, v230
    v_mul_f32 v198, v198, v230
    v_mul_f32 v199, v199, v230
    v_mul_f32 v200, v200, v230
    v_mul_f32 v201, v201, v230
    v_mul_f32 v202, v202, v230
    v_mul_f32 v203, v203, v230
    v_cvt_pk_bf16_f32 v196, v196, v197
    v_cvt_pk_bf16_f32 v197, v198, v199
    v_cvt_pk_bf16_f32 v198, v200, v201
    v_cvt_pk_bf16_f32 v199, v202, v203
    ds_write_b64 v234, v[196:197] offset:0
    ds_write_b64 v235, v[198:199] offset:0
    v_mul_f32 v204, v204, v231
    v_mul_f32 v205, v205, v231
    v_mul_f32 v206, v206, v231
    v_mul_f32 v207, v207, v231
    v_mul_f32 v208, v208, v231
    v_mul_f32 v209, v209, v231
    v_mul_f32 v210, v210, v231
    v_mul_f32 v211, v211, v231
    v_cvt_pk_bf16_f32 v204, v204, v205
    v_cvt_pk_bf16_f32 v205, v206, v207
    v_cvt_pk_bf16_f32 v206, v208, v209
    v_cvt_pk_bf16_f32 v207, v210, v211
    ds_write_b64 v234, v[204:205] offset:2048
    ds_write_b64 v235, v[206:207] offset:2048
    s_waitcnt lgkmcnt(0)
    s_barrier
    s_lshl_b32 s61, s53, 13
    s_add_u32 s61, s61, 73728
    v_add_u32 v3, s61, v4
    ds_read_b64_tr_b16 v[12:13], v236 offset:0
    ds_read_b64_tr_b16 v[14:15], v236 offset:2048
    ds_read_b64_tr_b16 v[28:29], v237 offset:0
    ds_read_b64_tr_b16 v[30:31], v237 offset:2048
    ds_read_b128 v[44:47], v3 offset:0
    ds_read_b128 v[60:63], v3 offset:1024
    ds_read_b64_tr_b16 v[16:17], v236 offset:4096
    ds_read_b64_tr_b16 v[18:19], v236 offset:6144
    ds_read_b64_tr_b16 v[32:33], v237 offset:4096
    ds_read_b64_tr_b16 v[34:35], v237 offset:6144
    ds_read_b128 v[48:51], v3 offset:2048
    ds_read_b128 v[64:67], v3 offset:3072
    ds_read_b64_tr_b16 v[20:21], v236 offset:16384
    ds_read_b64_tr_b16 v[22:23], v236 offset:18432
    ds_read_b64_tr_b16 v[36:37], v237 offset:16384
    ds_read_b64_tr_b16 v[38:39], v237 offset:18432
    ds_read_b128 v[52:55], v3 offset:4096
    ds_read_b128 v[68:71], v3 offset:5120
    ds_read_b64_tr_b16 v[24:25], v236 offset:20480
    ds_read_b64_tr_b16 v[26:27], v236 offset:22528
    ds_read_b64_tr_b16 v[40:41], v237 offset:20480
    ds_read_b64_tr_b16 v[42:43], v237 offset:22528
    ds_read_b128 v[56:59], v3 offset:6144
    ds_read_b128 v[72:75], v3 offset:7168
    s_waitcnt lgkmcnt(12)
    v_mfma_f32_16x16x32_bf16 v[124:127], v[12:15], v[44:47], 0
    v_mfma_f32_16x16x32_bf16 v[128:131], v[12:15], v[60:63], 0
    v_mfma_f32_16x16x32_bf16 v[132:135], v[12:15], v[76:79], 0
    v_mfma_f32_16x16x32_bf16 v[136:139], v[28:31], v[44:47], 0
    v_mfma_f32_16x16x32_bf16 v[140:143], v[28:31], v[60:63], 0
    v_mfma_f32_16x16x32_bf16 v[144:147], v[28:31], v[76:79], 0
    s_waitcnt lgkmcnt(12)
    v_mfma_f32_16x16x32_bf16 v[124:127], v[16:19], v[48:51], v[124:127]
    v_mfma_f32_16x16x32_bf16 v[128:131], v[16:19], v[64:67], v[128:131]
    v_mfma_f32_16x16x32_bf16 v[132:135], v[16:19], v[76:79], v[132:135]
    v_mfma_f32_16x16x32_bf16 v[136:139], v[32:35], v[48:51], v[136:139]
    v_mfma_f32_16x16x32_bf16 v[140:143], v[32:35], v[64:67], v[140:143]
    v_mfma_f32_16x16x32_bf16 v[144:147], v[32:35], v[76:79], v[144:147]
    s_waitcnt lgkmcnt(6)
    v_mfma_f32_16x16x32_bf16 v[124:127], v[20:23], v[52:55], v[124:127]
    v_mfma_f32_16x16x32_bf16 v[128:131], v[20:23], v[68:71], v[128:131]
    v_mfma_f32_16x16x32_bf16 v[132:135], v[20:23], v[76:79], v[132:135]
    v_mfma_f32_16x16x32_bf16 v[136:139], v[36:39], v[52:55], v[136:139]
    v_mfma_f32_16x16x32_bf16 v[140:143], v[36:39], v[68:71], v[140:143]
    v_mfma_f32_16x16x32_bf16 v[144:147], v[36:39], v[76:79], v[144:147]
    s_waitcnt lgkmcnt(0)
    v_mfma_f32_16x16x32_bf16 v[124:127], v[24:27], v[56:59], v[124:127]
    v_mfma_f32_16x16x32_bf16 v[128:131], v[24:27], v[72:75], v[128:131]
    v_mfma_f32_16x16x32_bf16 v[132:135], v[24:27], v[76:79], v[132:135]
    v_mfma_f32_16x16x32_bf16 v[136:139], v[40:43], v[56:59], v[136:139]
    v_mfma_f32_16x16x32_bf16 v[140:143], v[40:43], v[72:75], v[140:143]
    v_mfma_f32_16x16x32_bf16 v[144:147], v[40:43], v[76:79], v[144:147]
    s_lshl_b32 s61, s58, 4
    s_add_u32 s61, s61, s40
    s_lshl_b32 s63, s61, 12
    s_lshl_b32 s64, s52, 11
    s_add_u32 s63, s63, s64
    s_lshl_b32 s61, s61, 8
    s_lshl_b32 s64, s52, 7
    s_add_u32 s61, s61, s64
    v_and_b32 v2, 15, v1
    v_cmp_eq_u32 vcc, 0, v2
    v_cvt_pk_bf16_f32 v12, v124, v125
    v_cvt_pk_bf16_f32 v13, v126, v127
    v_cvt_pk_bf16_f32 v14, v136, v137
    v_cvt_pk_bf16_f32 v15, v138, v139
    buffer_store_dwordx4 v[12:15], v4, s[24:27], s63 offen offset:0 sc1
    v_cvt_pk_bf16_f32 v16, v128, v129
    v_cvt_pk_bf16_f32 v17, v130, v131
    v_cvt_pk_bf16_f32 v18, v140, v141
    v_cvt_pk_bf16_f32 v19, v142, v143
    buffer_store_dwordx4 v[16:19], v4, s[24:27], s63 offen offset:1024 sc1
    s_and_saveexec_b64 s[64:65], vcc
    buffer_store_dwordx4 v[132:135], v1, s[28:31], s61 offen offset:0 sc1
    buffer_store_dwordx4 v[144:147], v1, s[28:31], s61 offen offset:64 sc1
    s_mov_b64 exec, s[64:65]
    s_waitcnt vmcnt(0)
    s_barrier
    v_mfma_f32_16x16x32_bf16 v[12:15], v[188:191], v[240:243], 0
    v_mfma_f32_16x16x32_bf16 v[16:19], v[192:195], v[240:243], 0
    v_mfma_f32_16x16x32_bf16 v[20:23], v[188:191], v[244:247], 0
    v_mfma_f32_16x16x32_bf16 v[24:27], v[192:195], v[244:247], 0
    s_nop 4
    v_max3_f32 v44, v12, v13, v14
    s_nop 0
    v_max3_f32 v45, v20, v21, v22
    v_max3_f32 v46, -v12, -v13, -v14
    v_max3_f32 v47, -v20, -v21, -v22
    v_max3_f32 v44, v44, v15, v16
    v_max3_f32 v45, v45, v23, v24
    v_max3_f32 v46, v46, -v15, -v16
    v_max3_f32 v47, v47, -v23, -v24
    v_max3_f32 v44, v44, v17, v18
    v_max3_f32 v45, v45, v25, v26
    v_max3_f32 v46, v46, -v17, -v18
    v_max3_f32 v47, v47, -v25, -v26
    v_max_f32 v44, v19, v44
    v_max_f32 v45, v27, v45
    v_max_f32 v46, -v19, v46
    v_max_f32 v47, -v27, v47
    v_permlane32_swap_b32 v44, v45
    s_nop 0
    v_permlane32_swap_b32 v46, v47
    v_max_f32 v44, v44, v45
    v_max_f32 v46, v46, v47
    s_nop 1
    v_permlane16_swap_b32 v44, v46
    v_max_f32 v44, v44, v46
    v_mov_b32 v46, v44
    s_nop 1
    v_permlane16_swap_b32 v44, v46
    v_mov_b32 v45, v44
    v_mov_b32 v47, v46
    s_nop 0
    v_permlane32_swap_b32 v44, v45
    v_permlane32_swap_b32 v46, v47
    v_mul_f32 v44, s60, v44
    v_mul_f32 v45, s60, v45
    v_mul_f32 v46, s60, v46
    v_mul_f32 v47, s60, v47
    v_fma_f32 v28, v12, s60, -v44
    v_fma_f32 v29, v13, s60, -v44
    v_fma_f32 v30, v14, s60, -v44
    v_fma_f32 v31, v15, s60, -v44
    v_fma_f32 v32, v16, s60, -v44
    v_fma_f32 v33, v17, s60, -v44
    v_fma_f32 v34, v18, s60, -v44
    v_fma_f32 v35, v19, s60, -v44
    v_fma_f32 v12, -v12, s60, -v46
    v_fma_f32 v13, -v13, s60, -v46
    v_fma_f32 v14, -v14, s60, -v46
    v_fma_f32 v15, -v15, s60, -v46
    v_fma_f32 v16, -v16, s60, -v46
    v_fma_f32 v17, -v17, s60, -v46
    v_fma_f32 v18, -v18, s60, -v46
    v_fma_f32 v19, -v19, s60, -v46
    v_fma_f32 v36, v20, s60, -v45
    v_fma_f32 v37, v21, s60, -v45
    v_fma_f32 v38, v22, s60, -v45
    v_fma_f32 v39, v23, s60, -v45
    v_fma_f32 v40, v24, s60, -v45
    v_fma_f32 v41, v25, s60, -v45
    v_fma_f32 v42, v26, s60, -v45
    v_fma_f32 v43, v27, s60, -v45
    v_fma_f32 v20, -v20, s60, -v47
    v_fma_f32 v21, -v21, s60, -v47
    v_fma_f32 v22, -v22, s60, -v47
    v_fma_f32 v23, -v23, s60, -v47
    v_fma_f32 v24, -v24, s60, -v47
    v_fma_f32 v25, -v25, s60, -v47
    v_fma_f32 v26, -v26, s60, -v47
    v_fma_f32 v27, -v27, s60, -v47
    v_exp_f32 v28, v28
    v_exp_f32 v12, v12
    v_exp_f32 v29, v29
    v_exp_f32 v13, v13
    v_exp_f32 v30, v30
    v_exp_f32 v14, v14
    v_exp_f32 v31, v31
    v_exp_f32 v15, v15
    v_exp_f32 v32, v32
    v_exp_f32 v16, v16
    v_exp_f32 v33, v33
    v_exp_f32 v17, v17
    v_exp_f32 v34, v34
    v_exp_f32 v18, v18
    v_exp_f32 v35, v35
    v_exp_f32 v19, v19
    v_exp_f32 v36, v36
    v_exp_f32 v20, v20
    v_exp_f32 v37, v37
    v_exp_f32 v21, v21
    v_exp_f32 v38, v38
    v_exp_f32 v22, v22
    v_exp_f32 v39, v39
    v_exp_f32 v23, v23
    v_exp_f32 v40, v40
    v_exp_f32 v24, v24
    v_exp_f32 v41, v41
    v_exp_f32 v25, v25
    v_exp_f32 v42, v42
    v_exp_f32 v26, v26
    v_exp_f32 v43, v43
    v_exp_f32 v27, v27
    v_add_f32 v44, v28, v29
    v_add_f32 v45, v36, v37
    v_add_f32 v46, v12, v13
    v_add_f32 v47, v20, v21
    v_add_f32 v44, v44, v30
    v_add_f32 v45, v45, v38
    v_add_f32 v46, v46, v14
    v_add_f32 v47, v47, v22
    v_add_f32 v44, v44, v31
    v_add_f32 v45, v45, v39
    v_add_f32 v46, v46, v15
    v_add_f32 v47, v47, v23
    v_add_f32 v44, v44, v32
    v_add_f32 v45, v45, v40
    v_add_f32 v46, v46, v16
    v_add_f32 v47, v47, v24
    v_add_f32 v44, v44, v33
    v_add_f32 v45, v45, v41
    v_add_f32 v46, v46, v17
    v_add_f32 v47, v47, v25
    v_add_f32 v44, v44, v34
    v_add_f32 v45, v45, v42
    v_add_f32 v46, v46, v18
    v_add_f32 v47, v47, v26
    v_add_f32 v44, v44, v35
    v_add_f32 v45, v45, v43
    v_add_f32 v46, v46, v19
    v_add_f32 v47, v47, v27
    v_permlane32_swap_b32 v44, v45
    s_nop 0
    v_permlane32_swap_b32 v46, v47
    v_add_f32 v44, v44, v45
    v_add_f32 v46, v46, v47
    s_nop 1
    v_permlane16_swap_b32 v44, v46
    v_add_f32 v44, v44, v46
    v_mov_b32 v46, v44
    s_nop 1
    v_permlane16_swap_b32 v44, v46
    v_mov_b32 v45, v44
    v_mov_b32 v47, v46
    s_nop 0
    v_permlane32_swap_b32 v44, v45
    v_permlane32_swap_b32 v46, v47
    v_rcp_f32 v44, v44
    v_rcp_f32 v45, v45
    v_rcp_f32 v46, v46
    v_rcp_f32 v47, v47
    v_mul_f32 v28, v28, v44
    v_mul_f32 v29, v29, v44
    v_mul_f32 v30, v30, v44
    v_mul_f32 v31, v31, v44
    v_mul_f32 v32, v32, v44
    v_mul_f32 v33, v33, v44
    v_mul_f32 v34, v34, v44
    v_mul_f32 v35, v35, v44
    v_cvt_pk_bf16_f32 v28, v28, v29
    v_cvt_pk_bf16_f32 v29, v30, v31
    v_cvt_pk_bf16_f32 v30, v32, v33
    v_cvt_pk_bf16_f32 v31, v34, v35
    v_mul_f32 v36, v36, v45
    v_mul_f32 v37, v37, v45
    v_mul_f32 v38, v38, v45
    v_mul_f32 v39, v39, v45
    v_mul_f32 v40, v40, v45
    v_mul_f32 v41, v41, v45
    v_mul_f32 v42, v42, v45
    v_mul_f32 v43, v43, v45
    v_cvt_pk_bf16_f32 v36, v36, v37
    v_cvt_pk_bf16_f32 v37, v38, v39
    v_cvt_pk_bf16_f32 v38, v40, v41
    v_cvt_pk_bf16_f32 v39, v42, v43
    v_mul_f32 v12, v12, v46
    v_mul_f32 v13, v13, v46
    v_mul_f32 v14, v14, v46
    v_mul_f32 v15, v15, v46
    v_mul_f32 v16, v16, v46
    v_mul_f32 v17, v17, v46
    v_mul_f32 v18, v18, v46
    v_mul_f32 v19, v19, v46
    v_cvt_pk_bf16_f32 v12, v12, v13
    v_cvt_pk_bf16_f32 v13, v14, v15
    v_cvt_pk_bf16_f32 v14, v16, v17
    v_cvt_pk_bf16_f32 v15, v18, v19
    v_mul_f32 v20, v20, v47
    v_mul_f32 v21, v21, v47
    v_mul_f32 v22, v22, v47
    v_mul_f32 v23, v23, v47
    v_mul_f32 v24, v24, v47
    v_mul_f32 v25, v25, v47
    v_mul_f32 v26, v26, v47
    v_mul_f32 v27, v27, v47
    v_cvt_pk_bf16_f32 v20, v20, v21
    v_cvt_pk_bf16_f32 v21, v22, v23
    v_cvt_pk_bf16_f32 v22, v24, v25
    v_cvt_pk_bf16_f32 v23, v26, v27
    s_mov_b32 s93, s40
    s_barrier
    s_add_u32 s16, s6, 1048576
    s_addc_u32 s17, s7, 0
    s_mov_b32 s18, 33554432
    s_mov_b32 s19, 0x20000
    s_add_u32 s20, s6, 131072
    s_addc_u32 s21, s7, 0
    s_mov_b32 s22, 2097152
    s_mov_b32 s23, 0x20000
    s_lshr_b32 s60, s42, 2
    s_lshl_b32 s61, s41, 1
    s_add_u32 s60, s60, s61
    s_and_b32 s61, s42, 3
    s_lshl_b32 s62, s60, 16
    s_lshl_b32 s63, s61, 10
    s_add_u32 s62, s62, s63
    s_lshl_b32 s63, s60, 12
    s_lshl_b32 s64, s61, 6
    s_add_u32 s63, s63, s64
    v_lshlrev_b32 v156, 4, v1
    v_lshrrev_b32 v157, 4, v1
    v_lshlrev_b32 v157, 4, v157
    v_and_b32 v158, 15, v1
    v_lshl_add_u32 v157, v158, 8, v157
    buffer_load_dwordx4 v[168:171], v157, s[20:23], s63 offen sc1
    s_lshl_b32 s64, s40, 1
    s_add_u32 s64, s64, 0
    s_and_b32 s64, s64, 15
    s_lshl_b32 s64, s64, 12
    s_add_u32 s64, s64, s62
    buffer_load_dwordx4 v[176:179], v156, s[16:19], s64 offen sc1
    s_lshl_b32 s64, s40, 1
    s_add_u32 s64, s64, 1
    s_and_b32 s64, s64, 15
    s_lshl_b32 s64, s64, 12
    s_add_u32 s64, s64, s62
    buffer_load_dwordx4 v[180:183], v156, s[16:19], s64 offen sc1
    s_lshl_b32 s64, s40, 1
    s_add_u32 s64, s64, 2
    s_and_b32 s64, s64, 15
    s_lshl_b32 s64, s64, 12
    s_add_u32 s64, s64, s62
    buffer_load_dwordx4 v[184:187], v156, s[16:19], s64 offen sc1
    s_lshl_b32 s64, s40, 1
    s_add_u32 s64, s64, 3
    s_and_b32 s64, s64, 15
    s_lshl_b32 s64, s64, 12
    s_add_u32 s64, s64, s62
    buffer_load_dwordx4 v[188:191], v156, s[16:19], s64 offen sc1
    s_lshl_b32 s64, s40, 1
    s_add_u32 s64, s64, 4
    s_and_b32 s64, s64, 15
    s_lshl_b32 s64, s64, 12
    s_add_u32 s64, s64, s62
    buffer_load_dwordx4 v[192:195], v156, s[16:19], s64 offen sc1
    s_lshl_b32 s64, s40, 1
    s_add_u32 s64, s64, 5
    s_and_b32 s64, s64, 15
    s_lshl_b32 s64, s64, 12
    s_add_u32 s64, s64, s62
    buffer_load_dwordx4 v[196:199], v156, s[16:19], s64 offen sc1
    s_lshl_b32 s64, s40, 1
    s_add_u32 s64, s64, 6
    s_and_b32 s64, s64, 15
    s_lshl_b32 s64, s64, 12
    s_add_u32 s64, s64, s62
    buffer_load_dwordx4 v[200:203], v156, s[16:19], s64 offen sc1
    s_lshl_b32 s64, s40, 1
    s_add_u32 s64, s64, 7
    s_and_b32 s64, s64, 15
    s_lshl_b32 s64, s64, 12
    s_add_u32 s64, s64, s62
    buffer_load_dwordx4 v[204:207], v156, s[16:19], s64 offen sc1
    s_lshl_b32 s64, s40, 1
    s_add_u32 s64, s64, 8
    s_and_b32 s64, s64, 15
    s_lshl_b32 s64, s64, 12
    s_add_u32 s64, s64, s62
    buffer_load_dwordx4 v[208:211], v156, s[16:19], s64 offen sc1
    s_lshl_b32 s64, s40, 1
    s_add_u32 s64, s64, 9
    s_and_b32 s64, s64, 15
    s_lshl_b32 s64, s64, 12
    s_add_u32 s64, s64, s62
    buffer_load_dwordx4 v[212:215], v156, s[16:19], s64 offen sc1
    s_lshl_b32 s64, s40, 1
    s_add_u32 s64, s64, 10
    s_and_b32 s64, s64, 15
    s_lshl_b32 s64, s64, 12
    s_add_u32 s64, s64, s62
    buffer_load_dwordx4 v[216:219], v156, s[16:19], s64 offen sc1
    s_lshl_b32 s64, s40, 1
    s_add_u32 s64, s64, 11
    s_and_b32 s64, s64, 15
    s_lshl_b32 s64, s64, 12
    s_add_u32 s64, s64, s62
    buffer_load_dwordx4 v[220:223], v156, s[16:19], s64 offen sc1
    s_lshl_b32 s64, s40, 1
    s_add_u32 s64, s64, 12
    s_and_b32 s64, s64, 15
    s_lshl_b32 s64, s64, 12
    s_add_u32 s64, s64, s62
    buffer_load_dwordx4 v[224:227], v156, s[16:19], s64 offen sc1
    s_lshl_b32 s64, s40, 1
    s_add_u32 s64, s64, 13
    s_and_b32 s64, s64, 15
    s_lshl_b32 s64, s64, 12
    s_add_u32 s64, s64, s62
    buffer_load_dwordx4 v[228:231], v156, s[16:19], s64 offen sc1
    s_lshl_b32 s64, s40, 1
    s_add_u32 s64, s64, 14
    s_and_b32 s64, s64, 15
    s_lshl_b32 s64, s64, 12
    s_add_u32 s64, s64, s62
    buffer_load_dwordx4 v[232:235], v156, s[16:19], s64 offen sc1
    s_lshl_b32 s64, s40, 1
    s_add_u32 s64, s64, 15
    s_and_b32 s64, s64, 15
    s_lshl_b32 s64, s64, 12
    s_add_u32 s64, s64, s62
    buffer_load_dwordx4 v[236:239], v156, s[16:19], s64 offen sc1
    v_mov_b32 v244, 0
    v_mov_b32 v245, 0
    v_mov_b32 v248, 0
    v_mov_b32 v249, 0
    v_bfe_u32 v157, v1, 2, 2
    v_lshrrev_b32 v158, 4, v1
    v_cmp_eq_u32 vcc, v157, v158
    v_and_b32 v157, 1, v1
    v_lshlrev_b32 v157, 4, v157
    v_mov_b32 v158, 0x3f80
    v_lshlrev_b32 v157, v157, v158
    v_cndmask_b32 v157, 0, v157, vcc
    v_and_b32 v158, 2, v1
    v_cmp_eq_u32 vcc, 0, v158
    s_nop 1
    v_cndmask_b32 v246, 0, v157, vcc
    v_cndmask_b32 v247, v157, v244, vcc
    s_waitcnt vmcnt(16)
    v_add_f32_dpp v168, v168, v168 quad_perm:[1,0,3,2] row_mask:0xf bank_mask:0xf
    v_add_f32_dpp v169, v169, v169 quad_perm:[1,0,3,2] row_mask:0xf bank_mask:0xf
    v_add_f32_dpp v170, v170, v170 quad_perm:[1,0,3,2] row_mask:0xf bank_mask:0xf
    v_add_f32_dpp v171, v171, v171 quad_perm:[1,0,3,2] row_mask:0xf bank_mask:0xf
    v_add_f32_dpp v168, v168, v168 quad_perm:[2,3,0,1] row_mask:0xf bank_mask:0xf
    v_add_f32_dpp v169, v169, v169 quad_perm:[2,3,0,1] row_mask:0xf bank_mask:0xf
    v_add_f32_dpp v170, v170, v170 quad_perm:[2,3,0,1] row_mask:0xf bank_mask:0xf
    v_add_f32_dpp v171, v171, v171 quad_perm:[2,3,0,1] row_mask:0xf bank_mask:0xf
    v_add_f32_dpp v168, v168, v168 row_half_mirror row_mask:0xf bank_mask:0xf
    v_add_f32_dpp v169, v169, v169 row_half_mirror row_mask:0xf bank_mask:0xf
    v_add_f32_dpp v170, v170, v170 row_half_mirror row_mask:0xf bank_mask:0xf
    v_add_f32_dpp v171, v171, v171 row_half_mirror row_mask:0xf bank_mask:0xf
    v_add_f32_dpp v168, v168, v168 row_mirror row_mask:0xf bank_mask:0xf
    v_add_f32_dpp v169, v169, v169 row_mirror row_mask:0xf bank_mask:0xf
    v_add_f32_dpp v170, v170, v170 row_mirror row_mask:0xf bank_mask:0xf
    v_add_f32_dpp v171, v171, v171 row_mirror row_mask:0xf bank_mask:0xf
    s_waitcnt vmcnt(15)
    v_mfma_f32_16x16x32_bf16 v[160:163], v[246:249], v[176:179], 0
    v_mfma_f32_16x16x32_bf16 v[164:167], v[244:247], v[176:179], 0
    s_waitcnt vmcnt(14)
    v_mfma_f32_16x16x32_bf16 v[160:163], v[246:249], v[180:183], v[160:163]
    v_mfma_f32_16x16x32_bf16 v[164:167], v[244:247], v[180:183], v[164:167]
    s_waitcnt vmcnt(13)
    v_mfma_f32_16x16x32_bf16 v[160:163], v[246:249], v[184:187], v[160:163]
    v_mfma_f32_16x16x32_bf16 v[164:167], v[244:247], v[184:187], v[164:167]
    s_waitcnt vmcnt(12)
    v_mfma_f32_16x16x32_bf16 v[160:163], v[246:249], v[188:191], v[160:163]
    v_mfma_f32_16x16x32_bf16 v[164:167], v[244:247], v[188:191], v[164:167]
    s_waitcnt vmcnt(11)
    v_mfma_f32_16x16x32_bf16 v[160:163], v[246:249], v[192:195], v[160:163]
    v_mfma_f32_16x16x32_bf16 v[164:167], v[244:247], v[192:195], v[164:167]
    s_waitcnt vmcnt(10)
    v_mfma_f32_16x16x32_bf16 v[160:163], v[246:249], v[196:199], v[160:163]
    v_mfma_f32_16x16x32_bf16 v[164:167], v[244:247], v[196:199], v[164:167]
    s_waitcnt vmcnt(9)
    v_mfma_f32_16x16x32_bf16 v[160:163], v[246:249], v[200:203], v[160:163]
    v_mfma_f32_16x16x32_bf16 v[164:167], v[244:247], v[200:203], v[164:167]
    s_waitcnt vmcnt(8)
    v_mfma_f32_16x16x32_bf16 v[160:163], v[246:249], v[204:207], v[160:163]
    v_mfma_f32_16x16x32_bf16 v[164:167], v[244:247], v[204:207], v[164:167]
    s_waitcnt vmcnt(7)
    v_mfma_f32_16x16x32_bf16 v[160:163], v[246:249], v[208:211], v[160:163]
    v_mfma_f32_16x16x32_bf16 v[164:167], v[244:247], v[208:211], v[164:167]
    s_waitcnt vmcnt(6)
    v_mfma_f32_16x16x32_bf16 v[160:163], v[246:249], v[212:215], v[160:163]
    v_mfma_f32_16x16x32_bf16 v[164:167], v[244:247], v[212:215], v[164:167]
    s_waitcnt vmcnt(5)
    v_mfma_f32_16x16x32_bf16 v[160:163], v[246:249], v[216:219], v[160:163]
    v_mfma_f32_16x16x32_bf16 v[164:167], v[244:247], v[216:219], v[164:167]
    s_waitcnt vmcnt(4)
    v_mfma_f32_16x16x32_bf16 v[160:163], v[246:249], v[220:223], v[160:163]
    v_mfma_f32_16x16x32_bf16 v[164:167], v[244:247], v[220:223], v[164:167]
    s_waitcnt vmcnt(3)
    v_mfma_f32_16x16x32_bf16 v[160:163], v[246:249], v[224:227], v[160:163]
    v_mfma_f32_16x16x32_bf16 v[164:167], v[244:247], v[224:227], v[164:167]
    s_waitcnt vmcnt(2)
    v_mfma_f32_16x16x32_bf16 v[160:163], v[246:249], v[228:231], v[160:163]
    v_mfma_f32_16x16x32_bf16 v[164:167], v[244:247], v[228:231], v[164:167]
    s_waitcnt vmcnt(1)
    v_mfma_f32_16x16x32_bf16 v[160:163], v[246:249], v[232:235], v[160:163]
    v_mfma_f32_16x16x32_bf16 v[164:167], v[244:247], v[232:235], v[164:167]
    s_waitcnt vmcnt(0)
    v_mfma_f32_16x16x32_bf16 v[160:163], v[246:249], v[236:239], v[160:163]
    v_mfma_f32_16x16x32_bf16 v[164:167], v[244:247], v[236:239], v[164:167]
    s_lshr_b32 s60, s42, 2
    s_mul_i32 s60, s60, 6144
    s_bfe_u32 s61, s42, 0x10001
    s_lshl_b32 s61, s61, 10
    s_add_u32 s60, s60, s61
    s_and_b32 s61, s42, 1
    s_lshl_b32 s62, s61, 11
    s_add_u32 s62, s62, s60
    s_lshl_b32 s61, s61, 3
    s_add_u32 s60, s60, s61
    v_add_u32 v157, s60, v156
    v_add_u32 v158, s62, v156
    v_cvt_pk_bf16_f32 v172, v168, v169
    v_cvt_pk_bf16_f32 v173, v170, v171
    ds_write_b64 v157, v[172:173] offset:4096
    v_cvt_pk_bf16_f32 v176, v160, v161
    v_cvt_pk_bf16_f32 v177, v162, v163
    v_cvt_pk_bf16_f32 v178, v164, v165
    v_cvt_pk_bf16_f32 v179, v166, v167
    ds_write_b128 v158, v[176:179]
    s_waitcnt lgkmcnt(0)
    s_barrier
    s_add_u32 s20, s6, 25165824
    s_addc_u32 s21, s7, 0
    s_mov_b32 s22, 4194304
    s_mov_b32 s23, 0x20000
    s_and_b32 s60, s42, 1
    s_mul_i32 s60, s60, 6144
    v_add_u32 v157, s60, v156
    ds_read_b128 v[176:179], v157 offset:0
    ds_read_b128 v[180:183], v157 offset:1024
    ds_read_b128 v[184:187], v157 offset:2048
    ds_read_b128 v[188:191], v157 offset:3072
    ds_read_b128 v[192:195], v157 offset:4096
    ds_read_b128 v[196:199], v157 offset:5120
    s_bfe_u32 s60, s42, 0x10001
    s_lshl_b32 s61, s93, 1
    s_add_u32 s60, s60, s61
    s_mul_i32 s60, s60, 131072
    s_lshl_b32 s61, s58, 10
    s_add_u32 s60, s60, s61
    s_waitcnt lgkmcnt(0)
    v_mfma_f32_16x16x32_bf16 v[208:211], v[192:195], v[28:31], 0
    v_mfma_f32_16x16x32_bf16 v[220:223], v[192:195], v[36:39], 0
    v_mfma_f32_16x16x32_bf16 v[200:203], v[176:179], v[28:31], 0
    v_mfma_f32_16x16x32_bf16 v[212:215], v[176:179], v[36:39], 0
    v_mfma_f32_16x16x32_bf16 v[204:207], v[184:187], v[28:31], 0
    v_mfma_f32_16x16x32_bf16 v[216:219], v[184:187], v[36:39], 0
    v_mfma_f32_16x16x32_bf16 v[208:211], v[196:199], v[12:15], v[208:211]
    v_mfma_f32_16x16x32_bf16 v[220:223], v[196:199], v[20:23], v[220:223]
    v_mfma_f32_16x16x32_bf16 v[200:203], v[180:183], v[12:15], v[200:203]
    v_mfma_f32_16x16x32_bf16 v[212:215], v[180:183], v[20:23], v[212:215]
    v_mfma_f32_16x16x32_bf16 v[204:207], v[188:191], v[12:15], v[204:207]
    v_mfma_f32_16x16x32_bf16 v[216:219], v[188:191], v[20:23], v[216:219]
    s_nop 2
    v_add_f32 v208, 0x358637bd, v208
    v_add_f32 v220, 0x358637bd, v220
    v_rcp_f32 v208, v208
    v_rcp_f32 v220, v220
    v_pk_mul_f32 v[200:201], v[200:201], v[208:209] op_sel_hi:[1,0]
    v_pk_mul_f32 v[202:203], v[202:203], v[208:209] op_sel_hi:[1,0]
    v_pk_mul_f32 v[204:205], v[204:205], v[208:209] op_sel_hi:[1,0]
    v_pk_mul_f32 v[206:207], v[206:207], v[208:209] op_sel_hi:[1,0]
    v_cvt_pk_bf16_f32 v160, v200, v201
    v_cvt_pk_bf16_f32 v161, v202, v203
    v_cvt_pk_bf16_f32 v162, v204, v205
    v_cvt_pk_bf16_f32 v163, v206, v207
    buffer_store_dwordx4 v[160:163], v156, s[20:23], s60 offen sc1
    s_add_u32 s60, s60, 32768
    v_pk_mul_f32 v[212:213], v[212:213], v[220:221] op_sel_hi:[1,0]
    v_pk_mul_f32 v[214:215], v[214:215], v[220:221] op_sel_hi:[1,0]
    v_pk_mul_f32 v[216:217], v[216:217], v[220:221] op_sel_hi:[1,0]
    v_pk_mul_f32 v[218:219], v[218:219], v[220:221] op_sel_hi:[1,0]
    v_cvt_pk_bf16_f32 v164, v212, v213
    v_cvt_pk_bf16_f32 v165, v214, v215
    v_cvt_pk_bf16_f32 v166, v216, v217
    v_cvt_pk_bf16_f32 v167, v218, v219
    buffer_store_dwordx4 v[164:167], v156, s[20:23], s60 offen sc1
    s_add_u32 s60, s60, 32768
    s_waitcnt vmcnt(0)
    s_barrier
    s_and_b32 s36, s2, 7
    s_lshr_b32 s37, s2, 3
    s_and_b32 s38, s36, 3
    s_lshr_b32 s36, s36, 2
    s_and_b32 s39, s37, 3
    s_lshr_b32 s37, s37, 2
    s_mul_i32 s38, s38, 4
    s_add_u32 s40, s38, s39
    s_mul_i32 s36, s36, 8
    s_add_u32 s41, s36, s37
    s_add_u32 s39, s39, s37
    s_and_b32 s39, s39, 3
    s_mul_i32 s43, s41, 128
    s_add_u32 s24, s6, 29360128
    s_addc_u32 s25, s7, 0
    s_mov_b32 s26, 4194304
    s_mov_b32 s27, 0x20000
    s_add_u32 s28, s6, 262144
    s_addc_u32 s29, s7, 0
    s_mov_b32 s30, 262144
    s_mov_b32 s31, 0x20000
    s_add_u32 s16, s6, 33554432
    s_addc_u32 s17, s7, 0
    s_mov_b32 s18, 4194304
    s_mov_b32 s19, 0x20000
    s_lshr_b32 s52, s42, 1
    s_and_b32 s53, s42, 1
    s_mul_i32 s54, s42, 8192
    v_lshl_add_u32 v4, v1, 4, s54
    v_lshrrev_b32 v2, 2, v1
    v_bfe_u32 v3, v1, 3, 2
    v_lshlrev_b32 v6, 5, v3
    v_lshl_add_u32 v6, v2, 7, v6
    v_and_b32 v3, 3, v1
    v_lshlrev_b32 v3, 3, v3
    v_add_u32 v3, 32768, v3
    v_add_u32 v6, v6, v3
    v_xor_b32 v7, 32, v6
    v_xor_b32 v8, 64, v6
    v_xor_b32 v9, 96, v6
    v_and_b32 v2, 7, v1
    v_lshrrev_b32 v3, 5, v1
    v_xor_b32 v2, v2, v3
    v_lshlrev_b32 v2, 4, v2
    v_bfe_u32 v3, v1, 4, 1
    v_lshl_add_u32 v2, v3, 3, v2
    v_and_b32 v3, 15, v1
    v_lshl_add_u32 v2, v3, 7, v2
    s_lshl_b32 s61, s42, 12
    s_add_u32 s61, s61, 147456
    v_add_u32 v204, s61, v2
    v_xor_b32 v205, 32, v204
    v_xor_b32 v206, 64, v204
    v_xor_b32 v207, 96, v204
    s_mov_b32 s47, 1
    v_add_u32 v4, 49152, v4
    v_add_u32 v6, 49152, v6
    v_add_u32 v7, 49152, v7
    v_add_u32 v8, 49152, v8
    v_add_u32 v9, 49152, v9
    s_mov_b32 s55, 49152
    s_barrier
    v_lshrrev_b32 v3, 4, v1
    v_lshlrev_b32 v3, 4, v3
    v_add_u32 v3, 147456, v3
    ds_read_b128 v[156:159], v3 offset:0
    ds_read_b128 v[160:163], v3 offset:64
    ds_read_b128 v[164:167], v3 offset:128
    ds_read_b128 v[168:171], v3 offset:192
    ds_read_b128 v[172:175], v3 offset:256
    ds_read_b128 v[176:179], v3 offset:320
    ds_read_b128 v[180:183], v3 offset:384
    ds_read_b128 v[184:187], v3 offset:448
    ds_read_b128 v[12:15], v4 offset:0
    ds_read_b64_tr_b16 v[20:21], v6 offset:0
    ds_read_b64_tr_b16 v[22:23], v6 offset:2048
    ds_read_b64_tr_b16 v[24:25], v7 offset:0
    ds_read_b64_tr_b16 v[26:27], v7 offset:2048
    ds_read_b64_tr_b16 v[28:29], v8 offset:0
    ds_read_b64_tr_b16 v[30:31], v8 offset:2048
    ds_read_b64_tr_b16 v[32:33], v9 offset:0
    ds_read_b64_tr_b16 v[34:35], v9 offset:2048
    ds_read_b128 v[16:19], v4 offset:4096
    ds_read_b128 v[36:39], v4 offset:1024
    ds_read_b64_tr_b16 v[44:45], v6 offset:4096
    ds_read_b64_tr_b16 v[46:47], v6 offset:6144
    ds_read_b64_tr_b16 v[48:49], v7 offset:4096
    ds_read_b64_tr_b16 v[50:51], v7 offset:6144
    ds_read_b64_tr_b16 v[52:53], v8 offset:4096
    ds_read_b64_tr_b16 v[54:55], v8 offset:6144
    ds_read_b64_tr_b16 v[56:57], v9 offset:4096
    ds_read_b64_tr_b16 v[58:59], v9 offset:6144
    ds_read_b128 v[40:43], v4 offset:5120
    s_waitcnt lgkmcnt(0)
    v_mfma_f32_16x16x32_bf16 v[108:111], v[20:23], v[12:15], 0
    ds_read_b128 v[60:63], v4 offset:2048
    ds_read_b64_tr_b16 v[68:69], v6 offset:8192
    v_mfma_f32_16x16x32_bf16 v[112:115], v[24:27], v[12:15], 0
    ds_read_b64_tr_b16 v[70:71], v6 offset:10240
    ds_read_b64_tr_b16 v[72:73], v7 offset:8192
    v_mfma_f32_16x16x32_bf16 v[116:119], v[28:31], v[12:15], 0
    ds_read_b64_tr_b16 v[74:75], v7 offset:10240
    ds_read_b64_tr_b16 v[76:77], v8 offset:8192
    v_mfma_f32_16x16x32_bf16 v[120:123], v[32:35], v[12:15], 0
    ds_read_b64_tr_b16 v[78:79], v8 offset:10240
    ds_read_b64_tr_b16 v[80:81], v9 offset:8192
    v_mfma_f32_16x16x32_bf16 v[124:127], v[20:23], v[16:19], 0
    ds_read_b64_tr_b16 v[82:83], v9 offset:10240
    ds_read_b128 v[64:67], v4 offset:6144
    v_mfma_f32_16x16x32_bf16 v[128:131], v[24:27], v[16:19], 0
    ds_read_b128 v[84:87], v4 offset:3072
    ds_read_b64_tr_b16 v[92:93], v6 offset:12288
    v_mfma_f32_16x16x32_bf16 v[132:135], v[28:31], v[16:19], 0
    ds_read_b64_tr_b16 v[94:95], v6 offset:14336
    ds_read_b64_tr_b16 v[96:97], v7 offset:12288
    v_mfma_f32_16x16x32_bf16 v[136:139], v[32:35], v[16:19], 0
    ds_read_b64_tr_b16 v[98:99], v7 offset:14336
    ds_read_b64_tr_b16 v[100:101], v8 offset:12288
    v_mfma_f32_16x16x32_bf16 v[108:111], v[44:47], v[36:39], v[108:111]
    ds_read_b64_tr_b16 v[102:103], v8 offset:14336
    ds_read_b64_tr_b16 v[104:105], v9 offset:12288
    v_mfma_f32_16x16x32_bf16 v[112:115], v[48:51], v[36:39], v[112:115]
    ds_read_b64_tr_b16 v[106:107], v9 offset:14336
    ds_read_b128 v[88:91], v4 offset:7168
    v_mfma_f32_16x16x32_bf16 v[116:119], v[52:55], v[36:39], v[116:119]
    s_add_u32 s47, s47, 1
    s_cmp_eq_u32 s47, 3
    v_mfma_f32_16x16x32_bf16 v[120:123], v[56:59], v[36:39], v[120:123]
    s_cselect_b32 s47, 0, s47
    s_cselect_b32 s54, -98304, s55
    v_mfma_f32_16x16x32_bf16 v[124:127], v[44:47], v[40:43], v[124:127]
    v_add_u32 v4, s54, v4
    v_mfma_f32_16x16x32_bf16 v[128:131], v[48:51], v[40:43], v[128:131]
    v_add_u32 v6, s54, v6
    v_mfma_f32_16x16x32_bf16 v[132:135], v[52:55], v[40:43], v[132:135]
    v_add_u32 v7, s54, v7
    v_mfma_f32_16x16x32_bf16 v[136:139], v[56:59], v[40:43], v[136:139]
    v_add_u32 v8, s54, v8
    v_add_u32 v9, s54, v9
    s_waitcnt lgkmcnt(0)
    v_mfma_f32_16x16x32_bf16 v[108:111], v[68:71], v[60:63], v[108:111]
    v_mfma_f32_16x16x32_bf16 v[112:115], v[72:75], v[60:63], v[112:115]
    s_barrier
    v_mfma_f32_16x16x32_bf16 v[116:119], v[76:79], v[60:63], v[116:119]
    ds_read_b128 v[12:15], v4 offset:0
    ds_read_b64_tr_b16 v[20:21], v6 offset:0
    v_mfma_f32_16x16x32_bf16 v[120:123], v[80:83], v[60:63], v[120:123]
    ds_read_b64_tr_b16 v[22:23], v6 offset:2048
    ds_read_b64_tr_b16 v[24:25], v7 offset:0
    v_mfma_f32_16x16x32_bf16 v[124:127], v[68:71], v[64:67], v[124:127]
    ds_read_b64_tr_b16 v[26:27], v7 offset:2048
    ds_read_b64_tr_b16 v[28:29], v8 offset:0
    v_mfma_f32_16x16x32_bf16 v[128:131], v[72:75], v[64:67], v[128:131]
    ds_read_b64_tr_b16 v[30:31], v8 offset:2048
    ds_read_b64_tr_b16 v[32:33], v9 offset:0
    v_mfma_f32_16x16x32_bf16 v[132:135], v[76:79], v[64:67], v[132:135]
    ds_read_b64_tr_b16 v[34:35], v9 offset:2048
    ds_read_b128 v[16:19], v4 offset:4096
    v_mfma_f32_16x16x32_bf16 v[136:139], v[80:83], v[64:67], v[136:139]
    ds_read_b128 v[36:39], v4 offset:1024
    ds_read_b64_tr_b16 v[44:45], v6 offset:4096
    v_mfma_f32_16x16x32_bf16 v[108:111], v[92:95], v[84:87], v[108:111]
    ds_read_b64_tr_b16 v[46:47], v6 offset:6144
    ds_read_b64_tr_b16 v[48:49], v7 offset:4096
    v_mfma_f32_16x16x32_bf16 v[112:115], v[96:99], v[84:87], v[112:115]
    ds_read_b64_tr_b16 v[50:51], v7 offset:6144
    ds_read_b64_tr_b16 v[52:53], v8 offset:4096
    v_mfma_f32_16x16x32_bf16 v[116:119], v[100:103], v[84:87], v[116:119]
    ds_read_b64_tr_b16 v[54:55], v8 offset:6144
    ds_read_b64_tr_b16 v[56:57], v9 offset:4096
    v_mfma_f32_16x16x32_bf16 v[120:123], v[104:107], v[84:87], v[120:123]
    ds_read_b64_tr_b16 v[58:59], v9 offset:6144
    ds_read_b128 v[40:43], v4 offset:5120
    v_mfma_f32_16x16x32_bf16 v[124:127], v[92:95], v[88:91], v[124:127]
    v_mfma_f32_16x16x32_bf16 v[128:131], v[96:99], v[88:91], v[128:131]
    v_mfma_f32_16x16x32_bf16 v[132:135], v[100:103], v[88:91], v[132:135]
    v_mfma_f32_16x16x32_bf16 v[136:139], v[104:107], v[88:91], v[136:139]
    s_mov_b32 s51, 6
    .p2align 3
wo_cloop:
    s_waitcnt lgkmcnt(0)
    v_mfma_f32_16x16x32_bf16 v[108:111], v[20:23], v[12:15], v[108:111]
    ds_read_b128 v[60:63], v4 offset:2048
    ds_read_b64_tr_b16 v[68:69], v6 offset:8192
    v_mfma_f32_16x16x32_bf16 v[112:115], v[24:27], v[12:15], v[112:115]
    ds_read_b64_tr_b16 v[70:71], v6 offset:10240
    ds_read_b64_tr_b16 v[72:73], v7 offset:8192
    v_mfma_f32_16x16x32_bf16 v[116:119], v[28:31], v[12:15], v[116:119]
    ds_read_b64_tr_b16 v[74:75], v7 offset:10240
    ds_read_b64_tr_b16 v[76:77], v8 offset:8192
    v_mfma_f32_16x16x32_bf16 v[120:123], v[32:35], v[12:15], v[120:123]
    ds_read_b64_tr_b16 v[78:79], v8 offset:10240
    ds_read_b64_tr_b16 v[80:81], v9 offset:8192
    v_mfma_f32_16x16x32_bf16 v[124:127], v[20:23], v[16:19], v[124:127]
    ds_read_b64_tr_b16 v[82:83], v9 offset:10240
    ds_read_b128 v[64:67], v4 offset:6144
    v_mfma_f32_16x16x32_bf16 v[128:131], v[24:27], v[16:19], v[128:131]
    ds_read_b128 v[84:87], v4 offset:3072
    ds_read_b64_tr_b16 v[92:93], v6 offset:12288
    v_mfma_f32_16x16x32_bf16 v[132:135], v[28:31], v[16:19], v[132:135]
    ds_read_b64_tr_b16 v[94:95], v6 offset:14336
    ds_read_b64_tr_b16 v[96:97], v7 offset:12288
    v_mfma_f32_16x16x32_bf16 v[136:139], v[32:35], v[16:19], v[136:139]
    ds_read_b64_tr_b16 v[98:99], v7 offset:14336
    ds_read_b64_tr_b16 v[100:101], v8 offset:12288
    v_mfma_f32_16x16x32_bf16 v[108:111], v[44:47], v[36:39], v[108:111]
    ds_read_b64_tr_b16 v[102:103], v8 offset:14336
    ds_read_b64_tr_b16 v[104:105], v9 offset:12288
    v_mfma_f32_16x16x32_bf16 v[112:115], v[48:51], v[36:39], v[112:115]
    ds_read_b64_tr_b16 v[106:107], v9 offset:14336
    ds_read_b128 v[88:91], v4 offset:7168
    v_mfma_f32_16x16x32_bf16 v[116:119], v[52:55], v[36:39], v[116:119]
    s_add_u32 s47, s47, 1
    s_cmp_eq_u32 s47, 3
    v_mfma_f32_16x16x32_bf16 v[120:123], v[56:59], v[36:39], v[120:123]
    s_cselect_b32 s47, 0, s47
    s_cselect_b32 s54, -98304, s55
    v_mfma_f32_16x16x32_bf16 v[124:127], v[44:47], v[40:43], v[124:127]
    v_add_u32 v4, s54, v4
    v_mfma_f32_16x16x32_bf16 v[128:131], v[48:51], v[40:43], v[128:131]
    v_add_u32 v6, s54, v6
    v_mfma_f32_16x16x32_bf16 v[132:135], v[52:55], v[40:43], v[132:135]
    v_add_u32 v7, s54, v7
    v_mfma_f32_16x16x32_bf16 v[136:139], v[56:59], v[40:43], v[136:139]
    v_add_u32 v8, s54, v8
    v_add_u32 v9, s54, v9
    s_waitcnt lgkmcnt(0)
    v_mfma_f32_16x16x32_bf16 v[108:111], v[68:71], v[60:63], v[108:111]
    v_mfma_f32_16x16x32_bf16 v[112:115], v[72:75], v[60:63], v[112:115]
    s_barrier
    v_mfma_f32_16x16x32_bf16 v[116:119], v[76:79], v[60:63], v[116:119]
    ds_read_b128 v[12:15], v4 offset:0
    ds_read_b64_tr_b16 v[20:21], v6 offset:0
    v_mfma_f32_16x16x32_bf16 v[120:123], v[80:83], v[60:63], v[120:123]
    ds_read_b64_tr_b16 v[22:23], v6 offset:2048
    ds_read_b64_tr_b16 v[24:25], v7 offset:0
    v_mfma_f32_16x16x32_bf16 v[124:127], v[68:71], v[64:67], v[124:127]
    ds_read_b64_tr_b16 v[26:27], v7 offset:2048
    ds_read_b64_tr_b16 v[28:29], v8 offset:0
    v_mfma_f32_16x16x32_bf16 v[128:131], v[72:75], v[64:67], v[128:131]
    ds_read_b64_tr_b16 v[30:31], v8 offset:2048
    ds_read_b64_tr_b16 v[32:33], v9 offset:0
    v_mfma_f32_16x16x32_bf16 v[132:135], v[76:79], v[64:67], v[132:135]
    ds_read_b64_tr_b16 v[34:35], v9 offset:2048
    ds_read_b128 v[16:19], v4 offset:4096
    v_mfma_f32_16x16x32_bf16 v[136:139], v[80:83], v[64:67], v[136:139]
    ds_read_b128 v[36:39], v4 offset:1024
    ds_read_b64_tr_b16 v[44:45], v6 offset:4096
    v_mfma_f32_16x16x32_bf16 v[108:111], v[92:95], v[84:87], v[108:111]
    ds_read_b64_tr_b16 v[46:47], v6 offset:6144
    ds_read_b64_tr_b16 v[48:49], v7 offset:4096
    v_mfma_f32_16x16x32_bf16 v[112:115], v[96:99], v[84:87], v[112:115]
    ds_read_b64_tr_b16 v[50:51], v7 offset:6144
    ds_read_b64_tr_b16 v[52:53], v8 offset:4096
    v_mfma_f32_16x16x32_bf16 v[116:119], v[100:103], v[84:87], v[116:119]
    ds_read_b64_tr_b16 v[54:55], v8 offset:6144
    ds_read_b64_tr_b16 v[56:57], v9 offset:4096
    v_mfma_f32_16x16x32_bf16 v[120:123], v[104:107], v[84:87], v[120:123]
    ds_read_b64_tr_b16 v[58:59], v9 offset:6144
    ds_read_b128 v[40:43], v4 offset:5120
    v_mfma_f32_16x16x32_bf16 v[124:127], v[92:95], v[88:91], v[124:127]
    v_mfma_f32_16x16x32_bf16 v[128:131], v[96:99], v[88:91], v[128:131]
    v_mfma_f32_16x16x32_bf16 v[132:135], v[100:103], v[88:91], v[132:135]
    v_mfma_f32_16x16x32_bf16 v[136:139], v[104:107], v[88:91], v[136:139]
    s_sub_u32 s51, s51, 1
    s_cmp_lg_u32 s51, 0
    s_cbranch_scc1 wo_cloop
    s_waitcnt lgkmcnt(0)
    v_mfma_f32_16x16x32_bf16 v[108:111], v[20:23], v[12:15], v[108:111]
    ds_read_b128 v[60:63], v4 offset:2048
    ds_read_b64_tr_b16 v[68:69], v6 offset:8192
    v_mfma_f32_16x16x32_bf16 v[112:115], v[24:27], v[12:15], v[112:115]
    ds_read_b64_tr_b16 v[70:71], v6 offset:10240
    ds_read_b64_tr_b16 v[72:73], v7 offset:8192
    v_mfma_f32_16x16x32_bf16 v[116:119], v[28:31], v[12:15], v[116:119]
    ds_read_b64_tr_b16 v[74:75], v7 offset:10240
    ds_read_b64_tr_b16 v[76:77], v8 offset:8192
    v_mfma_f32_16x16x32_bf16 v[120:123], v[32:35], v[12:15], v[120:123]
    ds_read_b64_tr_b16 v[78:79], v8 offset:10240
    ds_read_b64_tr_b16 v[80:81], v9 offset:8192
    v_mfma_f32_16x16x32_bf16 v[124:127], v[20:23], v[16:19], v[124:127]
    ds_read_b64_tr_b16 v[82:83], v9 offset:10240
    ds_read_b128 v[64:67], v4 offset:6144
    v_mfma_f32_16x16x32_bf16 v[128:131], v[24:27], v[16:19], v[128:131]
    ds_read_b128 v[84:87], v4 offset:3072
    ds_read_b64_tr_b16 v[92:93], v6 offset:12288
    v_mfma_f32_16x16x32_bf16 v[132:135], v[28:31], v[16:19], v[132:135]
    ds_read_b64_tr_b16 v[94:95], v6 offset:14336
    ds_read_b64_tr_b16 v[96:97], v7 offset:12288
    v_mfma_f32_16x16x32_bf16 v[136:139], v[32:35], v[16:19], v[136:139]
    ds_read_b64_tr_b16 v[98:99], v7 offset:14336
    ds_read_b64_tr_b16 v[100:101], v8 offset:12288
    v_mfma_f32_16x16x32_bf16 v[108:111], v[44:47], v[36:39], v[108:111]
    ds_read_b64_tr_b16 v[102:103], v8 offset:14336
    ds_read_b64_tr_b16 v[104:105], v9 offset:12288
    v_mfma_f32_16x16x32_bf16 v[112:115], v[48:51], v[36:39], v[112:115]
    ds_read_b64_tr_b16 v[106:107], v9 offset:14336
    ds_read_b128 v[88:91], v4 offset:7168
    v_mfma_f32_16x16x32_bf16 v[116:119], v[52:55], v[36:39], v[116:119]
    v_mfma_f32_16x16x32_bf16 v[120:123], v[56:59], v[36:39], v[120:123]
    v_mfma_f32_16x16x32_bf16 v[124:127], v[44:47], v[40:43], v[124:127]
    v_mfma_f32_16x16x32_bf16 v[128:131], v[48:51], v[40:43], v[128:131]
    v_mfma_f32_16x16x32_bf16 v[132:135], v[52:55], v[40:43], v[132:135]
    v_mfma_f32_16x16x32_bf16 v[136:139], v[56:59], v[40:43], v[136:139]
    s_waitcnt lgkmcnt(0)
    v_mfma_f32_16x16x32_bf16 v[108:111], v[68:71], v[60:63], v[108:111]
    ds_read_b64 v[140:141], v204 offset:0
    ds_read_b64 v[142:143], v205 offset:0
    v_mfma_f32_16x16x32_bf16 v[112:115], v[72:75], v[60:63], v[112:115]
    ds_read_b64 v[144:145], v206 offset:0
    ds_read_b64 v[146:147], v207 offset:0
    v_mfma_f32_16x16x32_bf16 v[116:119], v[76:79], v[60:63], v[116:119]
    ds_read_b64 v[148:149], v204 offset:2048
    ds_read_b64 v[150:151], v205 offset:2048
    v_mfma_f32_16x16x32_bf16 v[120:123], v[80:83], v[60:63], v[120:123]
    ds_read_b64 v[152:153], v206 offset:2048
    ds_read_b64 v[154:155], v207 offset:2048
    v_mfma_f32_16x16x32_bf16 v[124:127], v[68:71], v[64:67], v[124:127]
    v_mfma_f32_16x16x32_bf16 v[128:131], v[72:75], v[64:67], v[128:131]
    v_mfma_f32_16x16x32_bf16 v[132:135], v[76:79], v[64:67], v[132:135]
    v_mfma_f32_16x16x32_bf16 v[136:139], v[80:83], v[64:67], v[136:139]
    v_mfma_f32_16x16x32_bf16 v[108:111], v[92:95], v[84:87], v[108:111]
    v_mfma_f32_16x16x32_bf16 v[112:115], v[96:99], v[84:87], v[112:115]
    v_mfma_f32_16x16x32_bf16 v[116:119], v[100:103], v[84:87], v[116:119]
    v_mfma_f32_16x16x32_bf16 v[120:123], v[104:107], v[84:87], v[120:123]
    v_mfma_f32_16x16x32_bf16 v[124:127], v[92:95], v[88:91], v[124:127]
    v_mfma_f32_16x16x32_bf16 v[128:131], v[96:99], v[88:91], v[128:131]
    v_mfma_f32_16x16x32_bf16 v[132:135], v[100:103], v[88:91], v[132:135]
    v_mfma_f32_16x16x32_bf16 v[136:139], v[104:107], v[88:91], v[136:139]
    s_lshl_b32 s58, s40, 2
    s_add_u32 s58, s58, s42
    s_lshl_b32 s60, s58, 16
    s_lshl_b32 s61, s41, 7
    s_add_u32 s60, s60, s61
    v_and_b32 v2, 15, v1
    v_lshlrev_b32 v2, 11, v2
    v_bfe_u32 v3, v1, 4, 1
    v_lshl_add_u32 v2, v3, 5, v2
    v_lshrrev_b32 v3, 5, v1
    v_lshl_add_u32 v2, v3, 4, v2
    s_add_u32 s61, s60, 32768
    s_waitcnt lgkmcnt(0)
    v_lshlrev_b32 v12, 16, v140
    v_and_b32 v13, 0xffff0000, v140
    v_lshlrev_b32 v14, 16, v141
    v_and_b32 v15, 0xffff0000, v141
    v_lshlrev_b32 v16, 16, v142
    v_and_b32 v17, 0xffff0000, v142
    v_lshlrev_b32 v18, 16, v143
    v_and_b32 v19, 0xffff0000, v143
    v_lshlrev_b32 v20, 16, v144
    v_and_b32 v21, 0xffff0000, v144
    v_lshlrev_b32 v22, 16, v145
    v_and_b32 v23, 0xffff0000, v145
    v_lshlrev_b32 v24, 16, v146
    v_and_b32 v25, 0xffff0000, v146
    v_lshlrev_b32 v26, 16, v147
    v_and_b32 v27, 0xffff0000, v147
    v_pk_fma_f32 v[108:109], v[108:109], v[156:157], v[12:13]
    v_pk_fma_f32 v[110:111], v[110:111], v[158:159], v[14:15]
    v_pk_fma_f32 v[112:113], v[112:113], v[160:161], v[16:17]
    v_pk_fma_f32 v[114:115], v[114:115], v[162:163], v[18:19]
    v_pk_fma_f32 v[116:117], v[116:117], v[164:165], v[20:21]
    v_pk_fma_f32 v[118:119], v[118:119], v[166:167], v[22:23]
    v_pk_fma_f32 v[120:121], v[120:121], v[168:169], v[24:25]
    v_pk_fma_f32 v[122:123], v[122:123], v[170:171], v[26:27]
    v_lshlrev_b32 v28, 16, v148
    v_and_b32 v29, 0xffff0000, v148
    v_lshlrev_b32 v30, 16, v149
    v_and_b32 v31, 0xffff0000, v149
    v_lshlrev_b32 v32, 16, v150
    v_and_b32 v33, 0xffff0000, v150
    v_lshlrev_b32 v34, 16, v151
    v_and_b32 v35, 0xffff0000, v151
    v_lshlrev_b32 v36, 16, v152
    v_and_b32 v37, 0xffff0000, v152
    v_lshlrev_b32 v38, 16, v153
    v_and_b32 v39, 0xffff0000, v153
    v_lshlrev_b32 v40, 16, v154
    v_and_b32 v41, 0xffff0000, v154
    v_lshlrev_b32 v42, 16, v155
    v_and_b32 v43, 0xffff0000, v155
    v_pk_fma_f32 v[124:125], v[124:125], v[156:157], v[28:29]
    v_pk_fma_f32 v[126:127], v[126:127], v[158:159], v[30:31]
    v_pk_fma_f32 v[128:129], v[128:129], v[160:161], v[32:33]
    v_pk_fma_f32 v[130:131], v[130:131], v[162:163], v[34:35]
    v_pk_fma_f32 v[132:133], v[132:133], v[164:165], v[36:37]
    v_pk_fma_f32 v[134:135], v[134:135], v[166:167], v[38:39]
    v_pk_fma_f32 v[136:137], v[136:137], v[168:169], v[40:41]
    v_pk_fma_f32 v[138:139], v[138:139], v[170:171], v[42:43]
    v_pk_add_f32 v[64:65], v[108:109], v[112:113]
    v_pk_add_f32 v[66:67], v[110:111], v[114:115]
    v_pk_mul_f32 v[68:69], v[108:109], v[108:109]
    v_pk_mul_f32 v[70:71], v[110:111], v[110:111]
    v_pk_add_f32 v[64:65], v[64:65], v[116:117]
    v_pk_add_f32 v[66:67], v[66:67], v[118:119]
    v_pk_add_f32 v[64:65], v[64:65], v[120:121]
    v_pk_add_f32 v[66:67], v[66:67], v[122:123]
    v_pk_fma_f32 v[68:69], v[112:113], v[112:113], v[68:69]
    v_pk_fma_f32 v[70:71], v[114:115], v[114:115], v[70:71]
    v_pk_fma_f32 v[68:69], v[116:117], v[116:117], v[68:69]
    v_pk_fma_f32 v[70:71], v[118:119], v[118:119], v[70:71]
    v_pk_fma_f32 v[68:69], v[120:121], v[120:121], v[68:69]
    v_pk_fma_f32 v[70:71], v[122:123], v[122:123], v[70:71]
    v_pk_add_f32 v[64:65], v[64:65], v[66:67]
    v_pk_add_f32 v[68:69], v[68:69], v[70:71]
    v_add_f32 v60, v64, v65
    v_add_f32 v62, v68, v69
    v_pk_add_f32 v[72:73], v[124:125], v[128:129]
    v_pk_add_f32 v[74:75], v[126:127], v[130:131]
    v_pk_mul_f32 v[76:77], v[124:125], v[124:125]
    v_pk_mul_f32 v[78:79], v[126:127], v[126:127]
    v_pk_add_f32 v[72:73], v[72:73], v[132:133]
    v_pk_add_f32 v[74:75], v[74:75], v[134:135]
    v_pk_add_f32 v[72:73], v[72:73], v[136:137]
    v_pk_add_f32 v[74:75], v[74:75], v[138:139]
    v_pk_fma_f32 v[76:77], v[128:129], v[128:129], v[76:77]
    v_pk_fma_f32 v[78:79], v[130:131], v[130:131], v[78:79]
    v_pk_fma_f32 v[76:77], v[132:133], v[132:133], v[76:77]
    v_pk_fma_f32 v[78:79], v[134:135], v[134:135], v[78:79]
    v_pk_fma_f32 v[76:77], v[136:137], v[136:137], v[76:77]
    v_pk_fma_f32 v[78:79], v[138:139], v[138:139], v[78:79]
    v_pk_add_f32 v[72:73], v[72:73], v[74:75]
    v_pk_add_f32 v[76:77], v[76:77], v[78:79]
    v_add_f32 v61, v72, v73
    v_add_f32 v63, v76, v77
    s_nop 0
    v_permlane32_swap_b32 v60, v61
    v_permlane32_swap_b32 v62, v63
    v_add_f32 v60, v60, v61
    v_add_f32 v62, v62, v63
    s_nop 1
    v_permlane16_swap_b32 v60, v62
    v_add_f32 v60, v60, v62
    v_and_b32 v4, 15, v1
    v_lshrrev_b32 v3, 5, v1
    v_lshl_add_u32 v4, v3, 4, v4
    v_lshlrev_b32 v4, 3, v4
    v_bfe_u32 v3, v1, 4, 1
    v_lshl_add_u32 v4, v3, 2, v4
    s_lshl_b32 s63, s58, 8
    s_lshl_b32 s62, s41, 14
    s_add_u32 s62, s63, s62
    buffer_store_dword v60, v4, s[28:31], s62 offen sc1
    v_and_b32 v4, 15, v1
    v_lshlrev_b32 v4, 4, v4
    v_bfe_u32 v3, v1, 4, 1
    v_lshl_add_u32 v4, v3, 9, v4
    v_lshrrev_b32 v3, 5, v1
    v_lshl_add_u32 v4, v3, 8, v4
    s_lshl_b32 s62, s58, 16
    s_lshl_b32 s63, s41, 11
    s_add_u32 s62, s62, s63
    s_add_u32 s63, s62, 32768
    v_pk_mul_f32 v[12:13], v[108:109], v[172:173]
    v_pk_mul_f32 v[14:15], v[110:111], v[174:175]
    v_pk_mul_f32 v[16:17], v[112:113], v[176:177]
    v_pk_mul_f32 v[18:19], v[114:115], v[178:179]
    v_pk_mul_f32 v[20:21], v[116:117], v[180:181]
    v_pk_mul_f32 v[22:23], v[118:119], v[182:183]
    v_pk_mul_f32 v[24:25], v[120:121], v[184:185]
    v_pk_mul_f32 v[26:27], v[122:123], v[186:187]
    v_cvt_pk_bf16_f32 v88, v12, v13
    v_cvt_pk_bf16_f32 v89, v14, v15
    v_cvt_pk_bf16_f32 v90, v16, v17
    v_cvt_pk_bf16_f32 v91, v18, v19
    v_cvt_pk_bf16_f32 v92, v20, v21
    v_cvt_pk_bf16_f32 v93, v22, v23
    v_cvt_pk_bf16_f32 v94, v24, v25
    v_cvt_pk_bf16_f32 v95, v26, v27
    v_permlane16_swap_b32 v88, v90
    v_permlane16_swap_b32 v89, v91
    v_permlane16_swap_b32 v92, v94
    v_permlane16_swap_b32 v93, v95
    buffer_store_dwordx4 v[88:91], v4, s[16:19], s62 offen offset:0 sc1
    buffer_store_dwordx4 v[92:95], v4, s[16:19], s62 offen offset:1024 sc1
    v_pk_mul_f32 v[28:29], v[124:125], v[172:173]
    v_pk_mul_f32 v[30:31], v[126:127], v[174:175]
    v_pk_mul_f32 v[32:33], v[128:129], v[176:177]
    v_pk_mul_f32 v[34:35], v[130:131], v[178:179]
    v_pk_mul_f32 v[36:37], v[132:133], v[180:181]
    v_pk_mul_f32 v[38:39], v[134:135], v[182:183]
    v_pk_mul_f32 v[40:41], v[136:137], v[184:185]
    v_pk_mul_f32 v[42:43], v[138:139], v[186:187]
    v_cvt_pk_bf16_f32 v96, v28, v29
    v_cvt_pk_bf16_f32 v97, v30, v31
    v_cvt_pk_bf16_f32 v98, v32, v33
    v_cvt_pk_bf16_f32 v99, v34, v35
    v_cvt_pk_bf16_f32 v100, v36, v37
    v_cvt_pk_bf16_f32 v101, v38, v39
    v_cvt_pk_bf16_f32 v102, v40, v41
    v_cvt_pk_bf16_f32 v103, v42, v43
    v_permlane16_swap_b32 v96, v98
    v_permlane16_swap_b32 v97, v99
    v_permlane16_swap_b32 v100, v102
    v_permlane16_swap_b32 v101, v103
    buffer_store_dwordx4 v[96:99], v4, s[16:19], s63 offen offset:0 sc1
    buffer_store_dwordx4 v[100:103], v4, s[16:19], s63 offen offset:1024 sc1
    s_waitcnt vmcnt(0)
    s_barrier
    s_lshl_b32 s61, s42, 12
    s_add_u32 s61, s61, 147456
    v_add_u32 v5, s61, v4
    v_cvt_pk_bf16_f32 v44, v108, v109
    v_cvt_pk_bf16_f32 v45, v110, v111
    v_cvt_pk_bf16_f32 v46, v112, v113
    v_cvt_pk_bf16_f32 v47, v114, v115
    v_cvt_pk_bf16_f32 v48, v116, v117
    v_cvt_pk_bf16_f32 v49, v118, v119
    v_cvt_pk_bf16_f32 v50, v120, v121
    v_cvt_pk_bf16_f32 v51, v122, v123
    v_permlane16_swap_b32 v44, v46
    v_permlane16_swap_b32 v45, v47
    v_permlane16_swap_b32 v48, v50
    v_permlane16_swap_b32 v49, v51
    ds_write_b128 v5, v[44:47] offset:0
    ds_write_b128 v5, v[48:51] offset:1024
    v_cvt_pk_bf16_f32 v52, v124, v125
    v_cvt_pk_bf16_f32 v53, v126, v127
    v_cvt_pk_bf16_f32 v54, v128, v129
    v_cvt_pk_bf16_f32 v55, v130, v131
    v_cvt_pk_bf16_f32 v56, v132, v133
    v_cvt_pk_bf16_f32 v57, v134, v135
    v_cvt_pk_bf16_f32 v58, v136, v137
    v_cvt_pk_bf16_f32 v59, v138, v139
    v_permlane16_swap_b32 v52, v54
    v_permlane16_swap_b32 v53, v55
    v_permlane16_swap_b32 v56, v58
    v_permlane16_swap_b32 v57, v59
    ds_write_b128 v5, v[52:55] offset:2048
    ds_write_b128 v5, v[56:59] offset:3072
    s_and_b32 s36, s2, 7
    s_lshr_b32 s37, s2, 3
    s_and_b32 s38, s36, 1
    s_lshr_b32 s36, s36, 1
    s_and_b32 s39, s37, 7
    s_lshr_b32 s37, s37, 3
    s_mul_i32 s38, s38, 8
    s_add_u32 s40, s38, s39
    s_mul_i32 s36, s36, 4
    s_add_u32 s41, s36, s37
    s_add_u32 s39, s39, s37
    s_and_b32 s39, s39, 3
    s_mul_i32 s43, s41, 448
    s_and_b32 s36, s41, 1
    s_cmp_eq_u32 s36, 0
    s_cselect_b32 s36, 384, 0
    s_cselect_b32 s37, 0, 64
    s_add_u32 s44, s43, s36
    s_add_u32 s43, s43, s37
    s_add_u32 s24, s6, 41943040
    s_addc_u32 s25, s7, 0
    s_mov_b32 s26, 14680064
    s_mov_b32 s27, 0x20000
    s_lshr_b32 s61, s2, 3
    s_lshr_b32 s62, s61, 3
    s_add_u32 s62, s62, s61
    s_and_b32 s62, s62, 3
    s_cmp_eq_u32 s62, 0
    s_cselect_b32 s63, 4, s62
    s_lshl_b32 s64, s62, 2
    s_lshr_b32 s64, 0x1431, s64
    s_and_b32 s64, s64, 15
    s_add_u32 s65, s62, 1
    s_and_b32 s65, s65, 3
    s_add_u32 s62, s63, 3
    s_bitcmp1_b32 s61, 2
    s_cselect_b32 s64, s63, s64
    s_cselect_b32 s65, s62, s65
    s_and_b32 s61, s2, 1
    s_lshl_b32 s61, s61, 3
    s_add_u32 s65, s65, s61
    s_sub_u32 s64, s64, 1
    s_lshr_b32 s52, s42, 1
    s_and_b32 s53, s42, 1
    s_mul_i32 s54, s52, 8192
    v_lshl_add_u32 v4, v1, 4, s54
    s_mul_i32 s54, s53, 4096
    v_subrev_u32 v5, s54, v4
    v_add_u32 v4, s54, v4
    v_bfe_u32 v2, v1, 2, 2
    v_lshrrev_b32 v3, 4, v1
    v_lshl_add_u32 v2, v3, 3, v2
    v_bfe_u32 v3, v1, 3, 2
    s_lshl_b32 s54, s53, 1
    v_xor_b32 v6, s54, v3
    v_lshlrev_b32 v6, 5, v6
    v_lshl_add_u32 v6, v2, 7, v6
    v_and_b32 v3, 3, v1
    v_lshlrev_b32 v3, 3, v3
    v_add_u32 v3, 16384, v3
    v_add_u32 v6, v6, v3
    v_xor_b32 v7, 32, v6
    v_bfe_u32 v8, v1, 4, 1
    v_lshlrev_b32 v8, 5, v8
    v_lshl_add_u32 v8, v2, 6, v8
    v_add_u32 v8, v8, v3
    v_add_u32 v8, 24576, v8
    v_xor_b32 v9, 32, v8
    s_lshl_b32 s58, s53, 6
    s_add_u32 s58, s58, s43
    s_mul_i32 s59, s41, 448
    s_sub_u32 s60, s58, s59
    s_sub_u32 s59, s44, s59
    s_lshl_b32 s60, s60, 1
    s_lshl_b32 s59, s59, 1
    s_add_u32 s61, s60, 138240
    v_lshl_add_u32 v2, v1, 2, s61
    s_add_u32 s61, s59, 138240
    v_lshl_add_u32 v3, v1, 2, s61
    v_lshlrev_b32 v10, 4, v1
    v_add_u32 v10, 135168, v10
    s_mov_b32 s47, 0
    s_mov_b32 s55, 45056
    s_barrier
    s_barrier
    ds_read_b64_tr_b16 v[28:29], v6 offset:0
    ds_read_b64_tr_b16 v[30:31], v6 offset:512
    ds_read_b128 v[12:15], v4 offset:0
    ds_read_b128 v[16:19], v4 offset:2048
    ds_read_b128 v[20:23], v5 offset:4096
    ds_read_b128 v[24:27], v5 offset:6144
    ds_read_b64_tr_b16 v[32:33], v7 offset:0
    ds_read_b64_tr_b16 v[34:35], v7 offset:512
    ds_read_b64_tr_b16 v[36:37], v6 offset:8192
    ds_read_b64_tr_b16 v[38:39], v6 offset:8704
    ds_read_b64_tr_b16 v[40:41], v7 offset:8192
    ds_read_b64_tr_b16 v[42:43], v7 offset:8704
    ds_read_b64_tr_b16 v[44:45], v6 offset:16384
    ds_read_b64_tr_b16 v[46:47], v6 offset:16896
    ds_read_b64_tr_b16 v[48:49], v7 offset:16384
    ds_read_b64_tr_b16 v[50:51], v7 offset:16896
    ds_read_b64_tr_b16 v[52:53], v8 offset:0
    ds_read_b64_tr_b16 v[54:55], v8 offset:256
    ds_read_b64_tr_b16 v[56:57], v9 offset:0
    ds_read_b64_tr_b16 v[58:59], v9 offset:256
    s_waitcnt lgkmcnt(0)
    v_mfma_f32_16x16x32_bf16 v[108:111], v[28:31], v[12:15], 0
    ds_read_b64_tr_b16 v[76:77], v6 offset:4096
    v_mfma_f32_16x16x32_bf16 v[112:115], v[28:31], v[16:19], 0
    ds_read_b64_tr_b16 v[78:79], v6 offset:4608
    v_mfma_f32_16x16x32_bf16 v[116:119], v[28:31], v[20:23], 0
    ds_read_b128 v[60:63], v4 offset:1024
    v_mfma_f32_16x16x32_bf16 v[120:123], v[28:31], v[24:27], 0
    ds_read_b128 v[64:67], v4 offset:3072
    v_mfma_f32_16x16x32_bf16 v[124:127], v[32:35], v[12:15], 0
    ds_read_b128 v[68:71], v5 offset:5120
    v_mfma_f32_16x16x32_bf16 v[128:131], v[32:35], v[16:19], 0
    ds_read_b128 v[72:75], v5 offset:7168
    v_mfma_f32_16x16x32_bf16 v[132:135], v[32:35], v[20:23], 0
    ds_read_b64_tr_b16 v[80:81], v7 offset:4096
    v_mfma_f32_16x16x32_bf16 v[136:139], v[32:35], v[24:27], 0
    ds_read_b64_tr_b16 v[82:83], v7 offset:4608
    v_mfma_f32_16x16x32_bf16 v[140:143], v[36:39], v[12:15], 0
    ds_read_b64_tr_b16 v[84:85], v6 offset:12288
    v_mfma_f32_16x16x32_bf16 v[144:147], v[36:39], v[16:19], 0
    ds_read_b64_tr_b16 v[86:87], v6 offset:12800
    v_mfma_f32_16x16x32_bf16 v[148:151], v[36:39], v[20:23], 0
    ds_read_b64_tr_b16 v[88:89], v7 offset:12288
    v_mfma_f32_16x16x32_bf16 v[152:155], v[36:39], v[24:27], 0
    ds_read_b64_tr_b16 v[90:91], v7 offset:12800
    v_mfma_f32_16x16x32_bf16 v[156:159], v[40:43], v[12:15], 0
    ds_read_b64_tr_b16 v[92:93], v6 offset:20480
    v_mfma_f32_16x16x32_bf16 v[160:163], v[40:43], v[16:19], 0
    ds_read_b64_tr_b16 v[94:95], v6 offset:20992
    v_mfma_f32_16x16x32_bf16 v[164:167], v[40:43], v[20:23], 0
    ds_read_b64_tr_b16 v[96:97], v7 offset:20480
    v_mfma_f32_16x16x32_bf16 v[168:171], v[40:43], v[24:27], 0
    ds_read_b64_tr_b16 v[98:99], v7 offset:20992
    v_mfma_f32_16x16x32_bf16 v[172:175], v[44:47], v[12:15], 0
    ds_read_b64_tr_b16 v[100:101], v8 offset:2048
    v_mfma_f32_16x16x32_bf16 v[176:179], v[44:47], v[16:19], 0
    ds_read_b64_tr_b16 v[102:103], v8 offset:2304
    v_mfma_f32_16x16x32_bf16 v[180:183], v[44:47], v[20:23], 0
    ds_read_b64_tr_b16 v[104:105], v9 offset:2048
    v_mfma_f32_16x16x32_bf16 v[184:187], v[44:47], v[24:27], 0
    ds_read_b64_tr_b16 v[106:107], v9 offset:2304
    v_mfma_f32_16x16x32_bf16 v[188:191], v[48:51], v[12:15], 0
    s_add_u32 s47, s47, 1
    s_cmp_eq_u32 s47, 3
    v_mfma_f32_16x16x32_bf16 v[192:195], v[48:51], v[16:19], 0
    s_cselect_b32 s47, 0, s47
    s_cselect_b32 s54, -90112, s55
    v_mfma_f32_16x16x32_bf16 v[196:199], v[48:51], v[20:23], 0
    v_add_u32 v4, s54, v4
    v_mfma_f32_16x16x32_bf16 v[200:203], v[48:51], v[24:27], 0
    v_add_u32 v6, s54, v6
    v_mfma_f32_16x16x32_bf16 v[204:207], v[52:55], v[12:15], 0
    v_add_u32 v7, s54, v7
    v_mfma_f32_16x16x32_bf16 v[208:211], v[52:55], v[16:19], 0
    v_add_u32 v5, s54, v5
    v_mfma_f32_16x16x32_bf16 v[212:215], v[56:59], v[12:15], 0
    v_add_u32 v8, s54, v8
    v_mfma_f32_16x16x32_bf16 v[216:219], v[56:59], v[16:19], 0
    v_add_u32 v9, s54, v9
    s_waitcnt lgkmcnt(0)
    v_mfma_f32_16x16x32_bf16 v[108:111], v[76:79], v[60:63], v[108:111]
    v_mfma_f32_16x16x32_bf16 v[112:115], v[76:79], v[64:67], v[112:115]
    s_barrier
    v_mfma_f32_16x16x32_bf16 v[116:119], v[76:79], v[68:71], v[116:119]
    ds_read_b64_tr_b16 v[28:29], v6 offset:0
    v_mfma_f32_16x16x32_bf16 v[120:123], v[76:79], v[72:75], v[120:123]
    ds_read_b64_tr_b16 v[30:31], v6 offset:512
    v_mfma_f32_16x16x32_bf16 v[124:127], v[80:83], v[60:63], v[124:127]
    ds_read_b128 v[12:15], v4 offset:0
    v_mfma_f32_16x16x32_bf16 v[128:131], v[80:83], v[64:67], v[128:131]
    ds_read_b128 v[16:19], v4 offset:2048
    v_mfma_f32_16x16x32_bf16 v[132:135], v[80:83], v[68:71], v[132:135]
    ds_read_b128 v[20:23], v5 offset:4096
    v_mfma_f32_16x16x32_bf16 v[136:139], v[80:83], v[72:75], v[136:139]
    ds_read_b128 v[24:27], v5 offset:6144
    v_mfma_f32_16x16x32_bf16 v[140:143], v[84:87], v[60:63], v[140:143]
    ds_read_b64_tr_b16 v[32:33], v7 offset:0
    v_mfma_f32_16x16x32_bf16 v[144:147], v[84:87], v[64:67], v[144:147]
    ds_read_b64_tr_b16 v[34:35], v7 offset:512
    v_mfma_f32_16x16x32_bf16 v[148:151], v[84:87], v[68:71], v[148:151]
    ds_read_b64_tr_b16 v[36:37], v6 offset:8192
    v_mfma_f32_16x16x32_bf16 v[152:155], v[84:87], v[72:75], v[152:155]
    ds_read_b64_tr_b16 v[38:39], v6 offset:8704
    v_mfma_f32_16x16x32_bf16 v[156:159], v[88:91], v[60:63], v[156:159]
    ds_read_b64_tr_b16 v[40:41], v7 offset:8192
    v_mfma_f32_16x16x32_bf16 v[160:163], v[88:91], v[64:67], v[160:163]
    ds_read_b64_tr_b16 v[42:43], v7 offset:8704
    v_mfma_f32_16x16x32_bf16 v[164:167], v[88:91], v[68:71], v[164:167]
    ds_read_b64_tr_b16 v[44:45], v6 offset:16384
    v_mfma_f32_16x16x32_bf16 v[168:171], v[88:91], v[72:75], v[168:171]
    ds_read_b64_tr_b16 v[46:47], v6 offset:16896
    v_mfma_f32_16x16x32_bf16 v[172:175], v[92:95], v[60:63], v[172:175]
    ds_read_b64_tr_b16 v[48:49], v7 offset:16384
    v_mfma_f32_16x16x32_bf16 v[176:179], v[92:95], v[64:67], v[176:179]
    ds_read_b64_tr_b16 v[50:51], v7 offset:16896
    v_mfma_f32_16x16x32_bf16 v[180:183], v[92:95], v[68:71], v[180:183]
    ds_read_b64_tr_b16 v[52:53], v8 offset:0
    v_mfma_f32_16x16x32_bf16 v[184:187], v[92:95], v[72:75], v[184:187]
    ds_read_b64_tr_b16 v[54:55], v8 offset:256
    v_mfma_f32_16x16x32_bf16 v[188:191], v[96:99], v[60:63], v[188:191]
    ds_read_b64_tr_b16 v[56:57], v9 offset:0
    v_mfma_f32_16x16x32_bf16 v[192:195], v[96:99], v[64:67], v[192:195]
    ds_read_b64_tr_b16 v[58:59], v9 offset:256
    v_mfma_f32_16x16x32_bf16 v[196:199], v[96:99], v[68:71], v[196:199]
    v_mfma_f32_16x16x32_bf16 v[200:203], v[96:99], v[72:75], v[200:203]
    v_mfma_f32_16x16x32_bf16 v[204:207], v[100:103], v[60:63], v[204:207]
    v_mfma_f32_16x16x32_bf16 v[208:211], v[100:103], v[64:67], v[208:211]
    v_mfma_f32_16x16x32_bf16 v[212:215], v[104:107], v[60:63], v[212:215]
    v_mfma_f32_16x16x32_bf16 v[216:219], v[104:107], v[64:67], v[216:219]
    s_mov_b32 s51, 4
w1_hloop:
    s_waitcnt lgkmcnt(0)
    s_cmp_lg_u32 s64, 0
    s_cbranch_scc1 w1_xs1
    ds_read_b128 v[60:63], v10 offset:0
    s_waitcnt lgkmcnt(0)
    v_mfma_f32_16x16x32_bf16 v[220:223], v[60:63], v[28:31], 0
    v_mfma_f32_16x16x32_bf16 v[224:227], v[60:63], v[32:35], 0
    v_mfma_f32_16x16x32_bf16 v[228:231], v[60:63], v[36:39], 0
    v_mfma_f32_16x16x32_bf16 v[232:235], v[60:63], v[40:43], 0
    v_mfma_f32_16x16x32_bf16 v[236:239], v[60:63], v[44:47], 0
    v_mfma_f32_16x16x32_bf16 v[240:243], v[60:63], v[48:51], 0
    v_mfma_f32_16x16x32_bf16 v[244:247], v[60:63], v[52:55], 0
    v_mfma_f32_16x16x32_bf16 v[248:251], v[60:63], v[56:59], 0
w1_xs1:
    v_mfma_f32_16x16x32_bf16 v[108:111], v[28:31], v[12:15], v[108:111]
    ds_read_b64_tr_b16 v[76:77], v6 offset:4096
    v_mfma_f32_16x16x32_bf16 v[112:115], v[28:31], v[16:19], v[112:115]
    ds_read_b64_tr_b16 v[78:79], v6 offset:4608
    v_mfma_f32_16x16x32_bf16 v[116:119], v[28:31], v[20:23], v[116:119]
    ds_read_b128 v[60:63], v4 offset:1024
    v_mfma_f32_16x16x32_bf16 v[120:123], v[28:31], v[24:27], v[120:123]
    ds_read_b128 v[64:67], v4 offset:3072
    v_mfma_f32_16x16x32_bf16 v[124:127], v[32:35], v[12:15], v[124:127]
    ds_read_b128 v[68:71], v5 offset:5120
    v_mfma_f32_16x16x32_bf16 v[128:131], v[32:35], v[16:19], v[128:131]
    ds_read_b128 v[72:75], v5 offset:7168
    v_mfma_f32_16x16x32_bf16 v[132:135], v[32:35], v[20:23], v[132:135]
    ds_read_b64_tr_b16 v[80:81], v7 offset:4096
    v_mfma_f32_16x16x32_bf16 v[136:139], v[32:35], v[24:27], v[136:139]
    ds_read_b64_tr_b16 v[82:83], v7 offset:4608
    v_mfma_f32_16x16x32_bf16 v[140:143], v[36:39], v[12:15], v[140:143]
    ds_read_b64_tr_b16 v[84:85], v6 offset:12288
    v_mfma_f32_16x16x32_bf16 v[144:147], v[36:39], v[16:19], v[144:147]
    ds_read_b64_tr_b16 v[86:87], v6 offset:12800
    v_mfma_f32_16x16x32_bf16 v[148:151], v[36:39], v[20:23], v[148:151]
    ds_read_b64_tr_b16 v[88:89], v7 offset:12288
    v_mfma_f32_16x16x32_bf16 v[152:155], v[36:39], v[24:27], v[152:155]
    ds_read_b64_tr_b16 v[90:91], v7 offset:12800
    v_mfma_f32_16x16x32_bf16 v[156:159], v[40:43], v[12:15], v[156:159]
    ds_read_b64_tr_b16 v[92:93], v6 offset:20480
    v_mfma_f32_16x16x32_bf16 v[160:163], v[40:43], v[16:19], v[160:163]
    ds_read_b64_tr_b16 v[94:95], v6 offset:20992
    v_mfma_f32_16x16x32_bf16 v[164:167], v[40:43], v[20:23], v[164:167]
    ds_read_b64_tr_b16 v[96:97], v7 offset:20480
    v_mfma_f32_16x16x32_bf16 v[168:171], v[40:43], v[24:27], v[168:171]
    ds_read_b64_tr_b16 v[98:99], v7 offset:20992
    v_mfma_f32_16x16x32_bf16 v[172:175], v[44:47], v[12:15], v[172:175]
    ds_read_b64_tr_b16 v[100:101], v8 offset:2048
    v_mfma_f32_16x16x32_bf16 v[176:179], v[44:47], v[16:19], v[176:179]
    ds_read_b64_tr_b16 v[102:103], v8 offset:2304
    v_mfma_f32_16x16x32_bf16 v[180:183], v[44:47], v[20:23], v[180:183]
    ds_read_b64_tr_b16 v[104:105], v9 offset:2048
    v_mfma_f32_16x16x32_bf16 v[184:187], v[44:47], v[24:27], v[184:187]
    ds_read_b64_tr_b16 v[106:107], v9 offset:2304
    v_mfma_f32_16x16x32_bf16 v[188:191], v[48:51], v[12:15], v[188:191]
    s_add_u32 s47, s47, 1
    s_cmp_eq_u32 s47, 3
    v_mfma_f32_16x16x32_bf16 v[192:195], v[48:51], v[16:19], v[192:195]
    s_cselect_b32 s47, 0, s47
    s_cselect_b32 s54, -90112, s55
    v_mfma_f32_16x16x32_bf16 v[196:199], v[48:51], v[20:23], v[196:199]
    v_add_u32 v4, s54, v4
    v_mfma_f32_16x16x32_bf16 v[200:203], v[48:51], v[24:27], v[200:203]
    v_add_u32 v6, s54, v6
    v_mfma_f32_16x16x32_bf16 v[204:207], v[52:55], v[12:15], v[204:207]
    v_add_u32 v7, s54, v7
    v_mfma_f32_16x16x32_bf16 v[208:211], v[52:55], v[16:19], v[208:211]
    v_add_u32 v5, s54, v5
    v_mfma_f32_16x16x32_bf16 v[212:215], v[56:59], v[12:15], v[212:215]
    v_add_u32 v8, s54, v8
    v_mfma_f32_16x16x32_bf16 v[216:219], v[56:59], v[16:19], v[216:219]
    v_add_u32 v9, s54, v9
    s_waitcnt lgkmcnt(0)
    s_cmp_lg_u32 s64, 0
    s_cbranch_scc1 w1_xs2
    ds_read_b128 v[12:15], v10 offset:1024
    s_waitcnt lgkmcnt(0)
    v_mfma_f32_16x16x32_bf16 v[220:223], v[12:15], v[76:79], v[220:223]
    v_mfma_f32_16x16x32_bf16 v[224:227], v[12:15], v[80:83], v[224:227]
    v_mfma_f32_16x16x32_bf16 v[228:231], v[12:15], v[84:87], v[228:231]
    v_mfma_f32_16x16x32_bf16 v[232:235], v[12:15], v[88:91], v[232:235]
    v_mfma_f32_16x16x32_bf16 v[236:239], v[12:15], v[92:95], v[236:239]
    v_mfma_f32_16x16x32_bf16 v[240:243], v[12:15], v[96:99], v[240:243]
    v_mfma_f32_16x16x32_bf16 v[244:247], v[12:15], v[100:103], v[244:247]
    v_mfma_f32_16x16x32_bf16 v[248:251], v[12:15], v[104:107], v[248:251]
    s_mov_b64 exec, 0xffff
    ds_write_b32 v2, v220 offset:0
    ds_write_b32 v2, v221 offset:1024
    ds_write_b32 v2, v224 offset:64
    ds_write_b32 v2, v225 offset:1088
    ds_write_b32 v2, v228 offset:256
    ds_write_b32 v2, v229 offset:1280
    ds_write_b32 v2, v232 offset:320
    ds_write_b32 v2, v233 offset:1344
    ds_write_b32 v2, v236 offset:512
    ds_write_b32 v2, v237 offset:1536
    ds_write_b32 v2, v240 offset:576
    ds_write_b32 v2, v241 offset:1600
    ds_write_b32 v3, v244 offset:0
    ds_write_b32 v3, v245 offset:1024
    ds_write_b32 v3, v248 offset:64
    ds_write_b32 v3, v249 offset:1088
    s_mov_b64 exec, -1
    s_waitcnt lgkmcnt(0)
w1_xs2:
    s_sub_u32 s64, s64, 1
    v_mfma_f32_16x16x32_bf16 v[108:111], v[76:79], v[60:63], v[108:111]
    v_mfma_f32_16x16x32_bf16 v[112:115], v[76:79], v[64:67], v[112:115]
    s_barrier
    v_mfma_f32_16x16x32_bf16 v[116:119], v[76:79], v[68:71], v[116:119]
    ds_read_b64_tr_b16 v[28:29], v6 offset:0
    v_mfma_f32_16x16x32_bf16 v[120:123], v[76:79], v[72:75], v[120:123]
    ds_read_b64_tr_b16 v[30:31], v6 offset:512
    v_mfma_f32_16x16x32_bf16 v[124:127], v[80:83], v[60:63], v[124:127]
    ds_read_b128 v[12:15], v4 offset:0
    v_mfma_f32_16x16x32_bf16 v[128:131], v[80:83], v[64:67], v[128:131]
    ds_read_b128 v[16:19], v4 offset:2048
    v_mfma_f32_16x16x32_bf16 v[132:135], v[80:83], v[68:71], v[132:135]
    ds_read_b128 v[20:23], v5 offset:4096
    v_mfma_f32_16x16x32_bf16 v[136:139], v[80:83], v[72:75], v[136:139]
    ds_read_b128 v[24:27], v5 offset:6144
    v_mfma_f32_16x16x32_bf16 v[140:143], v[84:87], v[60:63], v[140:143]
    ds_read_b64_tr_b16 v[32:33], v7 offset:0
    v_mfma_f32_16x16x32_bf16 v[144:147], v[84:87], v[64:67], v[144:147]
    ds_read_b64_tr_b16 v[34:35], v7 offset:512
    v_mfma_f32_16x16x32_bf16 v[148:151], v[84:87], v[68:71], v[148:151]
    ds_read_b64_tr_b16 v[36:37], v6 offset:8192
    v_mfma_f32_16x16x32_bf16 v[152:155], v[84:87], v[72:75], v[152:155]
    ds_read_b64_tr_b16 v[38:39], v6 offset:8704
    v_mfma_f32_16x16x32_bf16 v[156:159], v[88:91], v[60:63], v[156:159]
    ds_read_b64_tr_b16 v[40:41], v7 offset:8192
    v_mfma_f32_16x16x32_bf16 v[160:163], v[88:91], v[64:67], v[160:163]
    ds_read_b64_tr_b16 v[42:43], v7 offset:8704
    v_mfma_f32_16x16x32_bf16 v[164:167], v[88:91], v[68:71], v[164:167]
    ds_read_b64_tr_b16 v[44:45], v6 offset:16384
    v_mfma_f32_16x16x32_bf16 v[168:171], v[88:91], v[72:75], v[168:171]
    ds_read_b64_tr_b16 v[46:47], v6 offset:16896
    v_mfma_f32_16x16x32_bf16 v[172:175], v[92:95], v[60:63], v[172:175]
    ds_read_b64_tr_b16 v[48:49], v7 offset:16384
    v_mfma_f32_16x16x32_bf16 v[176:179], v[92:95], v[64:67], v[176:179]
    ds_read_b64_tr_b16 v[50:51], v7 offset:16896
    v_mfma_f32_16x16x32_bf16 v[180:183], v[92:95], v[68:71], v[180:183]
    ds_read_b64_tr_b16 v[52:53], v8 offset:0
    v_mfma_f32_16x16x32_bf16 v[184:187], v[92:95], v[72:75], v[184:187]
    ds_read_b64_tr_b16 v[54:55], v8 offset:256
    v_mfma_f32_16x16x32_bf16 v[188:191], v[96:99], v[60:63], v[188:191]
    ds_read_b64_tr_b16 v[56:57], v9 offset:0
    v_mfma_f32_16x16x32_bf16 v[192:195], v[96:99], v[64:67], v[192:195]
    ds_read_b64_tr_b16 v[58:59], v9 offset:256
    v_mfma_f32_16x16x32_bf16 v[196:199], v[96:99], v[68:71], v[196:199]
    v_mfma_f32_16x16x32_bf16 v[200:203], v[96:99], v[72:75], v[200:203]
    v_mfma_f32_16x16x32_bf16 v[204:207], v[100:103], v[60:63], v[204:207]
    v_mfma_f32_16x16x32_bf16 v[208:211], v[100:103], v[64:67], v[208:211]
    v_mfma_f32_16x16x32_bf16 v[212:215], v[104:107], v[60:63], v[212:215]
    v_mfma_f32_16x16x32_bf16 v[216:219], v[104:107], v[64:67], v[216:219]
    s_sub_u32 s51, s51, 1
    s_cmp_lg_u32 s51, 0
    s_cbranch_scc1 w1_hloop
    s_mov_b32 s51, 10
    .p2align 3
w1_cloop:
    s_waitcnt lgkmcnt(0)
    v_mfma_f32_16x16x32_bf16 v[108:111], v[28:31], v[12:15], v[108:111]
    ds_read_b64_tr_b16 v[76:77], v6 offset:4096
    v_mfma_f32_16x16x32_bf16 v[112:115], v[28:31], v[16:19], v[112:115]
    ds_read_b64_tr_b16 v[78:79], v6 offset:4608
    v_mfma_f32_16x16x32_bf16 v[116:119], v[28:31], v[20:23], v[116:119]
    ds_read_b128 v[60:63], v4 offset:1024
    v_mfma_f32_16x16x32_bf16 v[120:123], v[28:31], v[24:27], v[120:123]
    ds_read_b128 v[64:67], v4 offset:3072
    v_mfma_f32_16x16x32_bf16 v[124:127], v[32:35], v[12:15], v[124:127]
    ds_read_b128 v[68:71], v5 offset:5120
    v_mfma_f32_16x16x32_bf16 v[128:131], v[32:35], v[16:19], v[128:131]
    ds_read_b128 v[72:75], v5 offset:7168
    v_mfma_f32_16x16x32_bf16 v[132:135], v[32:35], v[20:23], v[132:135]
    ds_read_b64_tr_b16 v[80:81], v7 offset:4096
    v_mfma_f32_16x16x32_bf16 v[136:139], v[32:35], v[24:27], v[136:139]
    ds_read_b64_tr_b16 v[82:83], v7 offset:4608
    v_mfma_f32_16x16x32_bf16 v[140:143], v[36:39], v[12:15], v[140:143]
    ds_read_b64_tr_b16 v[84:85], v6 offset:12288
    v_mfma_f32_16x16x32_bf16 v[144:147], v[36:39], v[16:19], v[144:147]
    ds_read_b64_tr_b16 v[86:87], v6 offset:12800
    v_mfma_f32_16x16x32_bf16 v[148:151], v[36:39], v[20:23], v[148:151]
    ds_read_b64_tr_b16 v[88:89], v7 offset:12288
    v_mfma_f32_16x16x32_bf16 v[152:155], v[36:39], v[24:27], v[152:155]
    ds_read_b64_tr_b16 v[90:91], v7 offset:12800
    v_mfma_f32_16x16x32_bf16 v[156:159], v[40:43], v[12:15], v[156:159]
    ds_read_b64_tr_b16 v[92:93], v6 offset:20480
    v_mfma_f32_16x16x32_bf16 v[160:163], v[40:43], v[16:19], v[160:163]
    ds_read_b64_tr_b16 v[94:95], v6 offset:20992
    v_mfma_f32_16x16x32_bf16 v[164:167], v[40:43], v[20:23], v[164:167]
    ds_read_b64_tr_b16 v[96:97], v7 offset:20480
    v_mfma_f32_16x16x32_bf16 v[168:171], v[40:43], v[24:27], v[168:171]
    ds_read_b64_tr_b16 v[98:99], v7 offset:20992
    v_mfma_f32_16x16x32_bf16 v[172:175], v[44:47], v[12:15], v[172:175]
    ds_read_b64_tr_b16 v[100:101], v8 offset:2048
    v_mfma_f32_16x16x32_bf16 v[176:179], v[44:47], v[16:19], v[176:179]
    ds_read_b64_tr_b16 v[102:103], v8 offset:2304
    v_mfma_f32_16x16x32_bf16 v[180:183], v[44:47], v[20:23], v[180:183]
    ds_read_b64_tr_b16 v[104:105], v9 offset:2048
    v_mfma_f32_16x16x32_bf16 v[184:187], v[44:47], v[24:27], v[184:187]
    ds_read_b64_tr_b16 v[106:107], v9 offset:2304
    v_mfma_f32_16x16x32_bf16 v[188:191], v[48:51], v[12:15], v[188:191]
    s_add_u32 s47, s47, 1
    s_cmp_eq_u32 s47, 3
    v_mfma_f32_16x16x32_bf16 v[192:195], v[48:51], v[16:19], v[192:195]
    s_cselect_b32 s47, 0, s47
    s_cselect_b32 s54, -90112, s55
    v_mfma_f32_16x16x32_bf16 v[196:199], v[48:51], v[20:23], v[196:199]
    v_add_u32 v4, s54, v4
    v_mfma_f32_16x16x32_bf16 v[200:203], v[48:51], v[24:27], v[200:203]
    v_add_u32 v6, s54, v6
    v_mfma_f32_16x16x32_bf16 v[204:207], v[52:55], v[12:15], v[204:207]
    v_add_u32 v7, s54, v7
    v_mfma_f32_16x16x32_bf16 v[208:211], v[52:55], v[16:19], v[208:211]
    v_add_u32 v5, s54, v5
    v_mfma_f32_16x16x32_bf16 v[212:215], v[56:59], v[12:15], v[212:215]
    v_add_u32 v8, s54, v8
    v_mfma_f32_16x16x32_bf16 v[216:219], v[56:59], v[16:19], v[216:219]
    v_add_u32 v9, s54, v9
    s_waitcnt lgkmcnt(0)
    v_mfma_f32_16x16x32_bf16 v[108:111], v[76:79], v[60:63], v[108:111]
    v_mfma_f32_16x16x32_bf16 v[112:115], v[76:79], v[64:67], v[112:115]
    s_barrier
    v_mfma_f32_16x16x32_bf16 v[116:119], v[76:79], v[68:71], v[116:119]
    ds_read_b64_tr_b16 v[28:29], v6 offset:0
    v_mfma_f32_16x16x32_bf16 v[120:123], v[76:79], v[72:75], v[120:123]
    ds_read_b64_tr_b16 v[30:31], v6 offset:512
    v_mfma_f32_16x16x32_bf16 v[124:127], v[80:83], v[60:63], v[124:127]
    ds_read_b128 v[12:15], v4 offset:0
    v_mfma_f32_16x16x32_bf16 v[128:131], v[80:83], v[64:67], v[128:131]
    ds_read_b128 v[16:19], v4 offset:2048
    v_mfma_f32_16x16x32_bf16 v[132:135], v[80:83], v[68:71], v[132:135]
    ds_read_b128 v[20:23], v5 offset:4096
    v_mfma_f32_16x16x32_bf16 v[136:139], v[80:83], v[72:75], v[136:139]
    ds_read_b128 v[24:27], v5 offset:6144
    v_mfma_f32_16x16x32_bf16 v[140:143], v[84:87], v[60:63], v[140:143]
    ds_read_b64_tr_b16 v[32:33], v7 offset:0
    v_mfma_f32_16x16x32_bf16 v[144:147], v[84:87], v[64:67], v[144:147]
    ds_read_b64_tr_b16 v[34:35], v7 offset:512
    v_mfma_f32_16x16x32_bf16 v[148:151], v[84:87], v[68:71], v[148:151]
    ds_read_b64_tr_b16 v[36:37], v6 offset:8192
    v_mfma_f32_16x16x32_bf16 v[152:155], v[84:87], v[72:75], v[152:155]
    ds_read_b64_tr_b16 v[38:39], v6 offset:8704
    v_mfma_f32_16x16x32_bf16 v[156:159], v[88:91], v[60:63], v[156:159]
    ds_read_b64_tr_b16 v[40:41], v7 offset:8192
    v_mfma_f32_16x16x32_bf16 v[160:163], v[88:91], v[64:67], v[160:163]
    ds_read_b64_tr_b16 v[42:43], v7 offset:8704
    v_mfma_f32_16x16x32_bf16 v[164:167], v[88:91], v[68:71], v[164:167]
    ds_read_b64_tr_b16 v[44:45], v6 offset:16384
    v_mfma_f32_16x16x32_bf16 v[168:171], v[88:91], v[72:75], v[168:171]
    ds_read_b64_tr_b16 v[46:47], v6 offset:16896
    v_mfma_f32_16x16x32_bf16 v[172:175], v[92:95], v[60:63], v[172:175]
    ds_read_b64_tr_b16 v[48:49], v7 offset:16384
    v_mfma_f32_16x16x32_bf16 v[176:179], v[92:95], v[64:67], v[176:179]
    ds_read_b64_tr_b16 v[50:51], v7 offset:16896
    v_mfma_f32_16x16x32_bf16 v[180:183], v[92:95], v[68:71], v[180:183]
    ds_read_b64_tr_b16 v[52:53], v8 offset:0
    v_mfma_f32_16x16x32_bf16 v[184:187], v[92:95], v[72:75], v[184:187]
    ds_read_b64_tr_b16 v[54:55], v8 offset:256
    v_mfma_f32_16x16x32_bf16 v[188:191], v[96:99], v[60:63], v[188:191]
    ds_read_b64_tr_b16 v[56:57], v9 offset:0
    v_mfma_f32_16x16x32_bf16 v[192:195], v[96:99], v[64:67], v[192:195]
    ds_read_b64_tr_b16 v[58:59], v9 offset:256
    v_mfma_f32_16x16x32_bf16 v[196:199], v[96:99], v[68:71], v[196:199]
    v_mfma_f32_16x16x32_bf16 v[200:203], v[96:99], v[72:75], v[200:203]
    v_mfma_f32_16x16x32_bf16 v[204:207], v[100:103], v[60:63], v[204:207]
    v_mfma_f32_16x16x32_bf16 v[208:211], v[100:103], v[64:67], v[208:211]
    v_mfma_f32_16x16x32_bf16 v[212:215], v[104:107], v[60:63], v[212:215]
    v_mfma_f32_16x16x32_bf16 v[216:219], v[104:107], v[64:67], v[216:219]
    s_sub_u32 s51, s51, 1
    s_cmp_lg_u32 s51, 0
    s_cbranch_scc1 w1_cloop
    s_waitcnt lgkmcnt(0)
    v_mfma_f32_16x16x32_bf16 v[108:111], v[28:31], v[12:15], v[108:111]
    ds_read_b64_tr_b16 v[76:77], v6 offset:4096
    v_mfma_f32_16x16x32_bf16 v[112:115], v[28:31], v[16:19], v[112:115]
    ds_read_b64_tr_b16 v[78:79], v6 offset:4608
    v_mfma_f32_16x16x32_bf16 v[116:119], v[28:31], v[20:23], v[116:119]
    ds_read_b128 v[60:63], v4 offset:1024
    v_mfma_f32_16x16x32_bf16 v[120:123], v[28:31], v[24:27], v[120:123]
    ds_read_b128 v[64:67], v4 offset:3072
    v_mfma_f32_16x16x32_bf16 v[124:127], v[32:35], v[12:15], v[124:127]
    ds_read_b128 v[68:71], v5 offset:5120
    v_mfma_f32_16x16x32_bf16 v[128:131], v[32:35], v[16:19], v[128:131]
    ds_read_b128 v[72:75], v5 offset:7168
    v_mfma_f32_16x16x32_bf16 v[132:135], v[32:35], v[20:23], v[132:135]
    ds_read_b64_tr_b16 v[80:81], v7 offset:4096
    v_mfma_f32_16x16x32_bf16 v[136:139], v[32:35], v[24:27], v[136:139]
    ds_read_b64_tr_b16 v[82:83], v7 offset:4608
    v_mfma_f32_16x16x32_bf16 v[140:143], v[36:39], v[12:15], v[140:143]
    ds_read_b64_tr_b16 v[84:85], v6 offset:12288
    v_mfma_f32_16x16x32_bf16 v[144:147], v[36:39], v[16:19], v[144:147]
    ds_read_b64_tr_b16 v[86:87], v6 offset:12800
    v_mfma_f32_16x16x32_bf16 v[148:151], v[36:39], v[20:23], v[148:151]
    ds_read_b64_tr_b16 v[88:89], v7 offset:12288
    v_mfma_f32_16x16x32_bf16 v[152:155], v[36:39], v[24:27], v[152:155]
    ds_read_b64_tr_b16 v[90:91], v7 offset:12800
    v_mfma_f32_16x16x32_bf16 v[156:159], v[40:43], v[12:15], v[156:159]
    ds_read_b64_tr_b16 v[92:93], v6 offset:20480
    v_mfma_f32_16x16x32_bf16 v[160:163], v[40:43], v[16:19], v[160:163]
    ds_read_b64_tr_b16 v[94:95], v6 offset:20992
    v_mfma_f32_16x16x32_bf16 v[164:167], v[40:43], v[20:23], v[164:167]
    ds_read_b64_tr_b16 v[96:97], v7 offset:20480
    v_mfma_f32_16x16x32_bf16 v[168:171], v[40:43], v[24:27], v[168:171]
    ds_read_b64_tr_b16 v[98:99], v7 offset:20992
    v_mfma_f32_16x16x32_bf16 v[172:175], v[44:47], v[12:15], v[172:175]
    ds_read_b64_tr_b16 v[100:101], v8 offset:2048
    v_mfma_f32_16x16x32_bf16 v[176:179], v[44:47], v[16:19], v[176:179]
    ds_read_b64_tr_b16 v[102:103], v8 offset:2304
    v_mfma_f32_16x16x32_bf16 v[180:183], v[44:47], v[20:23], v[180:183]
    ds_read_b64_tr_b16 v[104:105], v9 offset:2048
    v_mfma_f32_16x16x32_bf16 v[184:187], v[44:47], v[24:27], v[184:187]
    ds_read_b64_tr_b16 v[106:107], v9 offset:2304
    v_mfma_f32_16x16x32_bf16 v[188:191], v[48:51], v[12:15], v[188:191]
    v_mfma_f32_16x16x32_bf16 v[192:195], v[48:51], v[16:19], v[192:195]
    v_mfma_f32_16x16x32_bf16 v[196:199], v[48:51], v[20:23], v[196:199]
    v_mfma_f32_16x16x32_bf16 v[200:203], v[48:51], v[24:27], v[200:203]
    v_mfma_f32_16x16x32_bf16 v[204:207], v[52:55], v[12:15], v[204:207]
    v_mfma_f32_16x16x32_bf16 v[208:211], v[52:55], v[16:19], v[208:211]
    v_mfma_f32_16x16x32_bf16 v[212:215], v[56:59], v[12:15], v[212:215]
    v_mfma_f32_16x16x32_bf16 v[216:219], v[56:59], v[16:19], v[216:219]
    s_waitcnt lgkmcnt(0)
    v_mfma_f32_16x16x32_bf16 v[108:111], v[76:79], v[60:63], v[108:111]
    v_mfma_f32_16x16x32_bf16 v[112:115], v[76:79], v[64:67], v[112:115]
    v_mfma_f32_16x16x32_bf16 v[116:119], v[76:79], v[68:71], v[116:119]
    v_mfma_f32_16x16x32_bf16 v[120:123], v[76:79], v[72:75], v[120:123]
    v_mfma_f32_16x16x32_bf16 v[124:127], v[80:83], v[60:63], v[124:127]
    v_mfma_f32_16x16x32_bf16 v[128:131], v[80:83], v[64:67], v[128:131]
    v_mfma_f32_16x16x32_bf16 v[132:135], v[80:83], v[68:71], v[132:135]
    v_mfma_f32_16x16x32_bf16 v[136:139], v[80:83], v[72:75], v[136:139]
    v_mfma_f32_16x16x32_bf16 v[140:143], v[84:87], v[60:63], v[140:143]
    v_mfma_f32_16x16x32_bf16 v[144:147], v[84:87], v[64:67], v[144:147]
    v_mfma_f32_16x16x32_bf16 v[148:151], v[84:87], v[68:71], v[148:151]
    v_mfma_f32_16x16x32_bf16 v[152:155], v[84:87], v[72:75], v[152:155]
    v_mfma_f32_16x16x32_bf16 v[156:159], v[88:91], v[60:63], v[156:159]
    v_mfma_f32_16x16x32_bf16 v[160:163], v[88:91], v[64:67], v[160:163]
    v_mfma_f32_16x16x32_bf16 v[164:167], v[88:91], v[68:71], v[164:167]
    v_mfma_f32_16x16x32_bf16 v[168:171], v[88:91], v[72:75], v[168:171]
    v_mfma_f32_16x16x32_bf16 v[172:175], v[92:95], v[60:63], v[172:175]
    v_mfma_f32_16x16x32_bf16 v[176:179], v[92:95], v[64:67], v[176:179]
    v_mfma_f32_16x16x32_bf16 v[180:183], v[92:95], v[68:71], v[180:183]
    v_mfma_f32_16x16x32_bf16 v[184:187], v[92:95], v[72:75], v[184:187]
    v_mfma_f32_16x16x32_bf16 v[188:191], v[96:99], v[60:63], v[188:191]
    v_mfma_f32_16x16x32_bf16 v[192:195], v[96:99], v[64:67], v[192:195]
    v_mfma_f32_16x16x32_bf16 v[196:199], v[96:99], v[68:71], v[196:199]
    v_mfma_f32_16x16x32_bf16 v[200:203], v[96:99], v[72:75], v[200:203]
    v_mfma_f32_16x16x32_bf16 v[204:207], v[100:103], v[60:63], v[204:207]
    v_mfma_f32_16x16x32_bf16 v[208:211], v[100:103], v[64:67], v[208:211]
    v_mfma_f32_16x16x32_bf16 v[212:215], v[104:107], v[60:63], v[212:215]
    v_mfma_f32_16x16x32_bf16 v[216:219], v[104:107], v[64:67], v[216:219]
    v_lshrrev_b32 v3, 4, v1
    v_lshlrev_b32 v3, 4, v3
    s_add_u32 s60, s60, 140288
    s_add_u32 s59, s59, 140288
    v_add_u32 v2, s60, v3
    v_add_u32 v3, s59, v3
    v_and_b32 v5, 15, v1
    v_lshlrev_b32 v5, 3, v5
    s_lshl_b32 s60, s52, 9
    s_add_u32 s60, s60, 137216
    s_lshl_b32 s59, s53, 8
    s_add_u32 s61, s60, s59
    s_sub_u32 s60, s60, s59
    v_add_u32 v6, s60, v5
    v_add_u32 v5, s61, v5
    s_barrier
    ds_read_b64 v[220:221], v5 offset:0
    ds_read_b64 v[222:223], v5 offset:128
    ds_read_b64 v[224:225], v6 offset:256
    ds_read_b64 v[226:227], v6 offset:384
    ds_read_b128 v[12:15], v2 offset:0
    ds_read_b128 v[44:47], v2 offset:1024
    ds_read_b128 v[16:19], v2 offset:64
    ds_read_b128 v[48:51], v2 offset:1088
    ds_read_b128 v[20:23], v2 offset:256
    ds_read_b128 v[52:55], v2 offset:1280
    ds_read_b128 v[24:27], v2 offset:320
    ds_read_b128 v[56:59], v2 offset:1344
    ds_read_b128 v[28:31], v2 offset:512
    ds_read_b128 v[60:63], v2 offset:1536
    ds_read_b128 v[32:35], v2 offset:576
    ds_read_b128 v[64:67], v2 offset:1600
    ds_read_b128 v[36:39], v3 offset:0
    ds_read_b128 v[68:71], v3 offset:1024
    ds_read_b128 v[40:43], v3 offset:64
    ds_read_b128 v[72:75], v3 offset:1088
    v_lshlrev_b32 v4, 4, v1
    s_lshl_b32 s60, s40, 1
    s_add_u32 s60, s60, s52
    s_mul_i32 s60, s60, 458752
    s_mul_i32 s59, s53, 229376
    s_lshl_b32 s61, s58, 4
    s_add_u32 s61, s61, s60
    s_lshl_b32 s62, s44, 4
    s_add_u32 s62, s62, s60
    s_add_u32 s62, s62, s59
    s_add_u32 s61, s61, s59
    s_mul_i32 s60, s40, 917504
    s_lshl_b32 s59, s52, 13
    s_add_u32 s60, s60, s59
    s_lshl_b32 s59, s53, 12
    s_lshl_b32 s61, s43, 7
    s_add_u32 s61, s61, s60
    s_add_u32 s61, s61, s59
    s_lshl_b32 s62, s53, 10
    s_add_u32 s61, s61, s62
    s_lshr_b32 s62, s44, 7
    s_lshl_b32 s62, s62, 14
    s_add_u32 s62, s62, s60
    s_add_u32 s62, s62, s59
    s_bfe_u32 s63, s44, 0x10006
    s_lshl_b32 s63, s63, 10
    s_add_u32 s62, s62, s63
    s_lshl_b32 s63, s52, 13
    s_lshl_b32 s64, s53, 10
    s_add_u32 s63, s63, s64
    s_lshl_b32 s64, s53, 12
    s_add_u32 s65, s63, s64
    s_sub_u32 s63, s63, s64
    s_add_u32 s65, s65, 32768
    s_add_u32 s63, s63, 32768
    v_add_u32 v7, s65, v4
    v_add_u32 v8, s63, v4
    v_add_u32 v9, 0x10000, v7
    v_add_u32 v10, 0x10000, v8
    s_waitcnt lgkmcnt(0)
    v_pk_fma_f32 v[228:229], v[12:13], v[220:221], v[44:45] op_sel:[0,1,0] op_sel_hi:[1,1,1]
    v_pk_fma_f32 v[230:231], v[14:15], v[220:221], v[46:47] op_sel:[0,1,0] op_sel_hi:[1,1,1]
    v_pk_fma_f32 v[232:233], v[16:17], v[220:221], v[48:49] op_sel:[0,1,0] op_sel_hi:[1,1,1]
    v_pk_fma_f32 v[234:235], v[18:19], v[220:221], v[50:51] op_sel:[0,1,0] op_sel_hi:[1,1,1]
    v_pk_fma_f32 v[236:237], v[20:21], v[220:221], v[52:53] op_sel:[0,1,0] op_sel_hi:[1,1,1]
    v_pk_fma_f32 v[238:239], v[22:23], v[220:221], v[54:55] op_sel:[0,1,0] op_sel_hi:[1,1,1]
    v_pk_fma_f32 v[240:241], v[24:25], v[220:221], v[56:57] op_sel:[0,1,0] op_sel_hi:[1,1,1]
    v_pk_fma_f32 v[242:243], v[26:27], v[220:221], v[58:59] op_sel:[0,1,0] op_sel_hi:[1,1,1]
    v_pk_fma_f32 v[108:109], v[108:109], v[220:221], v[228:229] op_sel_hi:[1,0,1]
    v_pk_fma_f32 v[110:111], v[110:111], v[220:221], v[230:231] op_sel_hi:[1,0,1]
    v_pk_fma_f32 v[124:125], v[124:125], v[220:221], v[232:233] op_sel_hi:[1,0,1]
    v_pk_fma_f32 v[126:127], v[126:127], v[220:221], v[234:235] op_sel_hi:[1,0,1]
    v_pk_fma_f32 v[140:141], v[140:141], v[220:221], v[236:237] op_sel_hi:[1,0,1]
    v_pk_fma_f32 v[142:143], v[142:143], v[220:221], v[238:239] op_sel_hi:[1,0,1]
    v_pk_fma_f32 v[156:157], v[156:157], v[220:221], v[240:241] op_sel_hi:[1,0,1]
    v_pk_fma_f32 v[158:159], v[158:159], v[220:221], v[242:243] op_sel_hi:[1,0,1]
    v_pk_fma_f32 v[228:229], v[28:29], v[220:221], v[60:61] op_sel:[0,1,0] op_sel_hi:[1,1,1]
    v_pk_fma_f32 v[230:231], v[30:31], v[220:221], v[62:63] op_sel:[0,1,0] op_sel_hi:[1,1,1]
    v_pk_fma_f32 v[232:233], v[32:33], v[220:221], v[64:65] op_sel:[0,1,0] op_sel_hi:[1,1,1]
    v_pk_fma_f32 v[234:235], v[34:35], v[220:221], v[66:67] op_sel:[0,1,0] op_sel_hi:[1,1,1]
    v_pk_fma_f32 v[236:237], v[36:37], v[220:221], v[68:69] op_sel:[0,1,0] op_sel_hi:[1,1,1]
    v_pk_fma_f32 v[238:239], v[38:39], v[220:221], v[70:71] op_sel:[0,1,0] op_sel_hi:[1,1,1]
    v_pk_fma_f32 v[240:241], v[40:41], v[220:221], v[72:73] op_sel:[0,1,0] op_sel_hi:[1,1,1]
    v_pk_fma_f32 v[242:243], v[42:43], v[220:221], v[74:75] op_sel:[0,1,0] op_sel_hi:[1,1,1]
    v_pk_fma_f32 v[172:173], v[172:173], v[220:221], v[228:229] op_sel_hi:[1,0,1]
    v_pk_fma_f32 v[174:175], v[174:175], v[220:221], v[230:231] op_sel_hi:[1,0,1]
    v_pk_fma_f32 v[188:189], v[188:189], v[220:221], v[232:233] op_sel_hi:[1,0,1]
    v_pk_fma_f32 v[190:191], v[190:191], v[220:221], v[234:235] op_sel_hi:[1,0,1]
    v_pk_fma_f32 v[204:205], v[204:205], v[220:221], v[236:237] op_sel_hi:[1,0,1]
    v_pk_fma_f32 v[206:207], v[206:207], v[220:221], v[238:239] op_sel_hi:[1,0,1]
    v_pk_fma_f32 v[212:213], v[212:213], v[220:221], v[240:241] op_sel_hi:[1,0,1]
    v_pk_fma_f32 v[214:215], v[214:215], v[220:221], v[242:243] op_sel_hi:[1,0,1]
    v_max_f32 v108, 0, v108
    v_max_f32 v109, 0, v109
    v_max_f32 v110, 0, v110
    v_max_f32 v111, 0, v111
    v_max_f32 v124, 0, v124
    v_max_f32 v125, 0, v125
    v_max_f32 v126, 0, v126
    v_max_f32 v127, 0, v127
    v_max_f32 v140, 0, v140
    v_max_f32 v141, 0, v141
    v_max_f32 v142, 0, v142
    v_max_f32 v143, 0, v143
    v_max_f32 v156, 0, v156
    v_max_f32 v157, 0, v157
    v_max_f32 v158, 0, v158
    v_max_f32 v159, 0, v159
    v_max_f32 v172, 0, v172
    v_max_f32 v173, 0, v173
    v_max_f32 v174, 0, v174
    v_max_f32 v175, 0, v175
    v_max_f32 v188, 0, v188
    v_max_f32 v189, 0, v189
    v_max_f32 v190, 0, v190
    v_max_f32 v191, 0, v191
    v_max_f32 v204, 0, v204
    v_max_f32 v205, 0, v205
    v_max_f32 v206, 0, v206
    v_max_f32 v207, 0, v207
    v_max_f32 v212, 0, v212
    v_max_f32 v213, 0, v213
    v_max_f32 v214, 0, v214
    v_max_f32 v215, 0, v215
    v_pk_mul_f32 v[108:109], v[108:109], v[108:109]
    v_pk_mul_f32 v[110:111], v[110:111], v[110:111]
    v_pk_mul_f32 v[124:125], v[124:125], v[124:125]
    v_pk_mul_f32 v[126:127], v[126:127], v[126:127]
    v_pk_mul_f32 v[140:141], v[140:141], v[140:141]
    v_pk_mul_f32 v[142:143], v[142:143], v[142:143]
    v_pk_mul_f32 v[156:157], v[156:157], v[156:157]
    v_pk_mul_f32 v[158:159], v[158:159], v[158:159]
    v_pk_mul_f32 v[172:173], v[172:173], v[172:173]
    v_pk_mul_f32 v[174:175], v[174:175], v[174:175]
    v_pk_mul_f32 v[188:189], v[188:189], v[188:189]
    v_pk_mul_f32 v[190:191], v[190:191], v[190:191]
    v_pk_mul_f32 v[204:205], v[204:205], v[204:205]
    v_pk_mul_f32 v[206:207], v[206:207], v[206:207]
    v_pk_mul_f32 v[212:213], v[212:213], v[212:213]
    v_pk_mul_f32 v[214:215], v[214:215], v[214:215]
    v_cvt_pk_bf16_f32 v76, v108, v109
    v_cvt_pk_bf16_f32 v77, v110, v111
    v_cvt_pk_bf16_f32 v78, v124, v125
    v_cvt_pk_bf16_f32 v79, v126, v127
    v_cvt_pk_bf16_f32 v80, v140, v141
    v_cvt_pk_bf16_f32 v81, v142, v143
    v_cvt_pk_bf16_f32 v82, v156, v157
    v_cvt_pk_bf16_f32 v83, v158, v159
    v_cvt_pk_bf16_f32 v84, v172, v173
    v_cvt_pk_bf16_f32 v85, v174, v175
    v_cvt_pk_bf16_f32 v86, v188, v189
    v_cvt_pk_bf16_f32 v87, v190, v191
    v_cvt_pk_bf16_f32 v88, v204, v205
    v_cvt_pk_bf16_f32 v89, v206, v207
    v_cvt_pk_bf16_f32 v90, v212, v213
    v_cvt_pk_bf16_f32 v91, v214, v215
    ds_write_b128 v7, v[76:79] offset:0
    ds_write_b128 v7, v[80:83] offset:32768
    ds_write_b128 v9, v[84:87] offset:0
    s_add_u32 s63, s61, 0
    buffer_store_dwordx4 v[76:79], v4, s[24:27], s63 offen sc1
    s_add_u32 s63, s61, 16384
    buffer_store_dwordx4 v[80:83], v4, s[24:27], s63 offen sc1
    s_add_u32 s63, s61, 32768
    buffer_store_dwordx4 v[84:87], v4, s[24:27], s63 offen sc1
    buffer_store_dwordx4 v[88:91], v4, s[24:27], s62 offen sc1
    s_add_u32 s62, s62, 2048
    s_add_u32 s61, s61, 2048
    v_pk_fma_f32 v[228:229], v[12:13], v[222:223], v[44:45] op_sel:[0,1,0] op_sel_hi:[1,1,1]
    v_pk_fma_f32 v[230:231], v[14:15], v[222:223], v[46:47] op_sel:[0,1,0] op_sel_hi:[1,1,1]
    v_pk_fma_f32 v[232:233], v[16:17], v[222:223], v[48:49] op_sel:[0,1,0] op_sel_hi:[1,1,1]
    v_pk_fma_f32 v[234:235], v[18:19], v[222:223], v[50:51] op_sel:[0,1,0] op_sel_hi:[1,1,1]
    v_pk_fma_f32 v[236:237], v[20:21], v[222:223], v[52:53] op_sel:[0,1,0] op_sel_hi:[1,1,1]
    v_pk_fma_f32 v[238:239], v[22:23], v[222:223], v[54:55] op_sel:[0,1,0] op_sel_hi:[1,1,1]
    v_pk_fma_f32 v[240:241], v[24:25], v[222:223], v[56:57] op_sel:[0,1,0] op_sel_hi:[1,1,1]
    v_pk_fma_f32 v[242:243], v[26:27], v[222:223], v[58:59] op_sel:[0,1,0] op_sel_hi:[1,1,1]
    v_pk_fma_f32 v[112:113], v[112:113], v[222:223], v[228:229] op_sel_hi:[1,0,1]
    v_pk_fma_f32 v[114:115], v[114:115], v[222:223], v[230:231] op_sel_hi:[1,0,1]
    v_pk_fma_f32 v[128:129], v[128:129], v[222:223], v[232:233] op_sel_hi:[1,0,1]
    v_pk_fma_f32 v[130:131], v[130:131], v[222:223], v[234:235] op_sel_hi:[1,0,1]
    v_pk_fma_f32 v[144:145], v[144:145], v[222:223], v[236:237] op_sel_hi:[1,0,1]
    v_pk_fma_f32 v[146:147], v[146:147], v[222:223], v[238:239] op_sel_hi:[1,0,1]
    v_pk_fma_f32 v[160:161], v[160:161], v[222:223], v[240:241] op_sel_hi:[1,0,1]
    v_pk_fma_f32 v[162:163], v[162:163], v[222:223], v[242:243] op_sel_hi:[1,0,1]
    v_pk_fma_f32 v[228:229], v[28:29], v[222:223], v[60:61] op_sel:[0,1,0] op_sel_hi:[1,1,1]
    v_pk_fma_f32 v[230:231], v[30:31], v[222:223], v[62:63] op_sel:[0,1,0] op_sel_hi:[1,1,1]
    v_pk_fma_f32 v[232:233], v[32:33], v[222:223], v[64:65] op_sel:[0,1,0] op_sel_hi:[1,1,1]
    v_pk_fma_f32 v[234:235], v[34:35], v[222:223], v[66:67] op_sel:[0,1,0] op_sel_hi:[1,1,1]
    v_pk_fma_f32 v[236:237], v[36:37], v[222:223], v[68:69] op_sel:[0,1,0] op_sel_hi:[1,1,1]
    v_pk_fma_f32 v[238:239], v[38:39], v[222:223], v[70:71] op_sel:[0,1,0] op_sel_hi:[1,1,1]
    v_pk_fma_f32 v[240:241], v[40:41], v[222:223], v[72:73] op_sel:[0,1,0] op_sel_hi:[1,1,1]
    v_pk_fma_f32 v[242:243], v[42:43], v[222:223], v[74:75] op_sel:[0,1,0] op_sel_hi:[1,1,1]
    v_pk_fma_f32 v[176:177], v[176:177], v[222:223], v[228:229] op_sel_hi:[1,0,1]
    v_pk_fma_f32 v[178:179], v[178:179], v[222:223], v[230:231] op_sel_hi:[1,0,1]
    v_pk_fma_f32 v[192:193], v[192:193], v[222:223], v[232:233] op_sel_hi:[1,0,1]
    v_pk_fma_f32 v[194:195], v[194:195], v[222:223], v[234:235] op_sel_hi:[1,0,1]
    v_pk_fma_f32 v[208:209], v[208:209], v[222:223], v[236:237] op_sel_hi:[1,0,1]
    v_pk_fma_f32 v[210:211], v[210:211], v[222:223], v[238:239] op_sel_hi:[1,0,1]
    v_pk_fma_f32 v[216:217], v[216:217], v[222:223], v[240:241] op_sel_hi:[1,0,1]
    v_pk_fma_f32 v[218:219], v[218:219], v[222:223], v[242:243] op_sel_hi:[1,0,1]
    v_max_f32 v112, 0, v112
    v_max_f32 v113, 0, v113
    v_max_f32 v114, 0, v114
    v_max_f32 v115, 0, v115
    v_max_f32 v128, 0, v128
    v_max_f32 v129, 0, v129
    v_max_f32 v130, 0, v130
    v_max_f32 v131, 0, v131
    v_max_f32 v144, 0, v144
    v_max_f32 v145, 0, v145
    v_max_f32 v146, 0, v146
    v_max_f32 v147, 0, v147
    v_max_f32 v160, 0, v160
    v_max_f32 v161, 0, v161
    v_max_f32 v162, 0, v162
    v_max_f32 v163, 0, v163
    v_max_f32 v176, 0, v176
    v_max_f32 v177, 0, v177
    v_max_f32 v178, 0, v178
    v_max_f32 v179, 0, v179
    v_max_f32 v192, 0, v192
    v_max_f32 v193, 0, v193
    v_max_f32 v194, 0, v194
    v_max_f32 v195, 0, v195
    v_max_f32 v208, 0, v208
    v_max_f32 v209, 0, v209
    v_max_f32 v210, 0, v210
    v_max_f32 v211, 0, v211
    v_max_f32 v216, 0, v216
    v_max_f32 v217, 0, v217
    v_max_f32 v218, 0, v218
    v_max_f32 v219, 0, v219
    v_pk_mul_f32 v[112:113], v[112:113], v[112:113]
    v_pk_mul_f32 v[114:115], v[114:115], v[114:115]
    v_pk_mul_f32 v[128:129], v[128:129], v[128:129]
    v_pk_mul_f32 v[130:131], v[130:131], v[130:131]
    v_pk_mul_f32 v[144:145], v[144:145], v[144:145]
    v_pk_mul_f32 v[146:147], v[146:147], v[146:147]
    v_pk_mul_f32 v[160:161], v[160:161], v[160:161]
    v_pk_mul_f32 v[162:163], v[162:163], v[162:163]
    v_pk_mul_f32 v[176:177], v[176:177], v[176:177]
    v_pk_mul_f32 v[178:179], v[178:179], v[178:179]
    v_pk_mul_f32 v[192:193], v[192:193], v[192:193]
    v_pk_mul_f32 v[194:195], v[194:195], v[194:195]
    v_pk_mul_f32 v[208:209], v[208:209], v[208:209]
    v_pk_mul_f32 v[210:211], v[210:211], v[210:211]
    v_pk_mul_f32 v[216:217], v[216:217], v[216:217]
    v_pk_mul_f32 v[218:219], v[218:219], v[218:219]
    v_cvt_pk_bf16_f32 v92, v112, v113
    v_cvt_pk_bf16_f32 v93, v114, v115
    v_cvt_pk_bf16_f32 v94, v128, v129
    v_cvt_pk_bf16_f32 v95, v130, v131
    v_cvt_pk_bf16_f32 v96, v144, v145
    v_cvt_pk_bf16_f32 v97, v146, v147
    v_cvt_pk_bf16_f32 v98, v160, v161
    v_cvt_pk_bf16_f32 v99, v162, v163
    v_cvt_pk_bf16_f32 v100, v176, v177
    v_cvt_pk_bf16_f32 v101, v178, v179
    v_cvt_pk_bf16_f32 v102, v192, v193
    v_cvt_pk_bf16_f32 v103, v194, v195
    v_cvt_pk_bf16_f32 v104, v208, v209
    v_cvt_pk_bf16_f32 v105, v210, v211
    v_cvt_pk_bf16_f32 v106, v216, v217
    v_cvt_pk_bf16_f32 v107, v218, v219
    ds_write_b128 v7, v[92:95] offset:2048
    ds_write_b128 v7, v[96:99] offset:34816
    ds_write_b128 v9, v[100:103] offset:2048
    s_add_u32 s63, s61, 0
    buffer_store_dwordx4 v[92:95], v4, s[24:27], s63 offen sc1
    s_add_u32 s63, s61, 16384
    buffer_store_dwordx4 v[96:99], v4, s[24:27], s63 offen sc1
    s_add_u32 s63, s61, 32768
    buffer_store_dwordx4 v[100:103], v4, s[24:27], s63 offen sc1
    buffer_store_dwordx4 v[104:107], v4, s[24:27], s62 offen sc1
    s_add_u32 s62, s62, 2048
    s_add_u32 s61, s61, 2048
    s_lshl_b32 s59, s59, 1
    s_sub_u32 s61, s61, s59
    v_pk_fma_f32 v[228:229], v[12:13], v[224:225], v[44:45] op_sel:[0,1,0] op_sel_hi:[1,1,1]
    v_pk_fma_f32 v[230:231], v[14:15], v[224:225], v[46:47] op_sel:[0,1,0] op_sel_hi:[1,1,1]
    v_pk_fma_f32 v[232:233], v[16:17], v[224:225], v[48:49] op_sel:[0,1,0] op_sel_hi:[1,1,1]
    v_pk_fma_f32 v[234:235], v[18:19], v[224:225], v[50:51] op_sel:[0,1,0] op_sel_hi:[1,1,1]
    v_pk_fma_f32 v[236:237], v[20:21], v[224:225], v[52:53] op_sel:[0,1,0] op_sel_hi:[1,1,1]
    v_pk_fma_f32 v[238:239], v[22:23], v[224:225], v[54:55] op_sel:[0,1,0] op_sel_hi:[1,1,1]
    v_pk_fma_f32 v[240:241], v[24:25], v[224:225], v[56:57] op_sel:[0,1,0] op_sel_hi:[1,1,1]
    v_pk_fma_f32 v[242:243], v[26:27], v[224:225], v[58:59] op_sel:[0,1,0] op_sel_hi:[1,1,1]
    v_pk_fma_f32 v[116:117], v[116:117], v[224:225], v[228:229] op_sel_hi:[1,0,1]
    v_pk_fma_f32 v[118:119], v[118:119], v[224:225], v[230:231] op_sel_hi:[1,0,1]
    v_pk_fma_f32 v[132:133], v[132:133], v[224:225], v[232:233] op_sel_hi:[1,0,1]
    v_pk_fma_f32 v[134:135], v[134:135], v[224:225], v[234:235] op_sel_hi:[1,0,1]
    v_pk_fma_f32 v[148:149], v[148:149], v[224:225], v[236:237] op_sel_hi:[1,0,1]
    v_pk_fma_f32 v[150:151], v[150:151], v[224:225], v[238:239] op_sel_hi:[1,0,1]
    v_pk_fma_f32 v[164:165], v[164:165], v[224:225], v[240:241] op_sel_hi:[1,0,1]
    v_pk_fma_f32 v[166:167], v[166:167], v[224:225], v[242:243] op_sel_hi:[1,0,1]
    v_pk_fma_f32 v[228:229], v[28:29], v[224:225], v[60:61] op_sel:[0,1,0] op_sel_hi:[1,1,1]
    v_pk_fma_f32 v[230:231], v[30:31], v[224:225], v[62:63] op_sel:[0,1,0] op_sel_hi:[1,1,1]
    v_pk_fma_f32 v[232:233], v[32:33], v[224:225], v[64:65] op_sel:[0,1,0] op_sel_hi:[1,1,1]
    v_pk_fma_f32 v[234:235], v[34:35], v[224:225], v[66:67] op_sel:[0,1,0] op_sel_hi:[1,1,1]
    v_pk_fma_f32 v[180:181], v[180:181], v[224:225], v[228:229] op_sel_hi:[1,0,1]
    v_pk_fma_f32 v[182:183], v[182:183], v[224:225], v[230:231] op_sel_hi:[1,0,1]
    v_pk_fma_f32 v[196:197], v[196:197], v[224:225], v[232:233] op_sel_hi:[1,0,1]
    v_pk_fma_f32 v[198:199], v[198:199], v[224:225], v[234:235] op_sel_hi:[1,0,1]
    v_max_f32 v116, 0, v116
    v_max_f32 v117, 0, v117
    v_max_f32 v118, 0, v118
    v_max_f32 v119, 0, v119
    v_max_f32 v132, 0, v132
    v_max_f32 v133, 0, v133
    v_max_f32 v134, 0, v134
    v_max_f32 v135, 0, v135
    v_max_f32 v148, 0, v148
    v_max_f32 v149, 0, v149
    v_max_f32 v150, 0, v150
    v_max_f32 v151, 0, v151
    v_max_f32 v164, 0, v164
    v_max_f32 v165, 0, v165
    v_max_f32 v166, 0, v166
    v_max_f32 v167, 0, v167
    v_max_f32 v180, 0, v180
    v_max_f32 v181, 0, v181
    v_max_f32 v182, 0, v182
    v_max_f32 v183, 0, v183
    v_max_f32 v196, 0, v196
    v_max_f32 v197, 0, v197
    v_max_f32 v198, 0, v198
    v_max_f32 v199, 0, v199
    v_pk_mul_f32 v[116:117], v[116:117], v[116:117]
    v_pk_mul_f32 v[118:119], v[118:119], v[118:119]
    v_pk_mul_f32 v[132:133], v[132:133], v[132:133]
    v_pk_mul_f32 v[134:135], v[134:135], v[134:135]
    v_pk_mul_f32 v[148:149], v[148:149], v[148:149]
    v_pk_mul_f32 v[150:151], v[150:151], v[150:151]
    v_pk_mul_f32 v[164:165], v[164:165], v[164:165]
    v_pk_mul_f32 v[166:167], v[166:167], v[166:167]
    v_pk_mul_f32 v[180:181], v[180:181], v[180:181]
    v_pk_mul_f32 v[182:183], v[182:183], v[182:183]
    v_pk_mul_f32 v[196:197], v[196:197], v[196:197]
    v_pk_mul_f32 v[198:199], v[198:199], v[198:199]
    v_cvt_pk_bf16_f32 v76, v116, v117
    v_cvt_pk_bf16_f32 v77, v118, v119
    v_cvt_pk_bf16_f32 v78, v132, v133
    v_cvt_pk_bf16_f32 v79, v134, v135
    v_cvt_pk_bf16_f32 v80, v148, v149
    v_cvt_pk_bf16_f32 v81, v150, v151
    v_cvt_pk_bf16_f32 v82, v164, v165
    v_cvt_pk_bf16_f32 v83, v166, v167
    v_cvt_pk_bf16_f32 v84, v180, v181
    v_cvt_pk_bf16_f32 v85, v182, v183
    v_cvt_pk_bf16_f32 v86, v196, v197
    v_cvt_pk_bf16_f32 v87, v198, v199
    ds_write_b128 v8, v[76:79] offset:4096
    ds_write_b128 v8, v[80:83] offset:36864
    ds_write_b128 v10, v[84:87] offset:4096
    s_add_u32 s63, s61, 0
    buffer_store_dwordx4 v[76:79], v4, s[24:27], s63 offen sc1
    s_add_u32 s63, s61, 16384
    buffer_store_dwordx4 v[80:83], v4, s[24:27], s63 offen sc1
    s_add_u32 s63, s61, 32768
    buffer_store_dwordx4 v[84:87], v4, s[24:27], s63 offen sc1
    s_add_u32 s61, s61, 2048
    v_pk_fma_f32 v[228:229], v[12:13], v[226:227], v[44:45] op_sel:[0,1,0] op_sel_hi:[1,1,1]
    v_pk_fma_f32 v[230:231], v[14:15], v[226:227], v[46:47] op_sel:[0,1,0] op_sel_hi:[1,1,1]
    v_pk_fma_f32 v[232:233], v[16:17], v[226:227], v[48:49] op_sel:[0,1,0] op_sel_hi:[1,1,1]
    v_pk_fma_f32 v[234:235], v[18:19], v[226:227], v[50:51] op_sel:[0,1,0] op_sel_hi:[1,1,1]
    v_pk_fma_f32 v[236:237], v[20:21], v[226:227], v[52:53] op_sel:[0,1,0] op_sel_hi:[1,1,1]
    v_pk_fma_f32 v[238:239], v[22:23], v[226:227], v[54:55] op_sel:[0,1,0] op_sel_hi:[1,1,1]
    v_pk_fma_f32 v[240:241], v[24:25], v[226:227], v[56:57] op_sel:[0,1,0] op_sel_hi:[1,1,1]
    v_pk_fma_f32 v[242:243], v[26:27], v[226:227], v[58:59] op_sel:[0,1,0] op_sel_hi:[1,1,1]
    v_pk_fma_f32 v[120:121], v[120:121], v[226:227], v[228:229] op_sel_hi:[1,0,1]
    v_pk_fma_f32 v[122:123], v[122:123], v[226:227], v[230:231] op_sel_hi:[1,0,1]
    v_pk_fma_f32 v[136:137], v[136:137], v[226:227], v[232:233] op_sel_hi:[1,0,1]
    v_pk_fma_f32 v[138:139], v[138:139], v[226:227], v[234:235] op_sel_hi:[1,0,1]
    v_pk_fma_f32 v[152:153], v[152:153], v[226:227], v[236:237] op_sel_hi:[1,0,1]
    v_pk_fma_f32 v[154:155], v[154:155], v[226:227], v[238:239] op_sel_hi:[1,0,1]
    v_pk_fma_f32 v[168:169], v[168:169], v[226:227], v[240:241] op_sel_hi:[1,0,1]
    v_pk_fma_f32 v[170:171], v[170:171], v[226:227], v[242:243] op_sel_hi:[1,0,1]
    v_pk_fma_f32 v[228:229], v[28:29], v[226:227], v[60:61] op_sel:[0,1,0] op_sel_hi:[1,1,1]
    v_pk_fma_f32 v[230:231], v[30:31], v[226:227], v[62:63] op_sel:[0,1,0] op_sel_hi:[1,1,1]
    v_pk_fma_f32 v[232:233], v[32:33], v[226:227], v[64:65] op_sel:[0,1,0] op_sel_hi:[1,1,1]
    v_pk_fma_f32 v[234:235], v[34:35], v[226:227], v[66:67] op_sel:[0,1,0] op_sel_hi:[1,1,1]
    v_pk_fma_f32 v[184:185], v[184:185], v[226:227], v[228:229] op_sel_hi:[1,0,1]
    v_pk_fma_f32 v[186:187], v[186:187], v[226:227], v[230:231] op_sel_hi:[1,0,1]
    v_pk_fma_f32 v[200:201], v[200:201], v[226:227], v[232:233] op_sel_hi:[1,0,1]
    v_pk_fma_f32 v[202:203], v[202:203], v[226:227], v[234:235] op_sel_hi:[1,0,1]
    v_max_f32 v120, 0, v120
    v_max_f32 v121, 0, v121
    v_max_f32 v122, 0, v122
    v_max_f32 v123, 0, v123
    v_max_f32 v136, 0, v136
    v_max_f32 v137, 0, v137
    v_max_f32 v138, 0, v138
    v_max_f32 v139, 0, v139
    v_max_f32 v152, 0, v152
    v_max_f32 v153, 0, v153
    v_max_f32 v154, 0, v154
    v_max_f32 v155, 0, v155
    v_max_f32 v168, 0, v168
    v_max_f32 v169, 0, v169
    v_max_f32 v170, 0, v170
    v_max_f32 v171, 0, v171
    v_max_f32 v184, 0, v184
    v_max_f32 v185, 0, v185
    v_max_f32 v186, 0, v186
    v_max_f32 v187, 0, v187
    v_max_f32 v200, 0, v200
    v_max_f32 v201, 0, v201
    v_max_f32 v202, 0, v202
    v_max_f32 v203, 0, v203
    v_pk_mul_f32 v[120:121], v[120:121], v[120:121]
    v_pk_mul_f32 v[122:123], v[122:123], v[122:123]
    v_pk_mul_f32 v[136:137], v[136:137], v[136:137]
    v_pk_mul_f32 v[138:139], v[138:139], v[138:139]
    v_pk_mul_f32 v[152:153], v[152:153], v[152:153]
    v_pk_mul_f32 v[154:155], v[154:155], v[154:155]
    v_pk_mul_f32 v[168:169], v[168:169], v[168:169]
    v_pk_mul_f32 v[170:171], v[170:171], v[170:171]
    v_pk_mul_f32 v[184:185], v[184:185], v[184:185]
    v_pk_mul_f32 v[186:187], v[186:187], v[186:187]
    v_pk_mul_f32 v[200:201], v[200:201], v[200:201]
    v_pk_mul_f32 v[202:203], v[202:203], v[202:203]
    v_cvt_pk_bf16_f32 v92, v120, v121
    v_cvt_pk_bf16_f32 v93, v122, v123
    v_cvt_pk_bf16_f32 v94, v136, v137
    v_cvt_pk_bf16_f32 v95, v138, v139
    v_cvt_pk_bf16_f32 v96, v152, v153
    v_cvt_pk_bf16_f32 v97, v154, v155
    v_cvt_pk_bf16_f32 v98, v168, v169
    v_cvt_pk_bf16_f32 v99, v170, v171
    v_cvt_pk_bf16_f32 v100, v184, v185
    v_cvt_pk_bf16_f32 v101, v186, v187
    v_cvt_pk_bf16_f32 v102, v200, v201
    v_cvt_pk_bf16_f32 v103, v202, v203
    ds_write_b128 v8, v[92:95] offset:6144
    ds_write_b128 v8, v[96:99] offset:38912
    ds_write_b128 v10, v[100:103] offset:6144
    s_add_u32 s63, s61, 0
    buffer_store_dwordx4 v[92:95], v4, s[24:27], s63 offen sc1
    s_add_u32 s63, s61, 16384
    buffer_store_dwordx4 v[96:99], v4, s[24:27], s63 offen sc1
    s_add_u32 s63, s61, 32768
    buffer_store_dwordx4 v[100:103], v4, s[24:27], s63 offen sc1
    s_add_u32 s61, s61, 2048
    s_waitcnt lgkmcnt(0)
    s_load_dwordx2 s[34:35], s[0:1], 88
    s_and_b32 s36, s2, 7
    s_lshr_b32 s37, s2, 3
    s_and_b32 s38, s36, 1
    s_lshr_b32 s36, s36, 1
    s_and_b32 s39, s37, 7
    s_lshr_b32 s37, s37, 3
    s_mul_i32 s38, s38, 8
    s_add_u32 s40, s38, s39
    s_mul_i32 s36, s36, 4
    s_add_u32 s41, s36, s37
    s_add_u32 s39, s39, s37
    s_and_b32 s39, s39, 3
    s_mul_i32 s43, s41, 0
    s_mov_b32 s38, s41
    s_and_b32 s36, s38, 7
    s_lshl_b32 s36, s36, 1
    s_lshr_b32 s37, s38, 3
    s_add_u32 s41, s36, s37
    s_lshl_b32 s43, s41, 7
    s_waitcnt lgkmcnt(0)
    s_mov_b32 s28, s34
    s_mov_b32 s29, s35
    s_mov_b32 s30, 4194304
    s_mov_b32 s31, 0x20000
    s_add_u32 s24, s6, 16777216
    s_addc_u32 s25, s7, 0
    s_mov_b32 s26, 8388608
    s_mov_b32 s27, 0x20000
    s_lshr_b32 s52, s42, 1
    s_and_b32 s53, s42, 1
    s_mul_i32 s54, s52, 8192
    v_lshl_add_u32 v4, v1, 4, s54
    v_lshrrev_b32 v2, 2, v1
    v_bfe_u32 v3, v1, 3, 2
    s_lshl_b32 s54, s53, 1
    v_xor_b32 v6, s54, v3
    v_lshlrev_b32 v6, 5, v6
    v_lshl_add_u32 v6, v2, 7, v6
    v_and_b32 v3, 3, v1
    v_lshlrev_b32 v3, 3, v3
    v_add_u32 v3, 16384, v3
    v_add_u32 v6, v6, v3
    v_xor_b32 v7, 32, v6
    v_and_b32 v2, 15, v1
    v_lshlrev_b32 v2, 4, v2
    v_lshrrev_b32 v3, 5, v1
    v_lshl_add_u32 v2, v3, 8, v2
    v_bfe_u32 v3, v1, 4, 1
    v_lshl_add_u32 v2, v3, 3, v2
    s_lshl_b32 s61, s52, 13
    s_lshl_b32 s60, s53, 10
    s_add_u32 s61, s61, s60
    s_add_u32 s61, s61, 147456
    v_add_u32 v172, s61, v2
    v_add_u32 v173, 512, v172
    s_mov_b32 s47, 1
    v_add_u32 v4, 32768, v4
    v_add_u32 v6, 32768, v6
    v_add_u32 v7, 32768, v7
    s_mov_b32 s55, 32768
    s_barrier
    s_lshl_b32 s60, s53, 7
    s_add_u32 s61, s60, 131072
    v_lshrrev_b32 v3, 4, v1
    v_lshl_add_u32 v3, v3, 4, s61
    ds_read_b128 v[156:159], v3 offset:0
    ds_read_b128 v[160:163], v3 offset:64
    ds_read_b128 v[164:167], v3 offset:256
    ds_read_b128 v[168:171], v3 offset:320
    ds_read_b64_tr_b16 v[28:29], v6 offset:0
    ds_read_b64_tr_b16 v[30:31], v6 offset:2048
    ds_read_b128 v[12:15], v4 offset:0
    ds_read_b128 v[16:19], v4 offset:2048
    ds_read_b128 v[20:23], v4 offset:4096
    ds_read_b128 v[24:27], v4 offset:6144
    ds_read_b64_tr_b16 v[32:33], v7 offset:0
    ds_read_b64_tr_b16 v[34:35], v7 offset:2048
    ds_read_b64_tr_b16 v[36:37], v6 offset:8192
    ds_read_b64_tr_b16 v[38:39], v6 offset:10240
    ds_read_b64_tr_b16 v[40:41], v7 offset:8192
    ds_read_b64_tr_b16 v[42:43], v7 offset:10240
    s_waitcnt lgkmcnt(0)
    v_mfma_f32_16x16x32_bf16 v[76:79], v[28:31], v[12:15], 0
    ds_read_b64_tr_b16 v[60:61], v6 offset:4096
    v_mfma_f32_16x16x32_bf16 v[80:83], v[28:31], v[16:19], 0
    ds_read_b64_tr_b16 v[62:63], v6 offset:6144
    v_mfma_f32_16x16x32_bf16 v[84:87], v[28:31], v[20:23], 0
    ds_read_b128 v[44:47], v4 offset:1024
    v_mfma_f32_16x16x32_bf16 v[88:91], v[28:31], v[24:27], 0
    ds_read_b128 v[48:51], v4 offset:3072
    v_mfma_f32_16x16x32_bf16 v[92:95], v[32:35], v[12:15], 0
    ds_read_b128 v[52:55], v4 offset:5120
    v_mfma_f32_16x16x32_bf16 v[96:99], v[32:35], v[16:19], 0
    ds_read_b128 v[56:59], v4 offset:7168
    v_mfma_f32_16x16x32_bf16 v[100:103], v[32:35], v[20:23], 0
    ds_read_b64_tr_b16 v[64:65], v7 offset:4096
    v_mfma_f32_16x16x32_bf16 v[104:107], v[32:35], v[24:27], 0
    ds_read_b64_tr_b16 v[66:67], v7 offset:6144
    v_mfma_f32_16x16x32_bf16 v[108:111], v[36:39], v[12:15], 0
    ds_read_b64_tr_b16 v[68:69], v6 offset:12288
    v_mfma_f32_16x16x32_bf16 v[112:115], v[36:39], v[16:19], 0
    ds_read_b64_tr_b16 v[70:71], v6 offset:14336
    v_mfma_f32_16x16x32_bf16 v[116:119], v[36:39], v[20:23], 0
    ds_read_b64_tr_b16 v[72:73], v7 offset:12288
    v_mfma_f32_16x16x32_bf16 v[120:123], v[36:39], v[24:27], 0
    ds_read_b64_tr_b16 v[74:75], v7 offset:14336
    v_mfma_f32_16x16x32_bf16 v[124:127], v[40:43], v[12:15], 0
    s_add_u32 s47, s47, 1
    s_cmp_eq_u32 s47, 4
    v_mfma_f32_16x16x32_bf16 v[128:131], v[40:43], v[16:19], 0
    s_cselect_b32 s47, 0, s47
    s_cselect_b32 s54, -98304, s55
    v_mfma_f32_16x16x32_bf16 v[132:135], v[40:43], v[20:23], 0
    v_add_u32 v4, s54, v4
    v_mfma_f32_16x16x32_bf16 v[136:139], v[40:43], v[24:27], 0
    v_add_u32 v6, s54, v6
    v_add_u32 v7, s54, v7
    s_waitcnt lgkmcnt(0)
    v_mfma_f32_16x16x32_bf16 v[76:79], v[60:63], v[44:47], v[76:79]
    v_mfma_f32_16x16x32_bf16 v[80:83], v[60:63], v[48:51], v[80:83]
    s_waitcnt vmcnt(0)
    s_barrier
    v_mfma_f32_16x16x32_bf16 v[84:87], v[60:63], v[52:55], v[84:87]
    ds_read_b64_tr_b16 v[28:29], v6 offset:0
    v_mfma_f32_16x16x32_bf16 v[88:91], v[60:63], v[56:59], v[88:91]
    ds_read_b64_tr_b16 v[30:31], v6 offset:2048
    v_mfma_f32_16x16x32_bf16 v[92:95], v[64:67], v[44:47], v[92:95]
    ds_read_b128 v[12:15], v4 offset:0
    v_mfma_f32_16x16x32_bf16 v[96:99], v[64:67], v[48:51], v[96:99]
    ds_read_b128 v[16:19], v4 offset:2048
    v_mfma_f32_16x16x32_bf16 v[100:103], v[64:67], v[52:55], v[100:103]
    ds_read_b128 v[20:23], v4 offset:4096
    v_mfma_f32_16x16x32_bf16 v[104:107], v[64:67], v[56:59], v[104:107]
    ds_read_b128 v[24:27], v4 offset:6144
    v_mfma_f32_16x16x32_bf16 v[108:111], v[68:71], v[44:47], v[108:111]
    ds_read_b64_tr_b16 v[32:33], v7 offset:0
    v_mfma_f32_16x16x32_bf16 v[112:115], v[68:71], v[48:51], v[112:115]
    ds_read_b64_tr_b16 v[34:35], v7 offset:2048
    v_mfma_f32_16x16x32_bf16 v[116:119], v[68:71], v[52:55], v[116:119]
    ds_read_b64_tr_b16 v[36:37], v6 offset:8192
    v_mfma_f32_16x16x32_bf16 v[120:123], v[68:71], v[56:59], v[120:123]
    ds_read_b64_tr_b16 v[38:39], v6 offset:10240
    v_mfma_f32_16x16x32_bf16 v[124:127], v[72:75], v[44:47], v[124:127]
    ds_read_b64_tr_b16 v[40:41], v7 offset:8192
    v_mfma_f32_16x16x32_bf16 v[128:131], v[72:75], v[48:51], v[128:131]
    ds_read_b64_tr_b16 v[42:43], v7 offset:10240
    v_mfma_f32_16x16x32_bf16 v[132:135], v[72:75], v[52:55], v[132:135]
    v_mfma_f32_16x16x32_bf16 v[136:139], v[72:75], v[56:59], v[136:139]
    s_mov_b32 s51, 23
    .p2align 3
w2_cloop:
    s_waitcnt lgkmcnt(0)
    v_mfma_f32_16x16x32_bf16 v[76:79], v[28:31], v[12:15], v[76:79]
    ds_read_b64_tr_b16 v[60:61], v6 offset:4096
    v_mfma_f32_16x16x32_bf16 v[80:83], v[28:31], v[16:19], v[80:83]
    ds_read_b64_tr_b16 v[62:63], v6 offset:6144
    v_mfma_f32_16x16x32_bf16 v[84:87], v[28:31], v[20:23], v[84:87]
    ds_read_b128 v[44:47], v4 offset:1024
    v_mfma_f32_16x16x32_bf16 v[88:91], v[28:31], v[24:27], v[88:91]
    ds_read_b128 v[48:51], v4 offset:3072
    v_mfma_f32_16x16x32_bf16 v[92:95], v[32:35], v[12:15], v[92:95]
    ds_read_b128 v[52:55], v4 offset:5120
    v_mfma_f32_16x16x32_bf16 v[96:99], v[32:35], v[16:19], v[96:99]
    ds_read_b128 v[56:59], v4 offset:7168
    v_mfma_f32_16x16x32_bf16 v[100:103], v[32:35], v[20:23], v[100:103]
    ds_read_b64_tr_b16 v[64:65], v7 offset:4096
    v_mfma_f32_16x16x32_bf16 v[104:107], v[32:35], v[24:27], v[104:107]
    ds_read_b64_tr_b16 v[66:67], v7 offset:6144
    v_mfma_f32_16x16x32_bf16 v[108:111], v[36:39], v[12:15], v[108:111]
    ds_read_b64_tr_b16 v[68:69], v6 offset:12288
    v_mfma_f32_16x16x32_bf16 v[112:115], v[36:39], v[16:19], v[112:115]
    ds_read_b64_tr_b16 v[70:71], v6 offset:14336
    v_mfma_f32_16x16x32_bf16 v[116:119], v[36:39], v[20:23], v[116:119]
    ds_read_b64_tr_b16 v[72:73], v7 offset:12288
    v_mfma_f32_16x16x32_bf16 v[120:123], v[36:39], v[24:27], v[120:123]
    ds_read_b64_tr_b16 v[74:75], v7 offset:14336
    v_mfma_f32_16x16x32_bf16 v[124:127], v[40:43], v[12:15], v[124:127]
    s_add_u32 s47, s47, 1
    s_cmp_eq_u32 s47, 4
    v_mfma_f32_16x16x32_bf16 v[128:131], v[40:43], v[16:19], v[128:131]
    s_cselect_b32 s47, 0, s47
    s_cselect_b32 s54, -98304, s55
    v_mfma_f32_16x16x32_bf16 v[132:135], v[40:43], v[20:23], v[132:135]
    v_add_u32 v4, s54, v4
    v_mfma_f32_16x16x32_bf16 v[136:139], v[40:43], v[24:27], v[136:139]
    v_add_u32 v6, s54, v6
    v_add_u32 v7, s54, v7
    s_waitcnt lgkmcnt(0)
    v_mfma_f32_16x16x32_bf16 v[76:79], v[60:63], v[44:47], v[76:79]
    v_mfma_f32_16x16x32_bf16 v[80:83], v[60:63], v[48:51], v[80:83]
    s_barrier
    v_mfma_f32_16x16x32_bf16 v[84:87], v[60:63], v[52:55], v[84:87]
    ds_read_b64_tr_b16 v[28:29], v6 offset:0
    v_mfma_f32_16x16x32_bf16 v[88:91], v[60:63], v[56:59], v[88:91]
    ds_read_b64_tr_b16 v[30:31], v6 offset:2048
    v_mfma_f32_16x16x32_bf16 v[92:95], v[64:67], v[44:47], v[92:95]
    ds_read_b128 v[12:15], v4 offset:0
    v_mfma_f32_16x16x32_bf16 v[96:99], v[64:67], v[48:51], v[96:99]
    ds_read_b128 v[16:19], v4 offset:2048
    v_mfma_f32_16x16x32_bf16 v[100:103], v[64:67], v[52:55], v[100:103]
    ds_read_b128 v[20:23], v4 offset:4096
    v_mfma_f32_16x16x32_bf16 v[104:107], v[64:67], v[56:59], v[104:107]
    ds_read_b128 v[24:27], v4 offset:6144
    v_mfma_f32_16x16x32_bf16 v[108:111], v[68:71], v[44:47], v[108:111]
    ds_read_b64_tr_b16 v[32:33], v7 offset:0
    v_mfma_f32_16x16x32_bf16 v[112:115], v[68:71], v[48:51], v[112:115]
    ds_read_b64_tr_b16 v[34:35], v7 offset:2048
    v_mfma_f32_16x16x32_bf16 v[116:119], v[68:71], v[52:55], v[116:119]
    ds_read_b64_tr_b16 v[36:37], v6 offset:8192
    v_mfma_f32_16x16x32_bf16 v[120:123], v[68:71], v[56:59], v[120:123]
    ds_read_b64_tr_b16 v[38:39], v6 offset:10240
    v_mfma_f32_16x16x32_bf16 v[124:127], v[72:75], v[44:47], v[124:127]
    ds_read_b64_tr_b16 v[40:41], v7 offset:8192
    v_mfma_f32_16x16x32_bf16 v[128:131], v[72:75], v[48:51], v[128:131]
    ds_read_b64_tr_b16 v[42:43], v7 offset:10240
    v_mfma_f32_16x16x32_bf16 v[132:135], v[72:75], v[52:55], v[132:135]
    v_mfma_f32_16x16x32_bf16 v[136:139], v[72:75], v[56:59], v[136:139]
    s_sub_u32 s51, s51, 1
    s_cmp_lg_u32 s51, 0
    s_cbranch_scc1 w2_cloop
    s_waitcnt lgkmcnt(0)
    v_mfma_f32_16x16x32_bf16 v[76:79], v[28:31], v[12:15], v[76:79]
    ds_read_b64_tr_b16 v[60:61], v6 offset:4096
    v_mfma_f32_16x16x32_bf16 v[80:83], v[28:31], v[16:19], v[80:83]
    ds_read_b64_tr_b16 v[62:63], v6 offset:6144
    v_mfma_f32_16x16x32_bf16 v[84:87], v[28:31], v[20:23], v[84:87]
    ds_read_b128 v[44:47], v4 offset:1024
    v_mfma_f32_16x16x32_bf16 v[88:91], v[28:31], v[24:27], v[88:91]
    ds_read_b128 v[48:51], v4 offset:3072
    v_mfma_f32_16x16x32_bf16 v[92:95], v[32:35], v[12:15], v[92:95]
    ds_read_b128 v[52:55], v4 offset:5120
    v_mfma_f32_16x16x32_bf16 v[96:99], v[32:35], v[16:19], v[96:99]
    ds_read_b128 v[56:59], v4 offset:7168
    v_mfma_f32_16x16x32_bf16 v[100:103], v[32:35], v[20:23], v[100:103]
    ds_read_b64_tr_b16 v[64:65], v7 offset:4096
    v_mfma_f32_16x16x32_bf16 v[104:107], v[32:35], v[24:27], v[104:107]
    ds_read_b64_tr_b16 v[66:67], v7 offset:6144
    v_mfma_f32_16x16x32_bf16 v[108:111], v[36:39], v[12:15], v[108:111]
    ds_read_b64_tr_b16 v[68:69], v6 offset:12288
    v_mfma_f32_16x16x32_bf16 v[112:115], v[36:39], v[16:19], v[112:115]
    ds_read_b64_tr_b16 v[70:71], v6 offset:14336
    v_mfma_f32_16x16x32_bf16 v[116:119], v[36:39], v[20:23], v[116:119]
    ds_read_b64_tr_b16 v[72:73], v7 offset:12288
    v_mfma_f32_16x16x32_bf16 v[120:123], v[36:39], v[24:27], v[120:123]
    ds_read_b64_tr_b16 v[74:75], v7 offset:14336
    v_mfma_f32_16x16x32_bf16 v[124:127], v[40:43], v[12:15], v[124:127]
    s_add_u32 s47, s47, 1
    s_cmp_eq_u32 s47, 4
    v_mfma_f32_16x16x32_bf16 v[128:131], v[40:43], v[16:19], v[128:131]
    s_cselect_b32 s47, 0, s47
    s_cselect_b32 s54, -98304, s55
    v_mfma_f32_16x16x32_bf16 v[132:135], v[40:43], v[20:23], v[132:135]
    v_add_u32 v4, s54, v4
    v_mfma_f32_16x16x32_bf16 v[136:139], v[40:43], v[24:27], v[136:139]
    v_add_u32 v6, s54, v6
    v_add_u32 v7, s54, v7
    s_waitcnt lgkmcnt(0)
    v_mfma_f32_16x16x32_bf16 v[76:79], v[60:63], v[44:47], v[76:79]
    v_mfma_f32_16x16x32_bf16 v[80:83], v[60:63], v[48:51], v[80:83]
    s_barrier
    v_mfma_f32_16x16x32_bf16 v[84:87], v[60:63], v[52:55], v[84:87]
    ds_read_b64_tr_b16 v[28:29], v6 offset:0
    v_mfma_f32_16x16x32_bf16 v[88:91], v[60:63], v[56:59], v[88:91]
    ds_read_b64_tr_b16 v[30:31], v6 offset:2048
    v_mfma_f32_16x16x32_bf16 v[92:95], v[64:67], v[44:47], v[92:95]
    ds_read_b128 v[12:15], v4 offset:0
    v_mfma_f32_16x16x32_bf16 v[96:99], v[64:67], v[48:51], v[96:99]
    ds_read_b128 v[16:19], v4 offset:2048
    v_mfma_f32_16x16x32_bf16 v[100:103], v[64:67], v[52:55], v[100:103]
    ds_read_b128 v[20:23], v4 offset:4096
    v_mfma_f32_16x16x32_bf16 v[104:107], v[64:67], v[56:59], v[104:107]
    ds_read_b128 v[24:27], v4 offset:6144
    v_mfma_f32_16x16x32_bf16 v[108:111], v[68:71], v[44:47], v[108:111]
    ds_read_b64_tr_b16 v[32:33], v7 offset:0
    v_mfma_f32_16x16x32_bf16 v[112:115], v[68:71], v[48:51], v[112:115]
    ds_read_b64_tr_b16 v[34:35], v7 offset:2048
    v_mfma_f32_16x16x32_bf16 v[116:119], v[68:71], v[52:55], v[116:119]
    v_mfma_f32_16x16x32_bf16 v[120:123], v[68:71], v[56:59], v[120:123]
    v_mfma_f32_16x16x32_bf16 v[124:127], v[72:75], v[44:47], v[124:127]
    v_mfma_f32_16x16x32_bf16 v[128:131], v[72:75], v[48:51], v[128:131]
    v_mfma_f32_16x16x32_bf16 v[132:135], v[72:75], v[52:55], v[132:135]
    v_mfma_f32_16x16x32_bf16 v[136:139], v[72:75], v[56:59], v[136:139]
    s_lshl_b32 s60, s2, 2
    s_add_u32 s60, s60, s42
    s_lshl_b32 s60, s60, 13
    s_xor_b32 s62, s60, 131072
    s_add_u32 s61, s60, 4096
    s_add_u32 s63, s62, 4096
    v_lshlrev_b32 v2, 4, v1
    s_waitcnt lgkmcnt(0)
    v_mfma_f32_16x16x32_bf16 v[76:79], v[28:31], v[12:15], v[76:79]
    ds_read_b64_tr_b16 v[60:61], v6 offset:4096
    v_mfma_f32_16x16x32_bf16 v[80:83], v[28:31], v[16:19], v[80:83]
    ds_read_b64_tr_b16 v[62:63], v6 offset:6144
    v_mfma_f32_16x16x32_bf16 v[84:87], v[28:31], v[20:23], v[84:87]
    ds_read_b128 v[44:47], v4 offset:1024
    v_mfma_f32_16x16x32_bf16 v[88:91], v[28:31], v[24:27], v[88:91]
    ds_read_b128 v[48:51], v4 offset:3072
    v_mfma_f32_16x16x32_bf16 v[92:95], v[32:35], v[12:15], v[92:95]
    ds_read_b128 v[52:55], v4 offset:5120
    v_mfma_f32_16x16x32_bf16 v[96:99], v[32:35], v[16:19], v[96:99]
    ds_read_b128 v[56:59], v4 offset:7168
    v_mfma_f32_16x16x32_bf16 v[100:103], v[32:35], v[20:23], v[100:103]
    ds_read_b64_tr_b16 v[64:65], v7 offset:4096
    v_mfma_f32_16x16x32_bf16 v[104:107], v[32:35], v[24:27], v[104:107]
    ds_read_b64_tr_b16 v[66:67], v7 offset:6144
    v_cvt_pk_bf16_f32 v176, v108, v109
    v_cvt_pk_bf16_f32 v177, v110, v111
    v_cvt_pk_bf16_f32 v178, v124, v125
    v_cvt_pk_bf16_f32 v179, v126, v127
    buffer_store_dwordx4 v[176:179], v2, s[24:27], s60 offen offset:0 sc1
    s_add_u32 s47, s47, 1
    s_cmp_eq_u32 s47, 4
    s_cselect_b32 s47, 0, s47
    s_cselect_b32 s54, -98304, s55
    v_add_u32 v4, s54, v4
    v_add_u32 v6, s54, v6
    v_add_u32 v7, s54, v7
    s_waitcnt lgkmcnt(0)
    v_mfma_f32_16x16x32_bf16 v[76:79], v[60:63], v[44:47], v[76:79]
    v_mfma_f32_16x16x32_bf16 v[80:83], v[60:63], v[48:51], v[80:83]
    s_barrier
    v_mfma_f32_16x16x32_bf16 v[84:87], v[60:63], v[52:55], v[84:87]
    ds_read_b64_tr_b16 v[28:29], v6 offset:0
    v_mfma_f32_16x16x32_bf16 v[88:91], v[60:63], v[56:59], v[88:91]
    ds_read_b64_tr_b16 v[30:31], v6 offset:2048
    v_mfma_f32_16x16x32_bf16 v[92:95], v[64:67], v[44:47], v[92:95]
    ds_read_b128 v[12:15], v4 offset:0
    v_mfma_f32_16x16x32_bf16 v[96:99], v[64:67], v[48:51], v[96:99]
    ds_read_b128 v[16:19], v4 offset:2048
    v_mfma_f32_16x16x32_bf16 v[100:103], v[64:67], v[52:55], v[100:103]
    ds_read_b128 v[20:23], v4 offset:4096
    v_mfma_f32_16x16x32_bf16 v[104:107], v[64:67], v[56:59], v[104:107]
    ds_read_b128 v[24:27], v4 offset:6144
    ds_read_b64_tr_b16 v[32:33], v7 offset:0
    ds_read_b64_tr_b16 v[34:35], v7 offset:2048
    v_cvt_pk_bf16_f32 v180, v112, v113
    v_cvt_pk_bf16_f32 v181, v114, v115
    v_cvt_pk_bf16_f32 v182, v128, v129
    v_cvt_pk_bf16_f32 v183, v130, v131
    buffer_store_dwordx4 v[180:183], v2, s[24:27], s60 offen offset:1024 sc1
    s_waitcnt lgkmcnt(0)
    v_mfma_f32_16x16x32_bf16 v[76:79], v[28:31], v[12:15], v[76:79]
    ds_read_b64_tr_b16 v[60:61], v6 offset:4096
    v_mfma_f32_16x16x32_bf16 v[80:83], v[28:31], v[16:19], v[80:83]
    ds_read_b64_tr_b16 v[62:63], v6 offset:6144
    v_mfma_f32_16x16x32_bf16 v[84:87], v[28:31], v[20:23], v[84:87]
    ds_read_b128 v[44:47], v4 offset:1024
    v_mfma_f32_16x16x32_bf16 v[88:91], v[28:31], v[24:27], v[88:91]
    ds_read_b128 v[48:51], v4 offset:3072
    v_mfma_f32_16x16x32_bf16 v[92:95], v[32:35], v[12:15], v[92:95]
    ds_read_b128 v[52:55], v4 offset:5120
    v_mfma_f32_16x16x32_bf16 v[96:99], v[32:35], v[16:19], v[96:99]
    ds_read_b128 v[56:59], v4 offset:7168
    v_mfma_f32_16x16x32_bf16 v[100:103], v[32:35], v[20:23], v[100:103]
    ds_read_b64_tr_b16 v[64:65], v7 offset:4096
    v_mfma_f32_16x16x32_bf16 v[104:107], v[32:35], v[24:27], v[104:107]
    ds_read_b64_tr_b16 v[66:67], v7 offset:6144
    v_cvt_pk_bf16_f32 v184, v116, v117
    v_cvt_pk_bf16_f32 v185, v118, v119
    v_cvt_pk_bf16_f32 v186, v132, v133
    v_cvt_pk_bf16_f32 v187, v134, v135
    buffer_store_dwordx4 v[184:187], v2, s[24:27], s60 offen offset:2048 sc1
    s_add_u32 s47, s47, 1
    s_cmp_eq_u32 s47, 4
    s_cselect_b32 s47, 0, s47
    s_cselect_b32 s54, -98304, s55
    v_add_u32 v4, s54, v4
    v_add_u32 v6, s54, v6
    v_add_u32 v7, s54, v7
    s_waitcnt lgkmcnt(0)
    v_mfma_f32_16x16x32_bf16 v[76:79], v[60:63], v[44:47], v[76:79]
    v_mfma_f32_16x16x32_bf16 v[80:83], v[60:63], v[48:51], v[80:83]
    s_barrier
    v_mfma_f32_16x16x32_bf16 v[84:87], v[60:63], v[52:55], v[84:87]
    ds_read_b64_tr_b16 v[28:29], v6 offset:0
    v_mfma_f32_16x16x32_bf16 v[88:91], v[60:63], v[56:59], v[88:91]
    ds_read_b64_tr_b16 v[30:31], v6 offset:2048
    v_mfma_f32_16x16x32_bf16 v[92:95], v[64:67], v[44:47], v[92:95]
    ds_read_b128 v[12:15], v4 offset:0
    v_mfma_f32_16x16x32_bf16 v[96:99], v[64:67], v[48:51], v[96:99]
    ds_read_b128 v[16:19], v4 offset:2048
    v_mfma_f32_16x16x32_bf16 v[100:103], v[64:67], v[52:55], v[100:103]
    ds_read_b128 v[20:23], v4 offset:4096
    v_mfma_f32_16x16x32_bf16 v[104:107], v[64:67], v[56:59], v[104:107]
    ds_read_b128 v[24:27], v4 offset:6144
    ds_read_b64_tr_b16 v[32:33], v7 offset:0
    ds_read_b64_tr_b16 v[34:35], v7 offset:2048
    v_cvt_pk_bf16_f32 v188, v120, v121
    v_cvt_pk_bf16_f32 v189, v122, v123
    v_cvt_pk_bf16_f32 v190, v136, v137
    v_cvt_pk_bf16_f32 v191, v138, v139
    buffer_store_dwordx4 v[188:191], v2, s[24:27], s60 offen offset:3072 sc1
    s_waitcnt lgkmcnt(0)
    v_mfma_f32_16x16x32_bf16 v[76:79], v[28:31], v[12:15], v[76:79]
    ds_read_b64_tr_b16 v[60:61], v6 offset:4096
    v_mfma_f32_16x16x32_bf16 v[80:83], v[28:31], v[16:19], v[80:83]
    ds_read_b64_tr_b16 v[62:63], v6 offset:6144
    v_mfma_f32_16x16x32_bf16 v[84:87], v[28:31], v[20:23], v[84:87]
    ds_read_b128 v[44:47], v4 offset:1024
    v_mfma_f32_16x16x32_bf16 v[88:91], v[28:31], v[24:27], v[88:91]
    ds_read_b128 v[48:51], v4 offset:3072
    v_mfma_f32_16x16x32_bf16 v[92:95], v[32:35], v[12:15], v[92:95]
    ds_read_b128 v[52:55], v4 offset:5120
    v_mfma_f32_16x16x32_bf16 v[96:99], v[32:35], v[16:19], v[96:99]
    ds_read_b128 v[56:59], v4 offset:7168
    v_mfma_f32_16x16x32_bf16 v[100:103], v[32:35], v[20:23], v[100:103]
    ds_read_b64_tr_b16 v[64:65], v7 offset:4096
    v_mfma_f32_16x16x32_bf16 v[104:107], v[32:35], v[24:27], v[104:107]
    ds_read_b64_tr_b16 v[66:67], v7 offset:6144
    s_add_u32 s47, s47, 1
    s_cmp_eq_u32 s47, 4
    s_cselect_b32 s47, 0, s47
    s_cselect_b32 s54, -98304, s55
    v_add_u32 v4, s54, v4
    v_add_u32 v6, s54, v6
    v_add_u32 v7, s54, v7
    s_waitcnt lgkmcnt(0)
    v_mfma_f32_16x16x32_bf16 v[76:79], v[60:63], v[44:47], v[76:79]
    v_mfma_f32_16x16x32_bf16 v[80:83], v[60:63], v[48:51], v[80:83]
    s_waitcnt vmcnt(0)
    s_barrier
    v_mfma_f32_16x16x32_bf16 v[84:87], v[60:63], v[52:55], v[84:87]
    ds_read_b64_tr_b16 v[28:29], v6 offset:0
    v_mfma_f32_16x16x32_bf16 v[88:91], v[60:63], v[56:59], v[88:91]
    ds_read_b64_tr_b16 v[30:31], v6 offset:2048
    v_mfma_f32_16x16x32_bf16 v[92:95], v[64:67], v[44:47], v[92:95]
    ds_read_b128 v[12:15], v4 offset:0
    v_mfma_f32_16x16x32_bf16 v[96:99], v[64:67], v[48:51], v[96:99]
    ds_read_b128 v[16:19], v4 offset:2048
    v_mfma_f32_16x16x32_bf16 v[100:103], v[64:67], v[52:55], v[100:103]
    ds_read_b128 v[20:23], v4 offset:4096
    v_mfma_f32_16x16x32_bf16 v[104:107], v[64:67], v[56:59], v[104:107]
    ds_read_b128 v[24:27], v4 offset:6144
    ds_read_b64_tr_b16 v[32:33], v7 offset:0
    ds_read_b64_tr_b16 v[34:35], v7 offset:2048
    s_waitcnt lgkmcnt(0)
    v_mfma_f32_16x16x32_bf16 v[76:79], v[28:31], v[12:15], v[76:79]
    ds_read_b64_tr_b16 v[60:61], v6 offset:4096
    v_mfma_f32_16x16x32_bf16 v[80:83], v[28:31], v[16:19], v[80:83]
    ds_read_b64_tr_b16 v[62:63], v6 offset:6144
    v_mfma_f32_16x16x32_bf16 v[84:87], v[28:31], v[20:23], v[84:87]
    ds_read_b128 v[44:47], v4 offset:1024
    v_mfma_f32_16x16x32_bf16 v[88:91], v[28:31], v[24:27], v[88:91]
    ds_read_b128 v[48:51], v4 offset:3072
    v_mfma_f32_16x16x32_bf16 v[92:95], v[32:35], v[12:15], v[92:95]
    ds_read_b128 v[52:55], v4 offset:5120
    v_mfma_f32_16x16x32_bf16 v[96:99], v[32:35], v[16:19], v[96:99]
    ds_read_b128 v[56:59], v4 offset:7168
    v_mfma_f32_16x16x32_bf16 v[100:103], v[32:35], v[20:23], v[100:103]
    ds_read_b64_tr_b16 v[64:65], v7 offset:4096
    v_mfma_f32_16x16x32_bf16 v[104:107], v[32:35], v[24:27], v[104:107]
    ds_read_b64_tr_b16 v[66:67], v7 offset:6144
    s_add_u32 s47, s47, 1
    s_cmp_eq_u32 s47, 4
    s_cselect_b32 s47, 0, s47
    s_cselect_b32 s54, -98304, s55
    v_add_u32 v4, s54, v4
    v_add_u32 v6, s54, v6
    v_add_u32 v7, s54, v7
    s_waitcnt lgkmcnt(0)
    v_mfma_f32_16x16x32_bf16 v[76:79], v[60:63], v[44:47], v[76:79]
    v_mfma_f32_16x16x32_bf16 v[80:83], v[60:63], v[48:51], v[80:83]
    s_barrier
    v_mfma_f32_16x16x32_bf16 v[84:87], v[60:63], v[52:55], v[84:87]
    ds_read_b64_tr_b16 v[28:29], v6 offset:0
    v_mfma_f32_16x16x32_bf16 v[88:91], v[60:63], v[56:59], v[88:91]
    ds_read_b64_tr_b16 v[30:31], v6 offset:2048
    v_mfma_f32_16x16x32_bf16 v[92:95], v[64:67], v[44:47], v[92:95]
    ds_read_b128 v[12:15], v4 offset:0
    v_mfma_f32_16x16x32_bf16 v[96:99], v[64:67], v[48:51], v[96:99]
    ds_read_b128 v[16:19], v4 offset:2048
    v_mfma_f32_16x16x32_bf16 v[100:103], v[64:67], v[52:55], v[100:103]
    ds_read_b128 v[20:23], v4 offset:4096
    v_mfma_f32_16x16x32_bf16 v[104:107], v[64:67], v[56:59], v[104:107]
    ds_read_b128 v[24:27], v4 offset:6144
    ds_read_b64_tr_b16 v[32:33], v7 offset:0
    ds_read_b64_tr_b16 v[34:35], v7 offset:2048
    s_waitcnt lgkmcnt(0)
    v_mfma_f32_16x16x32_bf16 v[76:79], v[28:31], v[12:15], v[76:79]
    ds_read_b64_tr_b16 v[60:61], v6 offset:4096
    v_mfma_f32_16x16x32_bf16 v[80:83], v[28:31], v[16:19], v[80:83]
    ds_read_b64_tr_b16 v[62:63], v6 offset:6144
    v_mfma_f32_16x16x32_bf16 v[84:87], v[28:31], v[20:23], v[84:87]
    ds_read_b128 v[44:47], v4 offset:1024
    v_mfma_f32_16x16x32_bf16 v[88:91], v[28:31], v[24:27], v[88:91]
    ds_read_b128 v[48:51], v4 offset:3072
    v_mfma_f32_16x16x32_bf16 v[92:95], v[32:35], v[12:15], v[92:95]
    ds_read_b128 v[52:55], v4 offset:5120
    v_mfma_f32_16x16x32_bf16 v[96:99], v[32:35], v[16:19], v[96:99]
    ds_read_b128 v[56:59], v4 offset:7168
    v_mfma_f32_16x16x32_bf16 v[100:103], v[32:35], v[20:23], v[100:103]
    ds_read_b64_tr_b16 v[64:65], v7 offset:4096
    v_mfma_f32_16x16x32_bf16 v[104:107], v[32:35], v[24:27], v[104:107]
    ds_read_b64_tr_b16 v[66:67], v7 offset:6144
    s_add_u32 s47, s47, 1
    s_cmp_eq_u32 s47, 4
    s_cselect_b32 s47, 0, s47
    s_cselect_b32 s54, -98304, s55
    v_add_u32 v4, s54, v4
    v_add_u32 v6, s54, v6
    v_add_u32 v7, s54, v7
    s_waitcnt lgkmcnt(0)
    v_mfma_f32_16x16x32_bf16 v[76:79], v[60:63], v[44:47], v[76:79]
    v_mfma_f32_16x16x32_bf16 v[80:83], v[60:63], v[48:51], v[80:83]
    s_barrier
    v_mfma_f32_16x16x32_bf16 v[84:87], v[60:63], v[52:55], v[84:87]
    ds_read_b64_tr_b16 v[28:29], v6 offset:0
    v_mfma_f32_16x16x32_bf16 v[88:91], v[60:63], v[56:59], v[88:91]
    ds_read_b64_tr_b16 v[30:31], v6 offset:2048
    v_mfma_f32_16x16x32_bf16 v[92:95], v[64:67], v[44:47], v[92:95]
    ds_read_b128 v[12:15], v4 offset:0
    v_mfma_f32_16x16x32_bf16 v[96:99], v[64:67], v[48:51], v[96:99]
    ds_read_b128 v[16:19], v4 offset:2048
    v_mfma_f32_16x16x32_bf16 v[100:103], v[64:67], v[52:55], v[100:103]
    ds_read_b128 v[20:23], v4 offset:4096
    v_mfma_f32_16x16x32_bf16 v[104:107], v[64:67], v[56:59], v[104:107]
    ds_read_b128 v[24:27], v4 offset:6144
    ds_read_b64_tr_b16 v[32:33], v7 offset:0
    ds_read_b64_tr_b16 v[34:35], v7 offset:2048
    buffer_load_dwordx4 v[176:179], v2, s[24:27], s62 offen offset:0 sc1
    buffer_load_dwordx4 v[180:183], v2, s[24:27], s62 offen offset:1024 sc1
    s_waitcnt lgkmcnt(0)
    v_mfma_f32_16x16x32_bf16 v[76:79], v[28:31], v[12:15], v[76:79]
    ds_read_b64_tr_b16 v[60:61], v6 offset:4096
    v_mfma_f32_16x16x32_bf16 v[80:83], v[28:31], v[16:19], v[80:83]
    ds_read_b64_tr_b16 v[62:63], v6 offset:6144
    v_mfma_f32_16x16x32_bf16 v[84:87], v[28:31], v[20:23], v[84:87]
    ds_read_b128 v[44:47], v4 offset:1024
    v_mfma_f32_16x16x32_bf16 v[88:91], v[28:31], v[24:27], v[88:91]
    ds_read_b128 v[48:51], v4 offset:3072
    v_mfma_f32_16x16x32_bf16 v[92:95], v[32:35], v[12:15], v[92:95]
    ds_read_b128 v[52:55], v4 offset:5120
    v_mfma_f32_16x16x32_bf16 v[96:99], v[32:35], v[16:19], v[96:99]
    ds_read_b128 v[56:59], v4 offset:7168
    v_mfma_f32_16x16x32_bf16 v[100:103], v[32:35], v[20:23], v[100:103]
    ds_read_b64_tr_b16 v[64:65], v7 offset:4096
    v_mfma_f32_16x16x32_bf16 v[104:107], v[32:35], v[24:27], v[104:107]
    ds_read_b64_tr_b16 v[66:67], v7 offset:6144
    buffer_load_dwordx4 v[184:187], v2, s[24:27], s62 offen offset:2048 sc1
    buffer_load_dwordx4 v[188:191], v2, s[24:27], s62 offen offset:3072 sc1
    s_waitcnt lgkmcnt(0)
    v_mfma_f32_16x16x32_bf16 v[76:79], v[60:63], v[44:47], v[76:79]
    ds_read_b64 v[140:141], v172 offset:0
    v_mfma_f32_16x16x32_bf16 v[80:83], v[60:63], v[48:51], v[80:83]
    ds_read_b64 v[142:143], v173 offset:0
    v_mfma_f32_16x16x32_bf16 v[84:87], v[60:63], v[52:55], v[84:87]
    ds_read_b64 v[144:145], v172 offset:2048
    v_mfma_f32_16x16x32_bf16 v[88:91], v[60:63], v[56:59], v[88:91]
    ds_read_b64 v[146:147], v173 offset:2048
    v_mfma_f32_16x16x32_bf16 v[92:95], v[64:67], v[44:47], v[92:95]
    ds_read_b64 v[148:149], v172 offset:4096
    v_mfma_f32_16x16x32_bf16 v[96:99], v[64:67], v[48:51], v[96:99]
    ds_read_b64 v[150:151], v173 offset:4096
    v_mfma_f32_16x16x32_bf16 v[100:103], v[64:67], v[52:55], v[100:103]
    ds_read_b64 v[152:153], v172 offset:6144
    v_mfma_f32_16x16x32_bf16 v[104:107], v[64:67], v[56:59], v[104:107]
    ds_read_b64 v[154:155], v173 offset:6144
    s_waitcnt lgkmcnt(0)
    v_lshlrev_b32 v12, 16, v140
    v_and_b32 v13, 0xffff0000, v140
    v_lshlrev_b32 v14, 16, v141
    v_and_b32 v15, 0xffff0000, v141
    v_pk_add_f32 v[12:13], v[12:13], v[164:165]
    v_pk_add_f32 v[14:15], v[14:15], v[166:167]
    v_pk_fma_f32 v[12:13], v[76:77], v[156:157], v[12:13]
    v_pk_fma_f32 v[14:15], v[78:79], v[158:159], v[14:15]
    v_lshlrev_b32 v16, 16, v142
    v_and_b32 v17, 0xffff0000, v142
    v_lshlrev_b32 v18, 16, v143
    v_and_b32 v19, 0xffff0000, v143
    v_pk_add_f32 v[16:17], v[16:17], v[168:169]
    v_pk_add_f32 v[18:19], v[18:19], v[170:171]
    v_pk_fma_f32 v[16:17], v[92:93], v[160:161], v[16:17]
    v_pk_fma_f32 v[18:19], v[94:95], v[162:163], v[18:19]
    v_lshlrev_b32 v20, 16, v144
    v_and_b32 v21, 0xffff0000, v144
    v_lshlrev_b32 v22, 16, v145
    v_and_b32 v23, 0xffff0000, v145
    v_pk_add_f32 v[20:21], v[20:21], v[164:165]
    v_pk_add_f32 v[22:23], v[22:23], v[166:167]
    v_pk_fma_f32 v[20:21], v[80:81], v[156:157], v[20:21]
    v_pk_fma_f32 v[22:23], v[82:83], v[158:159], v[22:23]
    v_lshlrev_b32 v24, 16, v146
    v_and_b32 v25, 0xffff0000, v146
    v_lshlrev_b32 v26, 16, v147
    v_and_b32 v27, 0xffff0000, v147
    v_pk_add_f32 v[24:25], v[24:25], v[168:169]
    v_pk_add_f32 v[26:27], v[26:27], v[170:171]
    v_pk_fma_f32 v[24:25], v[96:97], v[160:161], v[24:25]
    v_pk_fma_f32 v[26:27], v[98:99], v[162:163], v[26:27]
    v_lshlrev_b32 v28, 16, v148
    v_and_b32 v29, 0xffff0000, v148
    v_lshlrev_b32 v30, 16, v149
    v_and_b32 v31, 0xffff0000, v149
    v_pk_add_f32 v[28:29], v[28:29], v[164:165]
    v_pk_add_f32 v[30:31], v[30:31], v[166:167]
    v_pk_fma_f32 v[28:29], v[84:85], v[156:157], v[28:29]
    v_pk_fma_f32 v[30:31], v[86:87], v[158:159], v[30:31]
    v_lshlrev_b32 v32, 16, v150
    v_and_b32 v33, 0xffff0000, v150
    v_lshlrev_b32 v34, 16, v151
    v_and_b32 v35, 0xffff0000, v151
    v_pk_add_f32 v[32:33], v[32:33], v[168:169]
    v_pk_add_f32 v[34:35], v[34:35], v[170:171]
    v_pk_fma_f32 v[32:33], v[100:101], v[160:161], v[32:33]
    v_pk_fma_f32 v[34:35], v[102:103], v[162:163], v[34:35]
    v_lshlrev_b32 v36, 16, v152
    v_and_b32 v37, 0xffff0000, v152
    v_lshlrev_b32 v38, 16, v153
    v_and_b32 v39, 0xffff0000, v153
    v_pk_add_f32 v[36:37], v[36:37], v[164:165]
    v_pk_add_f32 v[38:39], v[38:39], v[166:167]
    v_pk_fma_f32 v[36:37], v[88:89], v[156:157], v[36:37]
    v_pk_fma_f32 v[38:39], v[90:91], v[158:159], v[38:39]
    v_lshlrev_b32 v40, 16, v154
    v_and_b32 v41, 0xffff0000, v154
    v_lshlrev_b32 v42, 16, v155
    v_and_b32 v43, 0xffff0000, v155
    v_pk_add_f32 v[40:41], v[40:41], v[168:169]
    v_pk_add_f32 v[42:43], v[42:43], v[170:171]
    v_pk_fma_f32 v[40:41], v[104:105], v[160:161], v[40:41]
    v_pk_fma_f32 v[42:43], v[106:107], v[162:163], v[42:43]
    v_and_b32 v2, 15, v1
    v_lshlrev_b32 v2, 11, v2
    v_bfe_u32 v3, v1, 4, 1
    v_lshl_add_u32 v2, v3, 5, v2
    v_lshrrev_b32 v3, 5, v1
    v_lshl_add_u32 v2, v3, 4, v2
    s_lshl_b32 s62, s40, 1
    s_add_u32 s62, s62, s52
    s_lshl_b32 s62, s62, 17
    s_lshl_b32 s63, s41, 1
    s_add_u32 s63, s63, s53
    s_lshl_b32 s63, s63, 6
    s_add_u32 s62, s62, s63
    s_waitcnt vmcnt(3)
    v_lshlrev_b32 v108, 16, v176
    v_and_b32 v109, 0xffff0000, v176
    v_lshlrev_b32 v110, 16, v177
    v_and_b32 v111, 0xffff0000, v177
    v_lshlrev_b32 v124, 16, v178
    v_and_b32 v125, 0xffff0000, v178
    v_lshlrev_b32 v126, 16, v179
    v_and_b32 v127, 0xffff0000, v179
    v_pk_fma_f32 v[12:13], v[108:109], v[156:157], v[12:13]
    v_pk_fma_f32 v[14:15], v[110:111], v[158:159], v[14:15]
    v_cvt_pk_bf16_f32 v44, v12, v13
    v_cvt_pk_bf16_f32 v45, v14, v15
    v_pk_fma_f32 v[16:17], v[124:125], v[160:161], v[16:17]
    v_pk_fma_f32 v[18:19], v[126:127], v[162:163], v[18:19]
    v_cvt_pk_bf16_f32 v46, v16, v17
    v_cvt_pk_bf16_f32 v47, v18, v19
    s_nop 0
    v_permlane16_swap_b32 v44, v46
    v_permlane16_swap_b32 v45, v47
    buffer_store_dwordx4 v[44:47], v2, s[28:31], s62 offen sc1
    s_add_u32 s62, s62, 32768
    s_waitcnt vmcnt(3)
    v_lshlrev_b32 v112, 16, v180
    v_and_b32 v113, 0xffff0000, v180
    v_lshlrev_b32 v114, 16, v181
    v_and_b32 v115, 0xffff0000, v181
    v_lshlrev_b32 v128, 16, v182
    v_and_b32 v129, 0xffff0000, v182
    v_lshlrev_b32 v130, 16, v183
    v_and_b32 v131, 0xffff0000, v183
    v_pk_fma_f32 v[20:21], v[112:113], v[156:157], v[20:21]
    v_pk_fma_f32 v[22:23], v[114:115], v[158:159], v[22:23]
    v_cvt_pk_bf16_f32 v48, v20, v21
    v_cvt_pk_bf16_f32 v49, v22, v23
    v_pk_fma_f32 v[24:25], v[128:129], v[160:161], v[24:25]
    v_pk_fma_f32 v[26:27], v[130:131], v[162:163], v[26:27]
    v_cvt_pk_bf16_f32 v50, v24, v25
    v_cvt_pk_bf16_f32 v51, v26, v27
    s_nop 0
    v_permlane16_swap_b32 v48, v50
    v_permlane16_swap_b32 v49, v51
    buffer_store_dwordx4 v[48:51], v2, s[28:31], s62 offen sc1
    s_add_u32 s62, s62, 32768
    s_waitcnt vmcnt(3)
    v_lshlrev_b32 v116, 16, v184
    v_and_b32 v117, 0xffff0000, v184
    v_lshlrev_b32 v118, 16, v185
    v_and_b32 v119, 0xffff0000, v185
    v_lshlrev_b32 v132, 16, v186
    v_and_b32 v133, 0xffff0000, v186
    v_lshlrev_b32 v134, 16, v187
    v_and_b32 v135, 0xffff0000, v187
    v_pk_fma_f32 v[28:29], v[116:117], v[156:157], v[28:29]
    v_pk_fma_f32 v[30:31], v[118:119], v[158:159], v[30:31]
    v_cvt_pk_bf16_f32 v52, v28, v29
    v_cvt_pk_bf16_f32 v53, v30, v31
    v_pk_fma_f32 v[32:33], v[132:133], v[160:161], v[32:33]
    v_pk_fma_f32 v[34:35], v[134:135], v[162:163], v[34:35]
    v_cvt_pk_bf16_f32 v54, v32, v33
    v_cvt_pk_bf16_f32 v55, v34, v35
    s_nop 0
    v_permlane16_swap_b32 v52, v54
    v_permlane16_swap_b32 v53, v55
    buffer_store_dwordx4 v[52:55], v2, s[28:31], s62 offen sc1
    s_add_u32 s62, s62, 32768
    s_waitcnt vmcnt(3)
    v_lshlrev_b32 v120, 16, v188
    v_and_b32 v121, 0xffff0000, v188
    v_lshlrev_b32 v122, 16, v189
    v_and_b32 v123, 0xffff0000, v189
    v_lshlrev_b32 v136, 16, v190
    v_and_b32 v137, 0xffff0000, v190
    v_lshlrev_b32 v138, 16, v191
    v_and_b32 v139, 0xffff0000, v191
    v_pk_fma_f32 v[36:37], v[120:121], v[156:157], v[36:37]
    v_pk_fma_f32 v[38:39], v[122:123], v[158:159], v[38:39]
    v_cvt_pk_bf16_f32 v56, v36, v37
    v_cvt_pk_bf16_f32 v57, v38, v39
    v_pk_fma_f32 v[40:41], v[136:137], v[160:161], v[40:41]
    v_pk_fma_f32 v[42:43], v[138:139], v[162:163], v[42:43]
    v_cvt_pk_bf16_f32 v58, v40, v41
    v_cvt_pk_bf16_f32 v59, v42, v43
    s_nop 0
    v_permlane16_swap_b32 v56, v58
    v_permlane16_swap_b32 v57, v59
    buffer_store_dwordx4 v[56:59], v2, s[28:31], s62 offen sc1
    s_add_u32 s62, s62, 32768
mega_end:
    s_endpgm
.p2align 6
qkv_tab:
.byte 0,1,2,3,7,4,5,6,11,8,9,10,15,12,13,14,0,0,0,0,0,0,0,0,0,0,0,0,0,0,0,0,0,0,0,0,0,0,0,0,0,0,0,0,0,0,0,0,0,0,0,0,0,0,0,0,0,0,0,0,0,0,0,0
.byte 1,4,0,2,3,8,5,6,7,12,9,10,11,13,14,15,0,0,0,0,0,0,0,0,0,0,0,0,0,0,0,0,0,0,0,0,0,0,0,0,0,0,0,0,0,0,0,0,0,0,0,0,0,0,0,0,0,0,0,0,0,0,0,0
.byte 2,0,5,1,3,4,9,6,7,8,13,10,11,12,14,15,0,0,0,0,0,0,0,0,0,0,0,0,0,0,0,0,0,0,0,0,0,0,0,0,0,0,0,0,0,0,0,0,0,0,0,0,0,0,0,0,0,0,0,0,0,0,0,0
.byte 3,0,1,6,2,4,5,10,7,8,9,14,11,12,13,15,0,0,0,0,0,0,0,0,0,0,0,0,0,0,0,0,0,0,0,0,0,0,0,0,0,0,0,0,0,0,0,0,0,0,0,0,0,0,0,0,0,0,0,0,0,0,0,0
.p2align 2
.p2align 6
wo_tab:
.byte 0,1,2,3,7,4,5,6,0,0,0,0,0,0,0,0,0,0,0,0,0,0,0,0,0,0,0,0,0,0,0,0,0,0,0,0,0,0,0,0,0,0,0,0,0,0,0,0,0,0,0,0,0,0,0,0,0,0,0,0,0,0,0,0
.byte 1,4,0,2,3,5,6,7,0,0,0,0,0,0,0,0,0,0,0,0,0,0,0,0,0,0,0,0,0,0,0,0,0,0,0,0,0,0,0,0,0,0,0,0,0,0,0,0,0,0,0,0,0,0,0,0,0,0,0,0,0,0,0,0
.byte 2,0,5,1,3,4,6,7,0,0,0,0,0,0,0,0,0,0,0,0,0,0,0,0,0,0,0,0,0,0,0,0,0,0,0,0,0,0,0,0,0,0,0,0,0,0,0,0,0,0,0,0,0,0,0,0,0,0,0,0,0,0,0,0
.byte 3,0,1,6,2,4,5,7,0,0,0,0,0,0,0,0,0,0,0,0,0,0,0,0,0,0,0,0,0,0,0,0,0,0,0,0,0,0,0,0,0,0,0,0,0,0,0,0,0,0,0,0,0,0,0,0,0,0,0,0,0,0,0,0
.p2align 2
.p2align 6
w1_tab:
.byte 0,1,2,3,7,4,5,6,11,8,9,10,15,12,13,14,0,0,0,0,0,0,0,0,0,0,0,0,0,0,0,0,0,0,0,0,0,0,0,0,0,0,0,0,0,0,0,0,0,0,0,0,0,0,0,0,0,0,0,0,0,0,0,0
.byte 1,4,0,2,3,8,5,6,7,12,9,10,11,13,14,15,0,0,0,0,0,0,0,0,0,0,0,0,0,0,0,0,0,0,0,0,0,0,0,0,0,0,0,0,0,0,0,0,0,0,0,0,0,0,0,0,0,0,0,0,0,0,0,0
.byte 2,0,5,1,3,4,9,6,7,8,13,10,11,12,14,15,0,0,0,0,0,0,0,0,0,0,0,0,0,0,0,0,0,0,0,0,0,0,0,0,0,0,0,0,0,0,0,0,0,0,0,0,0,0,0,0,0,0,0,0,0,0,0,0
.byte 3,0,1,6,2,4,5,10,7,8,9,14,11,12,13,15,0,0,0,0,0,0,0,0,0,0,0,0,0,0,0,0,0,0,0,0,0,0,0,0,0,0,0,0,0,0,0,0,0,0,0,0,0,0,0,0,0,0,0,0,0,0,0,0
.byte 8,9,10,11,15,12,13,14,3,0,1,2,7,4,5,6,0,0,0,0,0,0,0,0,0,0,0,0,0,0,0,0,0,0,0,0,0,0,0,0,0,0,0,0,0,0,0,0,0,0,0,0,0,0,0,0,0,0,0,0,0,0,0,0
.byte 9,12,8,10,11,0,13,14,15,4,1,2,3,5,6,7,0,0,0,0,0,0,0,0,0,0,0,0,0,0,0,0,0,0,0,0,0,0,0,0,0,0,0,0,0,0,0,0,0,0,0,0,0,0,0,0,0,0,0,0,0,0,0,0
.byte 10,8,13,9,11,12,1,14,15,0,5,2,3,4,6,7,0,0,0,0,0,0,0,0,0,0,0,0,0,0,0,0,0,0,0,0,0,0,0,0,0,0,0,0,0,0,0,0,0,0,0,0,0,0,0,0,0,0,0,0,0,0,0,0
.byte 11,8,9,14,10,12,13,2,15,0,1,6,3,4,5,7,0,0,0,0,0,0,0,0,0,0,0,0,0,0,0,0,0,0,0,0,0,0,0,0,0,0,0,0,0,0,0,0,0,0,0,0,0,0,0,0,0,0,0,0,0,0,0,0
.p2align 2
.p2align 6
w2_tab:
.byte 0,1,2,3,7,4,5,6,11,8,9,10,15,12,13,14,19,16,17,18,23,20,21,22,24,25,26,27,53,54,55,0
.byte 4,5,6,0,1,2,3,7,11,8,9,10,15,12,13,14,19,16,17,18,23,20,21,22,24,25,26,27,53,54,55,0
.byte 7,8,9,0,1,2,3,4,5,6,11,10,15,12,13,14,19,16,17,18,23,20,21,22,24,25,26,27,53,54,55,0
.byte 11,12,13,0,1,2,3,7,4,5,6,8,9,10,15,14,19,16,17,18,23,20,21,22,24,25,26,27,53,54,55,0
.byte 14,15,16,0,1,2,3,7,4,5,6,11,8,9,10,12,13,19,17,18,23,20,21,22,24,25,26,27,53,54,55,0
.byte 18,19,20,0,1,2,3,7,4,5,6,11,8,9,10,15,12,13,14,16,17,23,21,22,24,25,26,27,53,54,55,0
.byte 21,22,23,0,1,2,3,7,4,5,6,11,8,9,10,15,12,13,14,19,16,17,18,20,24,25,26,27,53,54,55,0
.byte 25,26,27,3,7,4,5,6,11,8,9,10,15,12,13,14,19,16,17,18,23,20,21,22,24,0,1,2,28,29,30,0
.byte 28,29,30,31,35,32,33,34,39,36,37,38,43,40,41,42,47,44,45,46,51,48,49,50,52,25,26,27,53,54,55,0
.byte 32,33,34,28,29,30,31,35,39,36,37,38,43,40,41,42,47,44,45,46,51,48,49,50,52,25,26,27,53,54,55,0
.byte 35,36,37,28,29,30,31,32,33,34,39,38,43,40,41,42,47,44,45,46,51,48,49,50,52,25,26,27,53,54,55,0
.byte 39,40,41,28,29,30,31,35,32,33,34,36,37,38,43,42,47,44,45,46,51,48,49,50,52,25,26,27,53,54,55,0
.byte 42,43,44,28,29,30,31,35,32,33,34,39,36,37,38,40,41,47,45,46,51,48,49,50,52,25,26,27,53,54,55,0
.byte 46,47,48,28,29,30,31,35,32,33,34,39,36,37,38,43,40,41,42,44,45,51,49,50,52,25,26,27,53,54,55,0
.byte 49,50,51,28,29,30,31,35,32,33,34,39,36,37,38,43,40,41,42,47,44,45,46,48,52,25,26,27,53,54,55,0
.byte 53,54,55,31,35,32,33,34,39,36,37,38,43,40,41,42,47,44,45,46,51,48,49,50,52,0,1,2,28,29,30,0
.byte 0,1,2,4,3,8,5,6,7,12,9,10,11,16,13,14,15,20,17,18,19,24,21,22,23,26,54,25,27,53,55,0
.byte 4,5,6,1,0,2,3,8,7,12,9,10,11,16,13,14,15,20,17,18,19,24,21,22,23,26,54,25,27,53,55,0
.byte 7,8,9,1,4,0,2,3,5,6,12,10,11,16,13,14,15,20,17,18,19,24,21,22,23,26,54,25,27,53,55,0
.byte 11,12,13,1,4,0,2,3,8,5,6,7,9,10,16,14,15,20,17,18,19,24,21,22,23,26,54,25,27,53,55,0
.byte 14,15,16,1,4,0,2,3,8,5,6,7,12,9,10,11,13,20,17,18,19,24,21,22,23,26,54,25,27,53,55,0
.byte 18,19,20,1,4,0,2,3,8,5,6,7,12,9,10,11,16,13,14,15,17,24,21,22,23,26,54,25,27,53,55,0
.byte 21,22,23,1,4,0,2,3,8,5,6,7,12,9,10,11,16,13,14,15,20,17,18,19,24,26,54,25,27,53,55,0
.byte 25,26,27,4,3,8,5,6,7,12,9,10,11,16,13,14,15,20,17,18,19,24,21,22,23,1,29,0,2,28,30,0
.byte 28,29,30,32,31,36,33,34,35,40,37,38,39,44,41,42,43,48,45,46,47,52,49,50,51,26,54,25,27,53,55,0
.byte 32,33,34,29,28,30,31,36,35,40,37,38,39,44,41,42,43,48,45,46,47,52,49,50,51,26,54,25,27,53,55,0
.byte 35,36,37,29,32,28,30,31,33,34,40,38,39,44,41,42,43,48,45,46,47,52,49,50,51,26,54,25,27,53,55,0
.byte 39,40,41,29,32,28,30,31,36,33,34,35,37,38,44,42,43,48,45,46,47,52,49,50,51,26,54,25,27,53,55,0
.byte 42,43,44,29,32,28,30,31,36,33,34,35,40,37,38,39,41,48,45,46,47,52,49,50,51,26,54,25,27,53,55,0
.byte 46,47,48,29,32,28,30,31,36,33,34,35,40,37,38,39,44,41,42,43,45,52,49,50,51,26,54,25,27,53,55,0
.byte 49,50,51,29,32,28,30,31,36,33,34,35,40,37,38,39,44,41,42,43,48,45,46,47,52,26,54,25,27,53,55,0
.byte 53,54,55,32,31,36,33,34,35,40,37,38,39,44,41,42,43,48,45,46,47,52,49,50,51,1,29,0,2,28,30,0
.byte 0,1,2,5,3,4,9,6,7,8,13,10,11,12,17,14,15,16,21,18,19,20,22,23,24,27,25,55,26,53,54,0
.byte 4,5,6,2,0,1,3,9,7,8,13,10,11,12,17,14,15,16,21,18,19,20,22,23,24,27,25,55,26,53,54,0
.byte 7,8,9,2,0,5,1,3,4,6,13,10,11,12,17,14,15,16,21,18,19,20,22,23,24,27,25,55,26,53,54,0
.byte 11,12,13,2,0,5,1,3,4,9,6,7,8,10,17,14,15,16,21,18,19,20,22,23,24,27,25,55,26,53,54,0
.byte 14,15,16,2,0,5,1,3,4,9,6,7,8,13,10,11,12,17,21,18,19,20,22,23,24,27,25,55,26,53,54,0
.byte 18,19,20,2,0,5,1,3,4,9,6,7,8,13,10,11,12,17,14,15,16,21,22,23,24,27,25,55,26,53,54,0
.byte 21,22,23,2,0,5,1,3,4,9,6,7,8,13,10,11,12,17,14,15,16,18,19,20,24,27,25,55,26,53,54,0
.byte 25,26,27,5,3,4,9,6,7,8,13,10,11,12,17,14,15,16,21,18,19,20,22,23,24,2,0,30,1,28,29,0
.byte 28,29,30,33,31,32,37,34,35,36,41,38,39,40,45,42,43,44,49,46,47,48,50,51,52,27,25,55,26,53,54,0
.byte 32,33,34,30,28,29,31,37,35,36,41,38,39,40,45,42,43,44,49,46,47,48,50,51,52,27,25,55,26,53,54,0
.byte 35,36,37,30,28,33,29,31,32,34,41,38,39,40,45,42,43,44,49,46,47,48,50,51,52,27,25,55,26,53,54,0
.byte 39,40,41,30,28,33,29,31,32,37,34,35,36,38,45,42,43,44,49,46,47,48,50,51,52,27,25,55,26,53,54,0
.byte 42,43,44,30,28,33,29,31,32,37,34,35,36,41,38,39,40,45,49,46,47,48,50,51,52,27,25,55,26,53,54,0
.byte 46,47,48,30,28,33,29,31,32,37,34,35,36,41,38,39,40,45,42,43,44,49,50,51,52,27,25,55,26,53,54,0
.byte 49,50,51,30,28,33,29,31,32,37,34,35,36,41,38,39,40,45,42,43,44,46,47,48,52,27,25,55,26,53,54,0
.byte 53,54,55,33,31,32,37,34,35,36,41,38,39,40,45,42,43,44,49,46,47,48,50,51,52,2,0,30,1,28,29,0
.byte 0,1,2,3,6,4,5,10,7,8,9,14,11,12,13,18,15,16,17,22,19,20,21,23,24,53,25,26,27,54,55,0
.byte 4,5,6,3,0,1,2,10,7,8,9,14,11,12,13,18,15,16,17,22,19,20,21,23,24,53,25,26,27,54,55,0
.byte 7,8,9,3,0,1,6,2,4,5,10,14,11,12,13,18,15,16,17,22,19,20,21,23,24,53,25,26,27,54,55,0
.byte 11,12,13,3,0,1,6,2,4,5,10,7,8,9,14,18,15,16,17,22,19,20,21,23,24,53,25,26,27,54,55,0
.byte 14,15,16,3,0,1,6,2,4,5,10,7,8,9,11,12,13,18,17,22,19,20,21,23,24,53,25,26,27,54,55,0
.byte 18,19,20,3,0,1,6,2,4,5,10,7,8,9,14,11,12,13,15,16,17,22,21,23,24,53,25,26,27,54,55,0
.byte 21,22,23,3,0,1,6,2,4,5,10,7,8,9,14,11,12,13,18,15,16,17,19,20,24,53,25,26,27,54,55,0
.byte 25,26,27,3,6,4,5,10,7,8,9,14,11,12,13,18,15,16,17,22,19,20,21,23,24,28,0,1,2,29,30,0
.byte 28,29,30,31,34,32,33,38,35,36,37,42,39,40,41,46,43,44,45,50,47,48,49,51,52,53,25,26,27,54,55,0
.byte 32,33,34,31,28,29,30,38,35,36,37,42,39,40,41,46,43,44,45,50,47,48,49,51,52,53,25,26,27,54,55,0
.byte 35,36,37,31,28,29,34,30,32,33,38,42,39,40,41,46,43,44,45,50,47,48,49,51,52,53,25,26,27,54,55,0
.byte 39,40,41,31,28,29,34,30,32,33,38,35,36,37,42,46,43,44,45,50,47,48,49,51,52,53,25,26,27,54,55,0
.byte 42,43,44,31,28,29,34,30,32,33,38,35,36,37,39,40,41,46,45,50,47,48,49,51,52,53,25,26,27,54,55,0
.byte 46,47,48,31,28,29,34,30,32,33,38,35,36,37,42,39,40,41,43,44,45,50,49,51,52,53,25,26,27,54,55,0
.byte 49,50,51,31,28,29,34,30,32,33,38,35,36,37,42,39,40,41,46,43,44,45,47,48,52,53,25,26,27,54,55,0
.byte 53,54,55,31,34,32,33,38,35,36,37,42,39,40,41,46,43,44,45,50,47,48,49,51,52,28,0,1,2,29,30,0
.fill 64, 1, 0
.p2align 2
code_end:
    s_endpgm
.section .rodata,"a"
.p2align 6
.amdhsa_kernel adaLN_cond__linear_kernel_hedgehog__dense_activation_squared_relu__prompt_kernel
  .amdhsa_next_free_vgpr 256
  .amdhsa_next_free_sgpr 102
  .amdhsa_accum_offset 256
  .amdhsa_group_segment_fixed_size 0
  .amdhsa_kernarg_size 112
  .amdhsa_user_sgpr_count 2
  .amdhsa_user_sgpr_kernarg_segment_ptr 1
  .amdhsa_system_sgpr_workgroup_id_x 1
.end_amdhsa_kernel
```
